```python
import torch

def _softmax(x, axis=-1):
    return torch.softmax(x, dim=axis)
def _gelu(x):
    return torch.nn.functional.gelu(x, approximate="tanh")
def _silu(x):
    return torch.nn.functional.silu(x)
def _sigmoid(x):
    return torch.sigmoid(x)
def _layernorm(x, axis=-1, eps=1e-5):
    m = x.mean(dim=axis, keepdim=True)
    v = x.var(dim=axis, keepdim=True, unbiased=False)
    return (x - m) / torch.sqrt(v + eps)
def _scatter_add(tgt, idx, src, axis=0):
    return tgt.clone().index_add_(axis, idx, src)
def _segment_sum(src, seg, n):
    out = torch.zeros((n,) + src.shape[1:], dtype=src.dtype)
    return out.index_add_(0, seg, src)
def _pad(x, pw):
    flat = tuple(v for pair in reversed(pw) for v in pair)
    return torch.nn.functional.pad(x, flat)

kernel_name = 'parallel_sum__sliding_block__mixer_channel_mlp__prompt'

def setup_inputs():

    _w = (lambda a: (lambda t: t.to(torch.bfloat16) if t.is_floating_point() else t)(torch.as_tensor(a)))
    def _A_setup():
        B, S, D = 1, 2048, 1024
        return {
            "x": _w((lambda *s: torch.randn(*s, dtype=torch.bfloat16) * 0.05)(B, S, D)),
            "wqkv": _w((lambda *s: torch.randn(*s, dtype=torch.bfloat16) * 0.05)(D, 3 * D)),
            "wo": _w((lambda *s: torch.randn(*s, dtype=torch.bfloat16) * 0.05)(D, D)),
        }
    _A_in = _A_setup()

    def _B_setup():
        B, S, D, F = 1, 2048, 1024, 3584
        return {
            "x": _w((lambda *s: torch.randn(*s, dtype=torch.bfloat16) * 0.05)(B, S, D)),
            "w1": _w((lambda *s: torch.randn(*s, dtype=torch.bfloat16) * 3.2)(D, F) * (D ** -0.5)),
            "b1": _w((lambda *s: torch.randn(*s, dtype=torch.bfloat16) * 1.6)(F)),
            "w2": _w((lambda *s: torch.randn(*s, dtype=torch.bfloat16) * 0.4)(F, D) * (F ** -0.5)),
            "b2": _w((lambda *s: torch.randn(*s, dtype=torch.bfloat16) * 0.8)(D)),
        }
    _B_in = _B_setup()

    return {
        "A_x": _A_in["x"],
        "A_wqkv": _A_in["wqkv"],
        "A_wo": _A_in["wo"],
        "B_x": _B_in["x"],
        "B_w1": _B_in["w1"],
        "B_b1": _B_in["b1"],
        "B_w2": _B_in["w2"],
        "B_b2": _B_in["b2"],
    }

def reference(A_x, A_wqkv, A_wo, B_x, B_w1, B_b1, B_w2, B_b2):
    def _A_ref(x, wqkv, wo):
        B, S, D = x.shape
        H = 32; Dh = D // H; W = 256
        qkv = (lambda x, *d: x.permute(*d))((x @ wqkv).reshape(B, S, 3, H, Dh), 2, 0, 3, 1, 4)
        q, k, v = qkv[0], qkv[1], qkv[2]
        scores = torch.einsum("bhqd,bhkd->bhqk", q, k) * (Dh ** -0.5)
        idx = torch.arange(S)
        mask = (idx[:, None] - idx[None, :] >= 0) & (idx[:, None] - idx[None, :] < W)
        scores = torch.where(mask[None, None], scores, -1e9)
        p = _softmax(scores, axis=-1)
        o = torch.einsum("bhqk,bhkd->bhqd", p, v)
        return (lambda x, *d: x.permute(*d))(o, 0, 2, 1, 3).reshape(B, S, D) @ wo

    def _B_ref(x, w1, b1, w2, b2):
        y = _layernorm(x, axis=-1)
        h = _gelu(torch.einsum("bsd,df->bsf", y, w1) + b1)
        return torch.einsum("bsf,fd->bsd", h, w2) + b2

    x = A_x
    xn = _layernorm(x, axis=-1)
    return x + _A_ref(xn, A_wqkv, A_wo) + _B_ref(xn, B_w1, B_b1, B_w2, B_b2)
```

```asm
; @launch kernel=f1_kernel grid=(256,1,1) block=(512,1,1) lds=163840
.amdgcn_target "amdgcn-amd-amdhsa--gfx950"
.text
.globl f1_kernel
.p2align 8
.type f1_kernel,@function
f1_kernel:
    s_cmp_ge_u32 s2, 256
    s_cbranch_scc1 f1_done
    s_load_dwordx2 s[4:5], s[0:1], 0
    s_load_dwordx4 s[64:67], s[0:1], 8
    s_load_dwordx2 s[60:61], s[0:1], 32
    s_load_dwordx2 s[38:39], s[0:1], 40
    s_load_dwordx2 s[62:63], s[0:1], 48
    s_load_dwordx4 s[68:71], s[0:1], 72
    s_load_dwordx4 s[88:91], s[0:1], 56
    s_and_b32 s52, s2, 1
    s_lshl_b32 s52, s52, 2
    s_bfe_u32 s3, s2, 0x20003
    s_add_u32 s52, s52, s3
    s_bfe_u32 s53, s2, 0x20001
    s_lshl_b32 s53, s53, 3
    s_lshr_b32 s3, s2, 5
    s_add_u32 s53, s53, s3
    s_getreg_b32 s28, hwreg(HW_REG_XCC_ID, 0, 16)
    v_lshrrev_b32 v1, 6, v0
    v_and_b32 v254, 63, v0
    v_readfirstlane_b32 s24, v1
    s_nop 0
    s_and_b32 s25, s24, 3
    s_lshr_b32 s26, s24, 2
    s_cmp_eq_u32 s26, 0
    s_cbranch_scc0 f1_h
    s_and_b32 s54, s53, 1
    s_lshl_b32 s54, s54, 1
    s_lshl_b32 s57, s53, 3
    s_add_u32 s57, s57, s24
    s_lshl_b32 s58, s57, 11
    v_lshlrev_b32 v8, 4, v254
    v_lshrrev_b32 v2, 3, v254
    s_lshl_b32 s23, s24, 5
    v_add_u32 v2, s23, v2
    v_lshrrev_b32 v3, 4, v254
    v_and_b32 v4, 7, v254
    v_xor_b32 v3, v3, v4
    v_lshlrev_b32 v2, 11, v2
    v_lshl_add_u32 v182, v3, 4, v2
    v_xor_b32 v2, 64, v182
    v_add_u32 v183, 15360, v2
    v_add_u32 v184, 30720, v182
    v_add_u32 v185, 46080, v2
    s_lshl_b32 s36, s24, 12
    s_lshl_b32 s56, s52, 1
    s_lshl_b32 s16, s56, 7
    s_mul_i32 s55, s53, 64
    s_mul_i32 s17, s56, 393216
    s_add_u32 s17, s17, s55
    s_lshl_b32 s59, s52, 19
    s_waitcnt lgkmcnt(0)
    s_add_u32 s8, s4, s59
    s_addc_u32 s9, s5, 0
    s_mov_b32 s10, 524288
    s_mov_b32 s11, 0x00020000
    buffer_load_dwordx4 v[96:99], v8, s[8:11], s58 offen
    buffer_load_dwordx4 v[100:103], v8, s[8:11], s58 offen offset:1024
    s_add_u32 m0, s36, 0
    s_nop 0
    buffer_load_dwordx4 v182, s[8:11], s16 offen offset:0 lds
    buffer_load_dwordx4 v183, s[8:11], s16 offen offset:1024 lds
    buffer_load_dwordx4 v184, s[8:11], s16 offen offset:2048 lds
    buffer_load_dwordx4 v185, s[8:11], s16 offen offset:3072 lds
    s_add_u32 s16, s16, 128
    s_and_b32 s16, s16, 2047
    v_add_u32 v2, 0, v254
    v_mul_u32_u24 v3, 5462, v2
    v_lshrrev_b32 v3, 16, v3
    v_mul_u32_u24 v4, 12, v3
    v_sub_u32 v4, v2, v4
    v_lshrrev_b32 v5, 3, v3
    v_lshlrev_b32 v5, 1, v5
    v_xor_b32 v4, v4, v5
    v_lshrrev_b32 v5, 2, v4
    v_lshlrev_b32 v5, 11, v5
    v_and_b32 v4, 3, v4
    v_lshl_add_u32 v4, v4, 4, v5
    s_lshl_b32 s23, s25, 4
    v_add_u32 v3, s23, v3
    v_mul_u32_u24 v3, 6144, v3
    v_add_u32 v186, v3, v4
    v_add_u32 v2, 64, v254
    v_mul_u32_u24 v3, 5462, v2
    v_lshrrev_b32 v3, 16, v3
    v_mul_u32_u24 v4, 12, v3
    v_sub_u32 v4, v2, v4
    v_lshrrev_b32 v5, 3, v3
    v_lshlrev_b32 v5, 1, v5
    v_xor_b32 v4, v4, v5
    v_lshrrev_b32 v5, 2, v4
    v_lshlrev_b32 v5, 11, v5
    v_and_b32 v4, 3, v4
    v_lshl_add_u32 v4, v4, 4, v5
    s_lshl_b32 s23, s25, 4
    v_add_u32 v3, s23, v3
    v_mul_u32_u24 v3, 6144, v3
    v_add_u32 v187, v3, v4
    v_subrev_u32 v187, 1024, v187
    v_add_u32 v2, 128, v254
    v_mul_u32_u24 v3, 5462, v2
    v_lshrrev_b32 v3, 16, v3
    v_mul_u32_u24 v4, 12, v3
    v_sub_u32 v4, v2, v4
    v_lshrrev_b32 v5, 3, v3
    v_lshlrev_b32 v5, 1, v5
    v_xor_b32 v4, v4, v5
    v_lshrrev_b32 v5, 2, v4
    v_lshlrev_b32 v5, 11, v5
    v_and_b32 v4, 3, v4
    v_lshl_add_u32 v4, v4, 4, v5
    s_lshl_b32 s23, s25, 4
    v_add_u32 v3, s23, v3
    v_mul_u32_u24 v3, 6144, v3
    v_add_u32 v188, v3, v4
    v_subrev_u32 v188, 2048, v188
    s_mul_i32 s37, s25, 3072
    s_mov_b32 s12, s64
    s_mov_b32 s13, s65
    s_mov_b32 s14, 6291456
    s_mov_b32 s15, 0x00020000
    s_add_u32 m0, s37, 98304
    s_nop 0
    buffer_load_dwordx4 v186, s[12:15], s17 offen offset:0 lds
    buffer_load_dwordx4 v187, s[12:15], s17 offen offset:1024 lds
    buffer_load_dwordx4 v188, s[12:15], s17 offen offset:2048 lds
    s_add_u32 s17, s17, 393216
    v_and_b32 v2, 15, v254
    s_lshl_b32 s23, s25, 6
    v_add_u32 v3, s23, v2
    v_lshlrev_b32 v3, 7, v3
    v_lshrrev_b32 v2, 1, v2
    v_lshrrev_b32 v4, 4, v254
    v_xor_b32 v2, v2, v4
    v_lshl_add_u32 v176, v2, 4, v3
    v_xor_b32 v177, 64, v176
    v_add_u32 v178, 65536, v176
    v_add_u32 v179, 65536, v177
    v_bfe_u32 v2, v254, 2, 2
    v_lshl_add_u32 v3, v4, 3, v2
    v_and_b32 v5, 1, v4
    v_lshlrev_b32 v5, 1, v5
    v_mul_u32_u24 v3, 192, v3
    v_and_b32 v6, 1, v254
    v_lshl_add_u32 v3, v6, 3, v3
    v_add_u32 v3, 98304, v3
    v_bfe_u32 v6, v254, 1, 1
    v_add_u32 v7, 0, v6
    v_xor_b32 v7, v7, v5
    v_lshl_add_u32 v180, v7, 4, v3
    v_add_u32 v7, 2, v6
    v_xor_b32 v7, v7, v5
    v_lshl_add_u32 v181, v7, 4, v3
    s_mov_b64 s[6:7], s[70:71]
    s_add_u32 s44, s6, 33554432
    s_addc_u32 s45, s7, 0
    s_mov_b32 s46, 25165824
    s_mov_b32 s47, 0x00020000
    s_add_u32 s40, s6, 4096
    s_addc_u32 s41, s7, 0
    s_mov_b32 s42, 18874368
    s_mov_b32 s43, 0x00020000
    s_mov_b32 s48, s68
    s_mov_b32 s49, s69
    s_mov_b32 s50, 256
    s_mov_b32 s51, 0x00020000
    s_lshl_b32 s71, s52, 5
    s_add_u32 s71, s71, s53
    s_lshl_b32 s59, s71, 3
    s_add_u32 s59, s59, s24
    s_lshl_b32 s59, s59, 5
    s_add_u32 s59, s59, 8388608
    s_waitcnt vmcnt(7)
    s_mov_b32 s56, 0x3a800000
    s_mov_b32 s57, 0x3727c5ac
    s_mov_b32 s58, 0xffff0000
    v_lshlrev_b32 v16, 16, v96
    v_and_b32 v17, s58, v96
    v_lshlrev_b32 v18, 16, v97
    v_and_b32 v19, s58, v97
    v_lshlrev_b32 v20, 16, v98
    v_and_b32 v21, s58, v98
    v_lshlrev_b32 v22, 16, v99
    v_and_b32 v23, s58, v99
    v_lshlrev_b32 v24, 16, v100
    v_and_b32 v25, s58, v100
    v_lshlrev_b32 v26, 16, v101
    v_and_b32 v27, s58, v101
    v_lshlrev_b32 v28, 16, v102
    v_and_b32 v29, s58, v102
    v_lshlrev_b32 v30, 16, v103
    v_and_b32 v31, s58, v103
    v_pk_add_f32 v[36:37], v[16:17], v[24:25]
    v_pk_add_f32 v[38:39], v[18:19], v[26:27]
    v_pk_add_f32 v[40:41], v[20:21], v[28:29]
    v_pk_add_f32 v[42:43], v[22:23], v[30:31]
    v_pk_add_f32 v[36:37], v[36:37], v[40:41]
    v_pk_add_f32 v[38:39], v[38:39], v[42:43]
    v_pk_add_f32 v[36:37], v[36:37], v[38:39]
    v_add_f32 v32, v36, v37
    s_nop 1
    v_add_f32 v32, v32, v32 quad_perm:[1,0,3,2] row_mask:0xf bank_mask:0xf
    s_nop 1
    v_add_f32 v32, v32, v32 quad_perm:[2,3,0,1] row_mask:0xf bank_mask:0xf
    s_nop 1
    v_add_f32 v32, v32, v32 row_half_mirror row_mask:0xf bank_mask:0xf
    s_nop 1
    v_add_f32 v32, v32, v32 row_mirror row_mask:0xf bank_mask:0xf
    v_mov_b32 v33, v32
    s_nop 1
    v_permlane16_swap_b32 v33, v32
    v_add_f32 v32, v32, v33
    v_mov_b32 v33, v32
    s_nop 1
    v_permlane32_swap_b32 v33, v32
    v_add_f32 v32, v32, v33
    v_mul_f32 v34, s56, v32
    v_mul_f32 v35, s56, v32
    v_pk_add_f32 v[36:37], v[16:17], v[34:35] neg_lo:[0,1] neg_hi:[0,1]
    v_pk_add_f32 v[38:39], v[18:19], v[34:35] neg_lo:[0,1] neg_hi:[0,1]
    v_pk_add_f32 v[40:41], v[20:21], v[34:35] neg_lo:[0,1] neg_hi:[0,1]
    v_pk_add_f32 v[42:43], v[22:23], v[34:35] neg_lo:[0,1] neg_hi:[0,1]
    v_pk_add_f32 v[44:45], v[24:25], v[34:35] neg_lo:[0,1] neg_hi:[0,1]
    v_pk_add_f32 v[46:47], v[26:27], v[34:35] neg_lo:[0,1] neg_hi:[0,1]
    v_pk_add_f32 v[48:49], v[28:29], v[34:35] neg_lo:[0,1] neg_hi:[0,1]
    v_pk_add_f32 v[50:51], v[30:31], v[34:35] neg_lo:[0,1] neg_hi:[0,1]
    v_pk_mul_f32 v[32:33], v[36:37], v[36:37]
    v_pk_mul_f32 v[60:61], v[38:39], v[38:39]
    v_pk_fma_f32 v[32:33], v[40:41], v[40:41], v[32:33]
    v_pk_fma_f32 v[60:61], v[42:43], v[42:43], v[60:61]
    v_pk_fma_f32 v[32:33], v[44:45], v[44:45], v[32:33]
    v_pk_fma_f32 v[60:61], v[46:47], v[46:47], v[60:61]
    v_pk_fma_f32 v[32:33], v[48:49], v[48:49], v[32:33]
    v_pk_fma_f32 v[60:61], v[50:51], v[50:51], v[60:61]
    v_pk_add_f32 v[32:33], v[32:33], v[60:61]
    v_add_f32 v32, v32, v33
    s_nop 1
    v_add_f32 v32, v32, v32 quad_perm:[1,0,3,2] row_mask:0xf bank_mask:0xf
    s_nop 1
    v_add_f32 v32, v32, v32 quad_perm:[2,3,0,1] row_mask:0xf bank_mask:0xf
    s_nop 1
    v_add_f32 v32, v32, v32 row_half_mirror row_mask:0xf bank_mask:0xf
    s_nop 1
    v_add_f32 v32, v32, v32 row_mirror row_mask:0xf bank_mask:0xf
    v_mov_b32 v33, v32
    s_nop 1
    v_permlane16_swap_b32 v33, v32
    v_add_f32 v32, v32, v33
    v_mov_b32 v33, v32
    s_nop 1
    v_permlane32_swap_b32 v33, v32
    v_add_f32 v32, v32, v33
    v_mul_f32 v32, s56, v32
    v_cvt_pk_bf16_f32 v34, v34, v34
    v_and_b32 v34, s58, v34
    v_cvt_pk_bf16_f32 v32, v32, v32
    v_and_b32 v32, s58, v32
    v_add_f32 v32, s57, v32
    v_cvt_pk_bf16_f32 v32, v32, v32
    v_and_b32 v32, s58, v32
    v_sqrt_f32 v32, v32
    s_nop 0
    v_cvt_pk_bf16_f32 v32, v32, v32
    v_and_b32 v32, s58, v32
    v_cvt_pk_bf16_f32 v8, -v34, -v34
    v_mov_b32 v13, v32
    v_rcp_f32 v12, v32
    v_mov_b32 v9, v8
    v_mov_b32 v35, v34
    v_mov_b32 v62, v12
    v_mov_b32 v63, v12
    v_pk_add_f32 v[36:37], v[16:17], v[34:35] neg_lo:[0,1] neg_hi:[0,1]
    v_pk_add_f32 v[38:39], v[18:19], v[34:35] neg_lo:[0,1] neg_hi:[0,1]
    v_pk_add_f32 v[40:41], v[20:21], v[34:35] neg_lo:[0,1] neg_hi:[0,1]
    v_pk_add_f32 v[42:43], v[22:23], v[34:35] neg_lo:[0,1] neg_hi:[0,1]
    v_pk_add_f32 v[44:45], v[24:25], v[34:35] neg_lo:[0,1] neg_hi:[0,1]
    v_pk_add_f32 v[46:47], v[26:27], v[34:35] neg_lo:[0,1] neg_hi:[0,1]
    v_pk_add_f32 v[48:49], v[28:29], v[34:35] neg_lo:[0,1] neg_hi:[0,1]
    v_pk_add_f32 v[50:51], v[30:31], v[34:35] neg_lo:[0,1] neg_hi:[0,1]
    v_cvt_pk_bf16_f32 v52, v36, v37
    v_cvt_pk_bf16_f32 v53, v38, v39
    v_cvt_pk_bf16_f32 v54, v40, v41
    v_cvt_pk_bf16_f32 v55, v42, v43
    v_cvt_pk_bf16_f32 v56, v44, v45
    v_cvt_pk_bf16_f32 v57, v46, v47
    v_cvt_pk_bf16_f32 v58, v48, v49
    v_cvt_pk_bf16_f32 v59, v50, v51
    v_lshlrev_b32 v16, 16, v52
    v_and_b32 v17, s58, v52
    v_lshlrev_b32 v18, 16, v53
    v_and_b32 v19, s58, v53
    v_lshlrev_b32 v20, 16, v54
    v_and_b32 v21, s58, v54
    v_lshlrev_b32 v22, 16, v55
    v_and_b32 v23, s58, v55
    v_lshlrev_b32 v24, 16, v56
    v_and_b32 v25, s58, v56
    v_lshlrev_b32 v26, 16, v57
    v_and_b32 v27, s58, v57
    v_lshlrev_b32 v28, 16, v58
    v_and_b32 v29, s58, v58
    v_lshlrev_b32 v30, 16, v59
    v_and_b32 v31, s58, v59
    v_pk_mul_f32 v[36:37], v[16:17], v[62:63]
    v_pk_mul_f32 v[38:39], v[18:19], v[62:63]
    v_pk_mul_f32 v[40:41], v[20:21], v[62:63]
    v_pk_mul_f32 v[42:43], v[22:23], v[62:63]
    v_pk_mul_f32 v[44:45], v[24:25], v[62:63]
    v_pk_mul_f32 v[46:47], v[26:27], v[62:63]
    v_pk_mul_f32 v[48:49], v[28:29], v[62:63]
    v_pk_mul_f32 v[50:51], v[30:31], v[62:63]
    v_cvt_pk_bf16_f32 v52, v36, v37
    v_cvt_pk_bf16_f32 v53, v38, v39
    v_cvt_pk_bf16_f32 v54, v40, v41
    v_cvt_pk_bf16_f32 v55, v42, v43
    v_cvt_pk_bf16_f32 v56, v44, v45
    v_cvt_pk_bf16_f32 v57, v46, v47
    v_cvt_pk_bf16_f32 v58, v48, v49
    v_cvt_pk_bf16_f32 v59, v50, v51
    v_lshlrev_b32 v16, 16, v52
    v_and_b32 v17, s58, v52
    v_lshlrev_b32 v18, 16, v53
    v_and_b32 v19, s58, v53
    v_lshlrev_b32 v20, 16, v54
    v_and_b32 v21, s58, v54
    v_lshlrev_b32 v22, 16, v55
    v_and_b32 v23, s58, v55
    v_lshlrev_b32 v24, 16, v56
    v_and_b32 v25, s58, v56
    v_lshlrev_b32 v26, 16, v57
    v_and_b32 v27, s58, v57
    v_lshlrev_b32 v28, 16, v58
    v_and_b32 v29, s58, v58
    v_lshlrev_b32 v30, 16, v59
    v_and_b32 v31, s58, v59
    v_pk_add_f32 v[36:37], v[16:17], v[24:25]
    v_pk_add_f32 v[38:39], v[18:19], v[26:27]
    v_pk_add_f32 v[40:41], v[20:21], v[28:29]
    v_pk_add_f32 v[42:43], v[22:23], v[30:31]
    v_pk_add_f32 v[36:37], v[36:37], v[40:41]
    v_pk_add_f32 v[38:39], v[38:39], v[42:43]
    v_pk_add_f32 v[36:37], v[36:37], v[38:39]
    v_add_f32 v32, v36, v37
    s_nop 1
    v_add_f32 v32, v32, v32 quad_perm:[1,0,3,2] row_mask:0xf bank_mask:0xf
    s_nop 1
    v_add_f32 v32, v32, v32 quad_perm:[2,3,0,1] row_mask:0xf bank_mask:0xf
    s_nop 1
    v_add_f32 v32, v32, v32 row_half_mirror row_mask:0xf bank_mask:0xf
    s_nop 1
    v_add_f32 v32, v32, v32 row_mirror row_mask:0xf bank_mask:0xf
    v_mov_b32 v33, v32
    s_nop 1
    v_permlane16_swap_b32 v33, v32
    v_add_f32 v32, v32, v33
    v_mov_b32 v33, v32
    s_nop 1
    v_permlane32_swap_b32 v33, v32
    v_add_f32 v32, v32, v33
    v_mul_f32 v34, s56, v32
    v_mul_f32 v35, s56, v32
    v_pk_add_f32 v[36:37], v[16:17], v[34:35] neg_lo:[0,1] neg_hi:[0,1]
    v_pk_add_f32 v[38:39], v[18:19], v[34:35] neg_lo:[0,1] neg_hi:[0,1]
    v_pk_add_f32 v[40:41], v[20:21], v[34:35] neg_lo:[0,1] neg_hi:[0,1]
    v_pk_add_f32 v[42:43], v[22:23], v[34:35] neg_lo:[0,1] neg_hi:[0,1]
    v_pk_add_f32 v[44:45], v[24:25], v[34:35] neg_lo:[0,1] neg_hi:[0,1]
    v_pk_add_f32 v[46:47], v[26:27], v[34:35] neg_lo:[0,1] neg_hi:[0,1]
    v_pk_add_f32 v[48:49], v[28:29], v[34:35] neg_lo:[0,1] neg_hi:[0,1]
    v_pk_add_f32 v[50:51], v[30:31], v[34:35] neg_lo:[0,1] neg_hi:[0,1]
    v_pk_mul_f32 v[32:33], v[36:37], v[36:37]
    v_pk_mul_f32 v[60:61], v[38:39], v[38:39]
    v_pk_fma_f32 v[32:33], v[40:41], v[40:41], v[32:33]
    v_pk_fma_f32 v[60:61], v[42:43], v[42:43], v[60:61]
    v_pk_fma_f32 v[32:33], v[44:45], v[44:45], v[32:33]
    v_pk_fma_f32 v[60:61], v[46:47], v[46:47], v[60:61]
    v_pk_fma_f32 v[32:33], v[48:49], v[48:49], v[32:33]
    v_pk_fma_f32 v[60:61], v[50:51], v[50:51], v[60:61]
    v_pk_add_f32 v[32:33], v[32:33], v[60:61]
    v_add_f32 v32, v32, v33
    s_nop 1
    v_add_f32 v32, v32, v32 quad_perm:[1,0,3,2] row_mask:0xf bank_mask:0xf
    s_nop 1
    v_add_f32 v32, v32, v32 quad_perm:[2,3,0,1] row_mask:0xf bank_mask:0xf
    s_nop 1
    v_add_f32 v32, v32, v32 row_half_mirror row_mask:0xf bank_mask:0xf
    s_nop 1
    v_add_f32 v32, v32, v32 row_mirror row_mask:0xf bank_mask:0xf
    v_mov_b32 v33, v32
    s_nop 1
    v_permlane16_swap_b32 v33, v32
    v_add_f32 v32, v32, v33
    v_mov_b32 v33, v32
    s_nop 1
    v_permlane32_swap_b32 v33, v32
    v_add_f32 v32, v32, v33
    v_mul_f32 v32, s56, v32
    v_cvt_pk_bf16_f32 v34, v34, v34
    v_and_b32 v34, s58, v34
    v_cvt_pk_bf16_f32 v32, v32, v32
    v_and_b32 v32, s58, v32
    v_add_f32 v32, s57, v32
    v_cvt_pk_bf16_f32 v32, v32, v32
    v_and_b32 v32, s58, v32
    v_sqrt_f32 v32, v32
    s_nop 0
    v_cvt_pk_bf16_f32 v32, v32, v32
    v_and_b32 v32, s58, v32
    v_mul_f32 v10, v34, v13
    v_cvt_pk_bf16_f32 v10, -v10, -v10
    v_mul_f32 v11, v13, v32
    v_and_b32 v14, s58, v11
    v_sub_f32 v15, v11, v14
    v_cvt_pk_bf16_f32 v11, v14, v15
    v_mov_b32 v2, 0
    s_lshl_b32 s58, s71, 7
    s_lshl_b32 s23, s24, 2
    s_add_u32 s58, s58, s23
    s_add_u32 s58, s58, 9437184
    s_mov_b64 exec, 1
    buffer_store_dwordx4 v[8:11], v2, s[44:47], s59 offen sc1
    buffer_store_dwordx2 v[62:63], v2, s[44:47], s59 offen offset:16 sc1
    buffer_store_dword v2, v2, s[44:47], s58 offen sc1
    s_cmp_eq_u32 s24, 2
    s_cselect_b32 s3, s28, 0
    v_mov_b32 v4, s3
    buffer_store_dword v4, v2, s[44:47], s58 offen offset:32 sc1
    s_mov_b64 exec, -1
    s_add_u32 m0, s36, 32768
    s_nop 0
    buffer_load_dwordx4 v182, s[8:11], s16 offen offset:0 lds
    buffer_load_dwordx4 v183, s[8:11], s16 offen offset:1024 lds
    buffer_load_dwordx4 v184, s[8:11], s16 offen offset:2048 lds
    buffer_load_dwordx4 v185, s[8:11], s16 offen offset:3072 lds
    s_add_u32 s16, s16, 128
    s_and_b32 s16, s16, 2047
    s_add_u32 m0, s37, 110592
    s_nop 0
    buffer_load_dwordx4 v186, s[12:15], s17 offen offset:0 lds
    buffer_load_dwordx4 v187, s[12:15], s17 offen offset:1024 lds
    buffer_load_dwordx4 v188, s[12:15], s17 offen offset:2048 lds
    s_add_u32 s17, s17, 393216
    s_cmp_ge_u32 s17, 6291456
    s_cselect_b32 s17, s55, s17
    v_pk_mov_b32 v[216:217], 0, 0
    v_pk_mov_b32 v[218:219], 0, 0
    v_pk_mov_b32 v[220:221], 0, 0
    v_pk_mov_b32 v[222:223], 0, 0
    v_mov_b32 v224, 0x3f803f80
    v_mov_b32 v225, 0x3f803f80
    v_mov_b32 v226, 0x3f803f80
    v_mov_b32 v227, 0x3f803f80
    v_and_b32 v252, 7, v254
    v_lshlrev_b32 v252, 2, v252
    s_waitcnt vmcnt(11)
    s_barrier
    ds_read_b128 v[96:99], v176 offset:0
    ds_read_b64_tr_b16 v[128:129], v180 offset:0
    ds_read_b64_tr_b16 v[130:131], v180 offset:768
    ds_read_b128 v[100:103], v176 offset:2048
    ds_read_b128 v[104:107], v176 offset:4096
    ds_read_b128 v[108:111], v176 offset:6144
    ds_read_b64_tr_b16 v[132:133], v181 offset:0
    ds_read_b64_tr_b16 v[134:135], v181 offset:768
    ds_read_b64_tr_b16 v[136:137], v180 offset:64
    ds_read_b64_tr_b16 v[138:139], v180 offset:832
    ds_read_b64_tr_b16 v[140:141], v181 offset:64
    ds_read_b64_tr_b16 v[142:143], v181 offset:832
    ds_read_b64_tr_b16 v[144:145], v180 offset:128
    ds_read_b64_tr_b16 v[146:147], v180 offset:896
    ds_read_b64_tr_b16 v[148:149], v181 offset:128
    s_waitcnt lgkmcnt(14)
    ds_read_b64_tr_b16 v[150:151], v181 offset:896
    s_add_u32 m0, s36, 65536
    s_nop 0
    buffer_load_dwordx4 v182, s[8:11], s16 offen offset:0 lds
    buffer_load_dwordx4 v183, s[8:11], s16 offen offset:1024 lds
    buffer_load_dwordx4 v184, s[8:11], s16 offen offset:2048 lds
    buffer_load_dwordx4 v185, s[8:11], s16 offen offset:3072 lds
    s_add_u32 s16, s16, 128
    s_and_b32 s16, s16, 2047
    s_waitcnt lgkmcnt(13)
    v_mfma_f32_16x16x32_bf16 v[0:3], v[128:131], v[96:99], 0
    ds_read_b128 v[112:115], v177 offset:0
    s_waitcnt lgkmcnt(13)
    v_mfma_f32_16x16x32_bf16 v[4:7], v[128:131], v[100:103], 0
    ds_read_b64_tr_b16 v[152:153], v180 offset:6144
    s_waitcnt lgkmcnt(13)
    v_mfma_f32_16x16x32_bf16 v[8:11], v[128:131], v[104:107], 0
    ds_read_b64_tr_b16 v[154:155], v180 offset:6912
    s_waitcnt lgkmcnt(13)
    v_mfma_f32_16x16x32_bf16 v[12:15], v[128:131], v[108:111], 0
    ds_read_b128 v[116:119], v177 offset:2048
    s_waitcnt lgkmcnt(12)
    v_mfma_f32_16x16x32_bf16 v[16:19], v[132:135], v[96:99], 0
    ds_read_b128 v[120:123], v177 offset:4096
    v_mfma_f32_16x16x32_bf16 v[20:23], v[132:135], v[100:103], 0
    ds_read_b128 v[124:127], v177 offset:6144
    v_mfma_f32_16x16x32_bf16 v[24:27], v[132:135], v[104:107], 0
    ds_read_b64_tr_b16 v[156:157], v181 offset:6144
    v_mfma_f32_16x16x32_bf16 v[28:31], v[132:135], v[108:111], 0
    s_waitcnt lgkmcnt(14)
    ds_read_b64_tr_b16 v[158:159], v181 offset:6912
    s_waitcnt lgkmcnt(14)
    v_mfma_f32_16x16x32_bf16 v[32:35], v[136:139], v[96:99], 0
    ds_read_b64_tr_b16 v[160:161], v180 offset:6208
    v_mfma_f32_16x16x32_bf16 v[36:39], v[136:139], v[100:103], 0
    s_waitcnt lgkmcnt(14)
    ds_read_b64_tr_b16 v[162:163], v180 offset:6976
    v_mfma_f32_16x16x32_bf16 v[40:43], v[136:139], v[104:107], 0
    s_waitcnt lgkmcnt(14)
    ds_read_b64_tr_b16 v[164:165], v181 offset:6208
    v_mfma_f32_16x16x32_bf16 v[44:47], v[136:139], v[108:111], 0
    s_waitcnt lgkmcnt(14)
    ds_read_b64_tr_b16 v[166:167], v181 offset:6976
    v_mfma_f32_16x16x32_bf16 v[48:51], v[140:143], v[96:99], 0
    s_waitcnt lgkmcnt(14)
    ds_read_b64_tr_b16 v[168:169], v180 offset:6272
    v_mfma_f32_16x16x32_bf16 v[52:55], v[140:143], v[100:103], 0
    s_waitcnt lgkmcnt(14)
    ds_read_b64_tr_b16 v[170:171], v180 offset:7040
    v_mfma_f32_16x16x32_bf16 v[56:59], v[140:143], v[104:107], 0
    s_waitcnt lgkmcnt(14)
    ds_read_b64_tr_b16 v[172:173], v181 offset:6272
    v_mfma_f32_16x16x32_bf16 v[60:63], v[140:143], v[108:111], 0
    s_waitcnt lgkmcnt(14)
    ds_read_b64_tr_b16 v[174:175], v181 offset:7040
    v_mfma_f32_16x16x32_bf16 v[64:67], v[144:147], v[96:99], 0
    v_mfma_f32_16x16x32_bf16 v[68:71], v[144:147], v[100:103], 0
    v_mfma_f32_16x16x32_bf16 v[72:75], v[144:147], v[104:107], 0
    v_mfma_f32_16x16x32_bf16 v[76:79], v[144:147], v[108:111], 0
    v_mfma_f32_16x16x32_bf16 v[80:83], v[148:151], v[96:99], 0
    v_mfma_f32_16x16x32_bf16 v[84:87], v[148:151], v[100:103], 0
    s_waitcnt vmcnt(4) lgkmcnt(0)
    s_barrier
    s_setprio 1
    v_mfma_f32_16x16x32_bf16 v[88:91], v[148:151], v[104:107], 0
    v_mfma_f32_16x16x32_bf16 v[92:95], v[148:151], v[108:111], 0
    v_mfma_f32_16x16x32_bf16 v[0:3], v[152:155], v[112:115], v[0:3]
    s_cmp_eq_u32 s25, 1
    s_cbranch_scc1 cs_3
    s_cmp_eq_u32 s25, 2
    s_cbranch_scc1 cs_4
    s_cmp_eq_u32 s25, 3
    s_cbranch_scc1 cs_5
cs_2:
    v_mfma_f32_16x16x32_bf16 v[216:219], v[128:131], v[224:227], v[216:219]
    v_mfma_f32_16x16x32_bf16 v[216:219], v[152:155], v[224:227], v[216:219]
    v_mfma_f32_16x16x32_bf16 v[220:223], v[144:147], v[224:227], v[220:223]
    v_mfma_f32_16x16x32_bf16 v[220:223], v[168:171], v[224:227], v[220:223]
    s_branch csd_1
cs_3:
    v_mfma_f32_16x16x32_bf16 v[216:219], v[132:135], v[224:227], v[216:219]
    v_mfma_f32_16x16x32_bf16 v[216:219], v[156:159], v[224:227], v[216:219]
    v_mfma_f32_16x16x32_bf16 v[220:223], v[148:151], v[224:227], v[220:223]
    v_mfma_f32_16x16x32_bf16 v[220:223], v[172:175], v[224:227], v[220:223]
    s_branch csd_1
cs_4:
    v_mfma_f32_16x16x32_bf16 v[216:219], v[136:139], v[224:227], v[216:219]
    v_mfma_f32_16x16x32_bf16 v[216:219], v[160:163], v[224:227], v[216:219]
    s_branch csd_1
cs_5:
    v_mfma_f32_16x16x32_bf16 v[216:219], v[140:143], v[224:227], v[216:219]
    v_mfma_f32_16x16x32_bf16 v[216:219], v[164:167], v[224:227], v[216:219]
csd_1:
    ds_read_b128 v[96:99], v176 offset:32768
    s_add_u32 m0, s37, 98304
    s_nop 0
    buffer_load_dwordx4 v186, s[12:15], s17 offen offset:0 lds
    v_mfma_f32_16x16x32_bf16 v[4:7], v[152:155], v[116:119], v[4:7]
    ds_read_b64_tr_b16 v[128:129], v180 offset:12288
    v_mfma_f32_16x16x32_bf16 v[8:11], v[152:155], v[120:123], v[8:11]
    ds_read_b64_tr_b16 v[130:131], v180 offset:13056
    buffer_load_dwordx4 v187, s[12:15], s17 offen offset:1024 lds
    v_mfma_f32_16x16x32_bf16 v[12:15], v[152:155], v[124:127], v[12:15]
    ds_read_b128 v[100:103], v176 offset:34816
    v_mfma_f32_16x16x32_bf16 v[16:19], v[156:159], v[112:115], v[16:19]
    v_mfma_f32_16x16x32_bf16 v[20:23], v[156:159], v[116:119], v[20:23]
    ds_read_b128 v[104:107], v176 offset:36864
    buffer_load_dwordx4 v188, s[12:15], s17 offen offset:2048 lds
    s_add_u32 s17, s17, 393216
    v_mfma_f32_16x16x32_bf16 v[24:27], v[156:159], v[120:123], v[24:27]
    ds_read_b128 v[108:111], v176 offset:38912
    v_mfma_f32_16x16x32_bf16 v[28:31], v[156:159], v[124:127], v[28:31]
    ds_read_b64_tr_b16 v[132:133], v181 offset:12288
    v_mfma_f32_16x16x32_bf16 v[32:35], v[160:163], v[112:115], v[32:35]
    s_add_u32 m0, s36, 0
    s_nop 0
    buffer_load_dwordx4 v182, s[8:11], s16 offen offset:0 lds
    v_mfma_f32_16x16x32_bf16 v[36:39], v[160:163], v[116:119], v[36:39]
    ds_read_b64_tr_b16 v[134:135], v181 offset:13056
    v_mfma_f32_16x16x32_bf16 v[40:43], v[160:163], v[120:123], v[40:43]
    ds_read_b64_tr_b16 v[136:137], v180 offset:12352
    buffer_load_dwordx4 v183, s[8:11], s16 offen offset:1024 lds
    v_mfma_f32_16x16x32_bf16 v[44:47], v[160:163], v[124:127], v[44:47]
    ds_read_b64_tr_b16 v[138:139], v180 offset:13120
    v_mfma_f32_16x16x32_bf16 v[48:51], v[164:167], v[112:115], v[48:51]
    v_mfma_f32_16x16x32_bf16 v[52:55], v[164:167], v[116:119], v[52:55]
    ds_read_b64_tr_b16 v[140:141], v181 offset:12352
    buffer_load_dwordx4 v184, s[8:11], s16 offen offset:2048 lds
    v_mfma_f32_16x16x32_bf16 v[56:59], v[164:167], v[120:123], v[56:59]
    ds_read_b64_tr_b16 v[142:143], v181 offset:13120
    v_mfma_f32_16x16x32_bf16 v[60:63], v[164:167], v[124:127], v[60:63]
    ds_read_b64_tr_b16 v[144:145], v180 offset:12416
    v_mfma_f32_16x16x32_bf16 v[64:67], v[168:171], v[112:115], v[64:67]
    buffer_load_dwordx4 v185, s[8:11], s16 offen offset:3072 lds
    s_add_u32 s16, s16, 128
    s_and_b32 s16, s16, 2047
    v_mfma_f32_16x16x32_bf16 v[68:71], v[168:171], v[116:119], v[68:71]
    ds_read_b64_tr_b16 v[146:147], v180 offset:13184
    v_mfma_f32_16x16x32_bf16 v[72:75], v[168:171], v[120:123], v[72:75]
    ds_read_b64_tr_b16 v[148:149], v181 offset:12416
    s_setprio 0
    v_mfma_f32_16x16x32_bf16 v[76:79], v[168:171], v[124:127], v[76:79]
    s_waitcnt lgkmcnt(14)
    ds_read_b64_tr_b16 v[150:151], v181 offset:13184
    v_mfma_f32_16x16x32_bf16 v[80:83], v[172:175], v[112:115], v[80:83]
    v_mfma_f32_16x16x32_bf16 v[84:87], v[172:175], v[116:119], v[84:87]
    v_mfma_f32_16x16x32_bf16 v[88:91], v[172:175], v[120:123], v[88:91]
    v_mfma_f32_16x16x32_bf16 v[92:95], v[172:175], v[124:127], v[92:95]
    s_waitcnt lgkmcnt(13)
    v_mfma_f32_16x16x32_bf16 v[0:3], v[128:131], v[96:99], v[0:3]
    ds_read_b128 v[112:115], v177 offset:32768
    s_waitcnt lgkmcnt(13)
    v_mfma_f32_16x16x32_bf16 v[4:7], v[128:131], v[100:103], v[4:7]
    ds_read_b64_tr_b16 v[152:153], v180 offset:18432
    s_waitcnt lgkmcnt(13)
    v_mfma_f32_16x16x32_bf16 v[8:11], v[128:131], v[104:107], v[8:11]
    ds_read_b64_tr_b16 v[154:155], v180 offset:19200
    s_waitcnt lgkmcnt(13)
    v_mfma_f32_16x16x32_bf16 v[12:15], v[128:131], v[108:111], v[12:15]
    ds_read_b128 v[116:119], v177 offset:34816
    s_waitcnt lgkmcnt(12)
    v_mfma_f32_16x16x32_bf16 v[16:19], v[132:135], v[96:99], v[16:19]
    ds_read_b128 v[120:123], v177 offset:36864
    v_mfma_f32_16x16x32_bf16 v[20:23], v[132:135], v[100:103], v[20:23]
    ds_read_b128 v[124:127], v177 offset:38912
    v_mfma_f32_16x16x32_bf16 v[24:27], v[132:135], v[104:107], v[24:27]
    ds_read_b64_tr_b16 v[156:157], v181 offset:18432
    v_mfma_f32_16x16x32_bf16 v[28:31], v[132:135], v[108:111], v[28:31]
    s_waitcnt lgkmcnt(14)
    ds_read_b64_tr_b16 v[158:159], v181 offset:19200
    s_waitcnt lgkmcnt(14)
    v_mfma_f32_16x16x32_bf16 v[32:35], v[136:139], v[96:99], v[32:35]
    ds_read_b64_tr_b16 v[160:161], v180 offset:18496
    v_mfma_f32_16x16x32_bf16 v[36:39], v[136:139], v[100:103], v[36:39]
    s_waitcnt lgkmcnt(14)
    ds_read_b64_tr_b16 v[162:163], v180 offset:19264
    v_mfma_f32_16x16x32_bf16 v[40:43], v[136:139], v[104:107], v[40:43]
    s_waitcnt lgkmcnt(14)
    ds_read_b64_tr_b16 v[164:165], v181 offset:18496
    v_mfma_f32_16x16x32_bf16 v[44:47], v[136:139], v[108:111], v[44:47]
    s_waitcnt lgkmcnt(14)
    ds_read_b64_tr_b16 v[166:167], v181 offset:19264
    v_mfma_f32_16x16x32_bf16 v[48:51], v[140:143], v[96:99], v[48:51]
    s_waitcnt lgkmcnt(14)
    ds_read_b64_tr_b16 v[168:169], v180 offset:18560
    v_mfma_f32_16x16x32_bf16 v[52:55], v[140:143], v[100:103], v[52:55]
    s_waitcnt lgkmcnt(14)
    ds_read_b64_tr_b16 v[170:171], v180 offset:19328
    v_mfma_f32_16x16x32_bf16 v[56:59], v[140:143], v[104:107], v[56:59]
    s_waitcnt lgkmcnt(14)
    ds_read_b64_tr_b16 v[172:173], v181 offset:18560
    v_mfma_f32_16x16x32_bf16 v[60:63], v[140:143], v[108:111], v[60:63]
    s_waitcnt lgkmcnt(14)
    ds_read_b64_tr_b16 v[174:175], v181 offset:19328
    v_mfma_f32_16x16x32_bf16 v[64:67], v[144:147], v[96:99], v[64:67]
    v_mfma_f32_16x16x32_bf16 v[68:71], v[144:147], v[100:103], v[68:71]
    v_mfma_f32_16x16x32_bf16 v[72:75], v[144:147], v[104:107], v[72:75]
    v_mfma_f32_16x16x32_bf16 v[76:79], v[144:147], v[108:111], v[76:79]
    v_mfma_f32_16x16x32_bf16 v[80:83], v[148:151], v[96:99], v[80:83]
    v_mfma_f32_16x16x32_bf16 v[84:87], v[148:151], v[100:103], v[84:87]
    s_waitcnt vmcnt(4) lgkmcnt(0)
    s_barrier
    s_setprio 1
    v_mfma_f32_16x16x32_bf16 v[88:91], v[148:151], v[104:107], v[88:91]
    v_mfma_f32_16x16x32_bf16 v[92:95], v[148:151], v[108:111], v[92:95]
    v_mfma_f32_16x16x32_bf16 v[0:3], v[152:155], v[112:115], v[0:3]
    s_cmp_eq_u32 s25, 1
    s_cbranch_scc1 cs_8
    s_cmp_eq_u32 s25, 2
    s_cbranch_scc1 cs_9
    s_cmp_eq_u32 s25, 3
    s_cbranch_scc1 cs_10
cs_7:
    v_mfma_f32_16x16x32_bf16 v[216:219], v[128:131], v[224:227], v[216:219]
    v_mfma_f32_16x16x32_bf16 v[216:219], v[152:155], v[224:227], v[216:219]
    v_mfma_f32_16x16x32_bf16 v[220:223], v[144:147], v[224:227], v[220:223]
    v_mfma_f32_16x16x32_bf16 v[220:223], v[168:171], v[224:227], v[220:223]
    s_branch csd_6
cs_8:
    v_mfma_f32_16x16x32_bf16 v[216:219], v[132:135], v[224:227], v[216:219]
    v_mfma_f32_16x16x32_bf16 v[216:219], v[156:159], v[224:227], v[216:219]
    v_mfma_f32_16x16x32_bf16 v[220:223], v[148:151], v[224:227], v[220:223]
    v_mfma_f32_16x16x32_bf16 v[220:223], v[172:175], v[224:227], v[220:223]
    s_branch csd_6
cs_9:
    v_mfma_f32_16x16x32_bf16 v[216:219], v[136:139], v[224:227], v[216:219]
    v_mfma_f32_16x16x32_bf16 v[216:219], v[160:163], v[224:227], v[216:219]
    s_branch csd_6
cs_10:
    v_mfma_f32_16x16x32_bf16 v[216:219], v[140:143], v[224:227], v[216:219]
    v_mfma_f32_16x16x32_bf16 v[216:219], v[164:167], v[224:227], v[216:219]
csd_6:
    v_and_b32 v228, 3, v254
    v_lshrrev_b32 v229, 4, v254
    v_lshl_add_u32 v229, v229, 2, v228
    v_lshlrev_b32 v229, 5, v229
    s_lshl_b32 s59, s53, 13
    s_lshl_b32 s23, s25, 9
    s_add_u32 s59, s59, s23
    s_lshl_b32 s23, s52, 2
    s_add_u32 s59, s59, s23
    s_add_u32 s59, s59, 8454144
    s_nop 7
    v_cmp_eq_u32 vcc, 1, v228
    s_nop 1
    v_cndmask_b32 v216, v216, v217, vcc
    v_cndmask_b32 v220, v220, v221, vcc
    v_cmp_eq_u32 vcc, 2, v228
    s_nop 1
    v_cndmask_b32 v216, v216, v218, vcc
    v_cndmask_b32 v220, v220, v222, vcc
    v_cmp_eq_u32 vcc, 3, v228
    s_nop 1
    v_cndmask_b32 v216, v216, v219, vcc
    v_cndmask_b32 v220, v220, v223, vcc
    v_cvt_pk_bf16_f32 v217, v216, v216
    v_lshlrev_b32 v217, 16, v217
    v_sub_f32 v217, v216, v217
    v_cvt_pk_bf16_f32 v216, v216, v217
    v_cvt_pk_bf16_f32 v221, v220, v220
    v_lshlrev_b32 v221, 16, v221
    v_sub_f32 v221, v220, v221
    v_cvt_pk_bf16_f32 v220, v220, v221
    s_mov_b32 exec_lo, 0x000f000f
    s_mov_b32 exec_hi, 0x000f000f
    buffer_store_dword v216, v229, s[44:47], s59 offen offset:0 sc1
    buffer_store_dword v220, v229, s[44:47], s59 offen offset:2048 sc1
    s_mov_b64 exec, -1
    ds_read_b128 v[96:99], v178 offset:0
    s_add_u32 m0, s37, 110592
    s_nop 0
    buffer_load_dwordx4 v186, s[12:15], s17 offen offset:0 lds
    v_mfma_f32_16x16x32_bf16 v[4:7], v[152:155], v[116:119], v[4:7]
    ds_read_b64_tr_b16 v[128:129], v180 offset:0
    v_mfma_f32_16x16x32_bf16 v[8:11], v[152:155], v[120:123], v[8:11]
    ds_read_b64_tr_b16 v[130:131], v180 offset:768
    buffer_load_dwordx4 v187, s[12:15], s17 offen offset:1024 lds
    v_mfma_f32_16x16x32_bf16 v[12:15], v[152:155], v[124:127], v[12:15]
    ds_read_b128 v[100:103], v178 offset:2048
    v_mfma_f32_16x16x32_bf16 v[16:19], v[156:159], v[112:115], v[16:19]
    v_mfma_f32_16x16x32_bf16 v[20:23], v[156:159], v[116:119], v[20:23]
    ds_read_b128 v[104:107], v178 offset:4096
    buffer_load_dwordx4 v188, s[12:15], s17 offen offset:2048 lds
    s_add_u32 s17, s17, 393216
    s_cmp_ge_u32 s17, 6291456
    s_cselect_b32 s17, s55, s17
    v_mfma_f32_16x16x32_bf16 v[24:27], v[156:159], v[120:123], v[24:27]
    ds_read_b128 v[108:111], v178 offset:6144
    v_mfma_f32_16x16x32_bf16 v[28:31], v[156:159], v[124:127], v[28:31]
    ds_read_b64_tr_b16 v[132:133], v181 offset:0
    v_mfma_f32_16x16x32_bf16 v[32:35], v[160:163], v[112:115], v[32:35]
    s_add_u32 m0, s36, 32768
    s_nop 0
    buffer_load_dwordx4 v182, s[8:11], s16 offen offset:0 lds
    v_mfma_f32_16x16x32_bf16 v[36:39], v[160:163], v[116:119], v[36:39]
    ds_read_b64_tr_b16 v[134:135], v181 offset:768
    v_mfma_f32_16x16x32_bf16 v[40:43], v[160:163], v[120:123], v[40:43]
    ds_read_b64_tr_b16 v[136:137], v180 offset:64
    buffer_load_dwordx4 v183, s[8:11], s16 offen offset:1024 lds
    v_mfma_f32_16x16x32_bf16 v[44:47], v[160:163], v[124:127], v[44:47]
    ds_read_b64_tr_b16 v[138:139], v180 offset:832
    v_mfma_f32_16x16x32_bf16 v[48:51], v[164:167], v[112:115], v[48:51]
    v_mfma_f32_16x16x32_bf16 v[52:55], v[164:167], v[116:119], v[52:55]
    ds_read_b64_tr_b16 v[140:141], v181 offset:64
    buffer_load_dwordx4 v184, s[8:11], s16 offen offset:2048 lds
    v_mfma_f32_16x16x32_bf16 v[56:59], v[164:167], v[120:123], v[56:59]
    ds_read_b64_tr_b16 v[142:143], v181 offset:832
    v_mfma_f32_16x16x32_bf16 v[60:63], v[164:167], v[124:127], v[60:63]
    ds_read_b64_tr_b16 v[144:145], v180 offset:128
    v_mfma_f32_16x16x32_bf16 v[64:67], v[168:171], v[112:115], v[64:67]
    buffer_load_dwordx4 v185, s[8:11], s16 offen offset:3072 lds
    s_add_u32 s16, s16, 128
    s_and_b32 s16, s16, 2047
    v_mfma_f32_16x16x32_bf16 v[68:71], v[168:171], v[116:119], v[68:71]
    ds_read_b64_tr_b16 v[146:147], v180 offset:896
    v_mfma_f32_16x16x32_bf16 v[72:75], v[168:171], v[120:123], v[72:75]
    ds_read_b64_tr_b16 v[148:149], v181 offset:128
    s_setprio 0
    v_mfma_f32_16x16x32_bf16 v[76:79], v[168:171], v[124:127], v[76:79]
    s_waitcnt lgkmcnt(14)
    ds_read_b64_tr_b16 v[150:151], v181 offset:896
    v_mfma_f32_16x16x32_bf16 v[80:83], v[172:175], v[112:115], v[80:83]
    v_mfma_f32_16x16x32_bf16 v[84:87], v[172:175], v[116:119], v[84:87]
    v_mfma_f32_16x16x32_bf16 v[88:91], v[172:175], v[120:123], v[88:91]
    v_mfma_f32_16x16x32_bf16 v[92:95], v[172:175], v[124:127], v[92:95]
    s_waitcnt lgkmcnt(13)
    v_mfma_f32_16x16x32_bf16 v[0:3], v[128:131], v[96:99], v[0:3]
    ds_read_b128 v[112:115], v179 offset:0
    s_waitcnt lgkmcnt(13)
    v_mfma_f32_16x16x32_bf16 v[4:7], v[128:131], v[100:103], v[4:7]
    ds_read_b64_tr_b16 v[152:153], v180 offset:6144
    s_waitcnt lgkmcnt(13)
    v_mfma_f32_16x16x32_bf16 v[8:11], v[128:131], v[104:107], v[8:11]
    ds_read_b64_tr_b16 v[154:155], v180 offset:6912
    s_waitcnt lgkmcnt(13)
    v_mfma_f32_16x16x32_bf16 v[12:15], v[128:131], v[108:111], v[12:15]
    ds_read_b128 v[116:119], v179 offset:2048
    s_waitcnt lgkmcnt(12)
    v_mfma_f32_16x16x32_bf16 v[16:19], v[132:135], v[96:99], v[16:19]
    ds_read_b128 v[120:123], v179 offset:4096
    v_mfma_f32_16x16x32_bf16 v[20:23], v[132:135], v[100:103], v[20:23]
    ds_read_b128 v[124:127], v179 offset:6144
    v_mfma_f32_16x16x32_bf16 v[24:27], v[132:135], v[104:107], v[24:27]
    ds_read_b64_tr_b16 v[156:157], v181 offset:6144
    v_mfma_f32_16x16x32_bf16 v[28:31], v[132:135], v[108:111], v[28:31]
    s_waitcnt lgkmcnt(14)
    ds_read_b64_tr_b16 v[158:159], v181 offset:6912
    s_waitcnt lgkmcnt(14)
    v_mfma_f32_16x16x32_bf16 v[32:35], v[136:139], v[96:99], v[32:35]
    ds_read_b64_tr_b16 v[160:161], v180 offset:6208
    v_mfma_f32_16x16x32_bf16 v[36:39], v[136:139], v[100:103], v[36:39]
    s_waitcnt lgkmcnt(14)
    ds_read_b64_tr_b16 v[162:163], v180 offset:6976
    v_mfma_f32_16x16x32_bf16 v[40:43], v[136:139], v[104:107], v[40:43]
    s_waitcnt lgkmcnt(14)
    ds_read_b64_tr_b16 v[164:165], v181 offset:6208
    v_mfma_f32_16x16x32_bf16 v[44:47], v[136:139], v[108:111], v[44:47]
    s_waitcnt lgkmcnt(14)
    ds_read_b64_tr_b16 v[166:167], v181 offset:6976
    v_mfma_f32_16x16x32_bf16 v[48:51], v[140:143], v[96:99], v[48:51]
    s_waitcnt lgkmcnt(14)
    ds_read_b64_tr_b16 v[168:169], v180 offset:6272
    v_mfma_f32_16x16x32_bf16 v[52:55], v[140:143], v[100:103], v[52:55]
    s_waitcnt lgkmcnt(14)
    ds_read_b64_tr_b16 v[170:171], v180 offset:7040
    v_mfma_f32_16x16x32_bf16 v[56:59], v[140:143], v[104:107], v[56:59]
    s_waitcnt lgkmcnt(14)
    ds_read_b64_tr_b16 v[172:173], v181 offset:6272
    v_mfma_f32_16x16x32_bf16 v[60:63], v[140:143], v[108:111], v[60:63]
    s_waitcnt lgkmcnt(14)
    ds_read_b64_tr_b16 v[174:175], v181 offset:7040
    v_mfma_f32_16x16x32_bf16 v[64:67], v[144:147], v[96:99], v[64:67]
    v_mfma_f32_16x16x32_bf16 v[68:71], v[144:147], v[100:103], v[68:71]
    v_mfma_f32_16x16x32_bf16 v[72:75], v[144:147], v[104:107], v[72:75]
    v_mfma_f32_16x16x32_bf16 v[76:79], v[144:147], v[108:111], v[76:79]
    v_mfma_f32_16x16x32_bf16 v[80:83], v[148:151], v[96:99], v[80:83]
    v_mfma_f32_16x16x32_bf16 v[84:87], v[148:151], v[100:103], v[84:87]
    s_waitcnt vmcnt(4) lgkmcnt(0)
    s_barrier
    s_setprio 1
    v_mfma_f32_16x16x32_bf16 v[88:91], v[148:151], v[104:107], v[88:91]
    v_mfma_f32_16x16x32_bf16 v[92:95], v[148:151], v[108:111], v[92:95]
    v_mfma_f32_16x16x32_bf16 v[0:3], v[152:155], v[112:115], v[0:3]
    ds_read_b128 v[96:99], v176 offset:0
    s_add_u32 m0, s37, 98304
    s_nop 0
    buffer_load_dwordx4 v186, s[12:15], s17 offen offset:0 lds
    v_mfma_f32_16x16x32_bf16 v[4:7], v[152:155], v[116:119], v[4:7]
    ds_read_b64_tr_b16 v[128:129], v180 offset:12288
    v_mfma_f32_16x16x32_bf16 v[8:11], v[152:155], v[120:123], v[8:11]
    ds_read_b64_tr_b16 v[130:131], v180 offset:13056
    buffer_load_dwordx4 v187, s[12:15], s17 offen offset:1024 lds
    v_mfma_f32_16x16x32_bf16 v[12:15], v[152:155], v[124:127], v[12:15]
    ds_read_b128 v[100:103], v176 offset:2048
    v_mfma_f32_16x16x32_bf16 v[16:19], v[156:159], v[112:115], v[16:19]
    v_mfma_f32_16x16x32_bf16 v[20:23], v[156:159], v[116:119], v[20:23]
    ds_read_b128 v[104:107], v176 offset:4096
    buffer_load_dwordx4 v188, s[12:15], s17 offen offset:2048 lds
    s_add_u32 s17, s17, 393216
    v_mfma_f32_16x16x32_bf16 v[24:27], v[156:159], v[120:123], v[24:27]
    ds_read_b128 v[108:111], v176 offset:6144
    v_mfma_f32_16x16x32_bf16 v[28:31], v[156:159], v[124:127], v[28:31]
    ds_read_b64_tr_b16 v[132:133], v181 offset:12288
    v_mfma_f32_16x16x32_bf16 v[32:35], v[160:163], v[112:115], v[32:35]
    s_add_u32 m0, s36, 65536
    s_nop 0
    buffer_load_dwordx4 v182, s[8:11], s16 offen offset:0 lds
    v_mfma_f32_16x16x32_bf16 v[36:39], v[160:163], v[116:119], v[36:39]
    ds_read_b64_tr_b16 v[134:135], v181 offset:13056
    v_mfma_f32_16x16x32_bf16 v[40:43], v[160:163], v[120:123], v[40:43]
    ds_read_b64_tr_b16 v[136:137], v180 offset:12352
    buffer_load_dwordx4 v183, s[8:11], s16 offen offset:1024 lds
    v_mfma_f32_16x16x32_bf16 v[44:47], v[160:163], v[124:127], v[44:47]
    ds_read_b64_tr_b16 v[138:139], v180 offset:13120
    v_mfma_f32_16x16x32_bf16 v[48:51], v[164:167], v[112:115], v[48:51]
    v_mfma_f32_16x16x32_bf16 v[52:55], v[164:167], v[116:119], v[52:55]
    ds_read_b64_tr_b16 v[140:141], v181 offset:12352
    buffer_load_dwordx4 v184, s[8:11], s16 offen offset:2048 lds
    v_mfma_f32_16x16x32_bf16 v[56:59], v[164:167], v[120:123], v[56:59]
    ds_read_b64_tr_b16 v[142:143], v181 offset:13120
    v_mfma_f32_16x16x32_bf16 v[60:63], v[164:167], v[124:127], v[60:63]
    ds_read_b64_tr_b16 v[144:145], v180 offset:12416
    v_mfma_f32_16x16x32_bf16 v[64:67], v[168:171], v[112:115], v[64:67]
    buffer_load_dwordx4 v185, s[8:11], s16 offen offset:3072 lds
    s_add_u32 s16, s16, 128
    s_and_b32 s16, s16, 2047
    v_mfma_f32_16x16x32_bf16 v[68:71], v[168:171], v[116:119], v[68:71]
    ds_read_b64_tr_b16 v[146:147], v180 offset:13184
    v_mfma_f32_16x16x32_bf16 v[72:75], v[168:171], v[120:123], v[72:75]
    ds_read_b64_tr_b16 v[148:149], v181 offset:12416
    s_setprio 0
    v_mfma_f32_16x16x32_bf16 v[76:79], v[168:171], v[124:127], v[76:79]
    s_waitcnt lgkmcnt(14)
    ds_read_b64_tr_b16 v[150:151], v181 offset:13184
    v_mfma_f32_16x16x32_bf16 v[80:83], v[172:175], v[112:115], v[80:83]
    v_mfma_f32_16x16x32_bf16 v[84:87], v[172:175], v[116:119], v[84:87]
    v_mfma_f32_16x16x32_bf16 v[88:91], v[172:175], v[120:123], v[88:91]
    v_mfma_f32_16x16x32_bf16 v[92:95], v[172:175], v[124:127], v[92:95]
    s_waitcnt lgkmcnt(13)
    v_mfma_f32_16x16x32_bf16 v[0:3], v[128:131], v[96:99], v[0:3]
    ds_read_b128 v[112:115], v177 offset:0
    s_waitcnt lgkmcnt(13)
    v_mfma_f32_16x16x32_bf16 v[4:7], v[128:131], v[100:103], v[4:7]
    ds_read_b64_tr_b16 v[152:153], v180 offset:18432
    s_waitcnt lgkmcnt(13)
    v_mfma_f32_16x16x32_bf16 v[8:11], v[128:131], v[104:107], v[8:11]
    ds_read_b64_tr_b16 v[154:155], v180 offset:19200
    s_waitcnt lgkmcnt(13)
    v_mfma_f32_16x16x32_bf16 v[12:15], v[128:131], v[108:111], v[12:15]
    ds_read_b128 v[116:119], v177 offset:2048
    s_waitcnt lgkmcnt(12)
    v_mfma_f32_16x16x32_bf16 v[16:19], v[132:135], v[96:99], v[16:19]
    ds_read_b128 v[120:123], v177 offset:4096
    v_mfma_f32_16x16x32_bf16 v[20:23], v[132:135], v[100:103], v[20:23]
    ds_read_b128 v[124:127], v177 offset:6144
    v_mfma_f32_16x16x32_bf16 v[24:27], v[132:135], v[104:107], v[24:27]
    ds_read_b64_tr_b16 v[156:157], v181 offset:18432
    v_mfma_f32_16x16x32_bf16 v[28:31], v[132:135], v[108:111], v[28:31]
    s_waitcnt lgkmcnt(14)
    ds_read_b64_tr_b16 v[158:159], v181 offset:19200
    s_waitcnt lgkmcnt(14)
    v_mfma_f32_16x16x32_bf16 v[32:35], v[136:139], v[96:99], v[32:35]
    ds_read_b64_tr_b16 v[160:161], v180 offset:18496
    v_mfma_f32_16x16x32_bf16 v[36:39], v[136:139], v[100:103], v[36:39]
    s_waitcnt lgkmcnt(14)
    ds_read_b64_tr_b16 v[162:163], v180 offset:19264
    v_mfma_f32_16x16x32_bf16 v[40:43], v[136:139], v[104:107], v[40:43]
    s_waitcnt lgkmcnt(14)
    ds_read_b64_tr_b16 v[164:165], v181 offset:18496
    v_mfma_f32_16x16x32_bf16 v[44:47], v[136:139], v[108:111], v[44:47]
    s_waitcnt lgkmcnt(14)
    ds_read_b64_tr_b16 v[166:167], v181 offset:19264
    v_mfma_f32_16x16x32_bf16 v[48:51], v[140:143], v[96:99], v[48:51]
    s_waitcnt lgkmcnt(14)
    ds_read_b64_tr_b16 v[168:169], v180 offset:18560
    v_mfma_f32_16x16x32_bf16 v[52:55], v[140:143], v[100:103], v[52:55]
    s_waitcnt lgkmcnt(14)
    ds_read_b64_tr_b16 v[170:171], v180 offset:19328
    v_mfma_f32_16x16x32_bf16 v[56:59], v[140:143], v[104:107], v[56:59]
    s_waitcnt lgkmcnt(14)
    ds_read_b64_tr_b16 v[172:173], v181 offset:18560
    v_mfma_f32_16x16x32_bf16 v[60:63], v[140:143], v[108:111], v[60:63]
    s_waitcnt lgkmcnt(14)
    ds_read_b64_tr_b16 v[174:175], v181 offset:19328
    v_mfma_f32_16x16x32_bf16 v[64:67], v[144:147], v[96:99], v[64:67]
    v_mfma_f32_16x16x32_bf16 v[68:71], v[144:147], v[100:103], v[68:71]
    v_mfma_f32_16x16x32_bf16 v[72:75], v[144:147], v[104:107], v[72:75]
    v_mfma_f32_16x16x32_bf16 v[76:79], v[144:147], v[108:111], v[76:79]
    v_mfma_f32_16x16x32_bf16 v[80:83], v[148:151], v[96:99], v[80:83]
    v_mfma_f32_16x16x32_bf16 v[84:87], v[148:151], v[100:103], v[84:87]
    s_waitcnt vmcnt(4) lgkmcnt(0)
    s_barrier
    s_setprio 1
    v_mfma_f32_16x16x32_bf16 v[88:91], v[148:151], v[104:107], v[88:91]
    v_mfma_f32_16x16x32_bf16 v[92:95], v[148:151], v[108:111], v[92:95]
    v_mfma_f32_16x16x32_bf16 v[0:3], v[152:155], v[112:115], v[0:3]
    ds_read_b128 v[96:99], v176 offset:32768
    s_add_u32 m0, s37, 110592
    s_nop 0
    buffer_load_dwordx4 v186, s[12:15], s17 offen offset:0 lds
    v_mfma_f32_16x16x32_bf16 v[4:7], v[152:155], v[116:119], v[4:7]
    ds_read_b64_tr_b16 v[128:129], v180 offset:0
    v_mfma_f32_16x16x32_bf16 v[8:11], v[152:155], v[120:123], v[8:11]
    ds_read_b64_tr_b16 v[130:131], v180 offset:768
    buffer_load_dwordx4 v187, s[12:15], s17 offen offset:1024 lds
    v_mfma_f32_16x16x32_bf16 v[12:15], v[152:155], v[124:127], v[12:15]
    ds_read_b128 v[100:103], v176 offset:34816
    v_mfma_f32_16x16x32_bf16 v[16:19], v[156:159], v[112:115], v[16:19]
    v_mfma_f32_16x16x32_bf16 v[20:23], v[156:159], v[116:119], v[20:23]
    ds_read_b128 v[104:107], v176 offset:36864
    buffer_load_dwordx4 v188, s[12:15], s17 offen offset:2048 lds
    s_add_u32 s17, s17, 393216
    s_cmp_ge_u32 s17, 6291456
    s_cselect_b32 s17, s55, s17
    v_mfma_f32_16x16x32_bf16 v[24:27], v[156:159], v[120:123], v[24:27]
    ds_read_b128 v[108:111], v176 offset:38912
    v_mfma_f32_16x16x32_bf16 v[28:31], v[156:159], v[124:127], v[28:31]
    ds_read_b64_tr_b16 v[132:133], v181 offset:0
    v_mfma_f32_16x16x32_bf16 v[32:35], v[160:163], v[112:115], v[32:35]
    s_add_u32 m0, s36, 0
    s_nop 0
    buffer_load_dwordx4 v182, s[8:11], s16 offen offset:0 lds
    v_mfma_f32_16x16x32_bf16 v[36:39], v[160:163], v[116:119], v[36:39]
    ds_read_b64_tr_b16 v[134:135], v181 offset:768
    v_mfma_f32_16x16x32_bf16 v[40:43], v[160:163], v[120:123], v[40:43]
    ds_read_b64_tr_b16 v[136:137], v180 offset:64
    buffer_load_dwordx4 v183, s[8:11], s16 offen offset:1024 lds
    v_mfma_f32_16x16x32_bf16 v[44:47], v[160:163], v[124:127], v[44:47]
    ds_read_b64_tr_b16 v[138:139], v180 offset:832
    v_mfma_f32_16x16x32_bf16 v[48:51], v[164:167], v[112:115], v[48:51]
    v_mfma_f32_16x16x32_bf16 v[52:55], v[164:167], v[116:119], v[52:55]
    ds_read_b64_tr_b16 v[140:141], v181 offset:64
    buffer_load_dwordx4 v184, s[8:11], s16 offen offset:2048 lds
    v_mfma_f32_16x16x32_bf16 v[56:59], v[164:167], v[120:123], v[56:59]
    ds_read_b64_tr_b16 v[142:143], v181 offset:832
    v_mfma_f32_16x16x32_bf16 v[60:63], v[164:167], v[124:127], v[60:63]
    ds_read_b64_tr_b16 v[144:145], v180 offset:128
    v_mfma_f32_16x16x32_bf16 v[64:67], v[168:171], v[112:115], v[64:67]
    buffer_load_dwordx4 v185, s[8:11], s16 offen offset:3072 lds
    s_add_u32 s16, s16, 128
    s_and_b32 s16, s16, 2047
    v_mfma_f32_16x16x32_bf16 v[68:71], v[168:171], v[116:119], v[68:71]
    ds_read_b64_tr_b16 v[146:147], v180 offset:896
    v_mfma_f32_16x16x32_bf16 v[72:75], v[168:171], v[120:123], v[72:75]
    ds_read_b64_tr_b16 v[148:149], v181 offset:128
    s_setprio 0
    v_mfma_f32_16x16x32_bf16 v[76:79], v[168:171], v[124:127], v[76:79]
    s_waitcnt lgkmcnt(14)
    ds_read_b64_tr_b16 v[150:151], v181 offset:896
    v_mfma_f32_16x16x32_bf16 v[80:83], v[172:175], v[112:115], v[80:83]
    v_mfma_f32_16x16x32_bf16 v[84:87], v[172:175], v[116:119], v[84:87]
    v_mfma_f32_16x16x32_bf16 v[88:91], v[172:175], v[120:123], v[88:91]
    v_mfma_f32_16x16x32_bf16 v[92:95], v[172:175], v[124:127], v[92:95]
    s_waitcnt lgkmcnt(13)
    v_mfma_f32_16x16x32_bf16 v[0:3], v[128:131], v[96:99], v[0:3]
    ds_read_b128 v[112:115], v177 offset:32768
    s_waitcnt lgkmcnt(13)
    v_mfma_f32_16x16x32_bf16 v[4:7], v[128:131], v[100:103], v[4:7]
    ds_read_b64_tr_b16 v[152:153], v180 offset:6144
    s_waitcnt lgkmcnt(13)
    v_mfma_f32_16x16x32_bf16 v[8:11], v[128:131], v[104:107], v[8:11]
    ds_read_b64_tr_b16 v[154:155], v180 offset:6912
    s_waitcnt lgkmcnt(13)
    v_mfma_f32_16x16x32_bf16 v[12:15], v[128:131], v[108:111], v[12:15]
    ds_read_b128 v[116:119], v177 offset:34816
    s_waitcnt lgkmcnt(12)
    v_mfma_f32_16x16x32_bf16 v[16:19], v[132:135], v[96:99], v[16:19]
    ds_read_b128 v[120:123], v177 offset:36864
    v_mfma_f32_16x16x32_bf16 v[20:23], v[132:135], v[100:103], v[20:23]
    ds_read_b128 v[124:127], v177 offset:38912
    v_mfma_f32_16x16x32_bf16 v[24:27], v[132:135], v[104:107], v[24:27]
    ds_read_b64_tr_b16 v[156:157], v181 offset:6144
    v_mfma_f32_16x16x32_bf16 v[28:31], v[132:135], v[108:111], v[28:31]
    s_waitcnt lgkmcnt(14)
    ds_read_b64_tr_b16 v[158:159], v181 offset:6912
    s_waitcnt lgkmcnt(14)
    v_mfma_f32_16x16x32_bf16 v[32:35], v[136:139], v[96:99], v[32:35]
    ds_read_b64_tr_b16 v[160:161], v180 offset:6208
    v_mfma_f32_16x16x32_bf16 v[36:39], v[136:139], v[100:103], v[36:39]
    s_waitcnt lgkmcnt(14)
    ds_read_b64_tr_b16 v[162:163], v180 offset:6976
    v_mfma_f32_16x16x32_bf16 v[40:43], v[136:139], v[104:107], v[40:43]
    s_waitcnt lgkmcnt(14)
    ds_read_b64_tr_b16 v[164:165], v181 offset:6208
    v_mfma_f32_16x16x32_bf16 v[44:47], v[136:139], v[108:111], v[44:47]
    s_waitcnt lgkmcnt(14)
    ds_read_b64_tr_b16 v[166:167], v181 offset:6976
    v_mfma_f32_16x16x32_bf16 v[48:51], v[140:143], v[96:99], v[48:51]
    s_waitcnt lgkmcnt(14)
    ds_read_b64_tr_b16 v[168:169], v180 offset:6272
    v_mfma_f32_16x16x32_bf16 v[52:55], v[140:143], v[100:103], v[52:55]
    s_waitcnt lgkmcnt(14)
    ds_read_b64_tr_b16 v[170:171], v180 offset:7040
    v_mfma_f32_16x16x32_bf16 v[56:59], v[140:143], v[104:107], v[56:59]
    s_waitcnt lgkmcnt(14)
    ds_read_b64_tr_b16 v[172:173], v181 offset:6272
    v_mfma_f32_16x16x32_bf16 v[60:63], v[140:143], v[108:111], v[60:63]
    s_waitcnt lgkmcnt(14)
    ds_read_b64_tr_b16 v[174:175], v181 offset:7040
    v_mfma_f32_16x16x32_bf16 v[64:67], v[144:147], v[96:99], v[64:67]
    v_mfma_f32_16x16x32_bf16 v[68:71], v[144:147], v[100:103], v[68:71]
    v_mfma_f32_16x16x32_bf16 v[72:75], v[144:147], v[104:107], v[72:75]
    v_mfma_f32_16x16x32_bf16 v[76:79], v[144:147], v[108:111], v[76:79]
    v_mfma_f32_16x16x32_bf16 v[80:83], v[148:151], v[96:99], v[80:83]
    v_mfma_f32_16x16x32_bf16 v[84:87], v[148:151], v[100:103], v[84:87]
    s_waitcnt vmcnt(4) lgkmcnt(0)
    s_barrier
    s_setprio 1
    v_mfma_f32_16x16x32_bf16 v[88:91], v[148:151], v[104:107], v[88:91]
    v_mfma_f32_16x16x32_bf16 v[92:95], v[148:151], v[108:111], v[92:95]
    v_mfma_f32_16x16x32_bf16 v[0:3], v[152:155], v[112:115], v[0:3]
    ds_read_b128 v[96:99], v178 offset:0
    s_add_u32 m0, s37, 98304
    s_nop 0
    buffer_load_dwordx4 v186, s[12:15], s17 offen offset:0 lds
    v_mfma_f32_16x16x32_bf16 v[4:7], v[152:155], v[116:119], v[4:7]
    ds_read_b64_tr_b16 v[128:129], v180 offset:12288
    v_mfma_f32_16x16x32_bf16 v[8:11], v[152:155], v[120:123], v[8:11]
    ds_read_b64_tr_b16 v[130:131], v180 offset:13056
    buffer_load_dwordx4 v187, s[12:15], s17 offen offset:1024 lds
    v_mfma_f32_16x16x32_bf16 v[12:15], v[152:155], v[124:127], v[12:15]
    ds_read_b128 v[100:103], v178 offset:2048
    v_mfma_f32_16x16x32_bf16 v[16:19], v[156:159], v[112:115], v[16:19]
    v_mfma_f32_16x16x32_bf16 v[20:23], v[156:159], v[116:119], v[20:23]
    ds_read_b128 v[104:107], v178 offset:4096
    buffer_load_dwordx4 v188, s[12:15], s17 offen offset:2048 lds
    s_add_u32 s17, s17, 393216
    v_mfma_f32_16x16x32_bf16 v[24:27], v[156:159], v[120:123], v[24:27]
    ds_read_b128 v[108:111], v178 offset:6144
    v_mfma_f32_16x16x32_bf16 v[28:31], v[156:159], v[124:127], v[28:31]
    ds_read_b64_tr_b16 v[132:133], v181 offset:12288
    v_mfma_f32_16x16x32_bf16 v[32:35], v[160:163], v[112:115], v[32:35]
    s_add_u32 m0, s36, 32768
    s_nop 0
    buffer_load_dwordx4 v182, s[8:11], s16 offen offset:0 lds
    v_mfma_f32_16x16x32_bf16 v[36:39], v[160:163], v[116:119], v[36:39]
    ds_read_b64_tr_b16 v[134:135], v181 offset:13056
    v_mfma_f32_16x16x32_bf16 v[40:43], v[160:163], v[120:123], v[40:43]
    ds_read_b64_tr_b16 v[136:137], v180 offset:12352
    buffer_load_dwordx4 v183, s[8:11], s16 offen offset:1024 lds
    v_mfma_f32_16x16x32_bf16 v[44:47], v[160:163], v[124:127], v[44:47]
    ds_read_b64_tr_b16 v[138:139], v180 offset:13120
    v_mfma_f32_16x16x32_bf16 v[48:51], v[164:167], v[112:115], v[48:51]
    v_mfma_f32_16x16x32_bf16 v[52:55], v[164:167], v[116:119], v[52:55]
    ds_read_b64_tr_b16 v[140:141], v181 offset:12352
    buffer_load_dwordx4 v184, s[8:11], s16 offen offset:2048 lds
    v_mfma_f32_16x16x32_bf16 v[56:59], v[164:167], v[120:123], v[56:59]
    ds_read_b64_tr_b16 v[142:143], v181 offset:13120
    v_mfma_f32_16x16x32_bf16 v[60:63], v[164:167], v[124:127], v[60:63]
    ds_read_b64_tr_b16 v[144:145], v180 offset:12416
    v_mfma_f32_16x16x32_bf16 v[64:67], v[168:171], v[112:115], v[64:67]
    buffer_load_dwordx4 v185, s[8:11], s16 offen offset:3072 lds
    s_add_u32 s16, s16, 128
    s_and_b32 s16, s16, 2047
    v_mfma_f32_16x16x32_bf16 v[68:71], v[168:171], v[116:119], v[68:71]
    ds_read_b64_tr_b16 v[146:147], v180 offset:13184
    v_mfma_f32_16x16x32_bf16 v[72:75], v[168:171], v[120:123], v[72:75]
    ds_read_b64_tr_b16 v[148:149], v181 offset:12416
    s_cmp_eq_u32 s24, 0
    s_cbranch_scc0 sk_11
    s_lshl_b32 s59, s52, 2
    v_mov_b32 v253, 1
    s_mov_b64 exec, 1
    buffer_atomic_add v253, v252, s[48:51], s59 offen sc1
    s_mov_b64 exec, -1
sk_11:
    s_setprio 0
    v_mfma_f32_16x16x32_bf16 v[76:79], v[168:171], v[124:127], v[76:79]
    s_waitcnt lgkmcnt(14)
    ds_read_b64_tr_b16 v[150:151], v181 offset:13184
    v_mfma_f32_16x16x32_bf16 v[80:83], v[172:175], v[112:115], v[80:83]
    v_mfma_f32_16x16x32_bf16 v[84:87], v[172:175], v[116:119], v[84:87]
    v_mfma_f32_16x16x32_bf16 v[88:91], v[172:175], v[120:123], v[88:91]
    v_mfma_f32_16x16x32_bf16 v[92:95], v[172:175], v[124:127], v[92:95]
    s_waitcnt lgkmcnt(13)
    v_mfma_f32_16x16x32_bf16 v[0:3], v[128:131], v[96:99], v[0:3]
    ds_read_b128 v[112:115], v179 offset:0
    s_waitcnt lgkmcnt(13)
    v_mfma_f32_16x16x32_bf16 v[4:7], v[128:131], v[100:103], v[4:7]
    ds_read_b64_tr_b16 v[152:153], v180 offset:18432
    s_waitcnt lgkmcnt(13)
    v_mfma_f32_16x16x32_bf16 v[8:11], v[128:131], v[104:107], v[8:11]
    ds_read_b64_tr_b16 v[154:155], v180 offset:19200
    s_waitcnt lgkmcnt(13)
    v_mfma_f32_16x16x32_bf16 v[12:15], v[128:131], v[108:111], v[12:15]
    ds_read_b128 v[116:119], v179 offset:2048
    s_waitcnt lgkmcnt(12)
    v_mfma_f32_16x16x32_bf16 v[16:19], v[132:135], v[96:99], v[16:19]
    ds_read_b128 v[120:123], v179 offset:4096
    v_mfma_f32_16x16x32_bf16 v[20:23], v[132:135], v[100:103], v[20:23]
    ds_read_b128 v[124:127], v179 offset:6144
    v_mfma_f32_16x16x32_bf16 v[24:27], v[132:135], v[104:107], v[24:27]
    ds_read_b64_tr_b16 v[156:157], v181 offset:18432
    v_mfma_f32_16x16x32_bf16 v[28:31], v[132:135], v[108:111], v[28:31]
    s_waitcnt lgkmcnt(14)
    ds_read_b64_tr_b16 v[158:159], v181 offset:19200
    s_waitcnt lgkmcnt(14)
    v_mfma_f32_16x16x32_bf16 v[32:35], v[136:139], v[96:99], v[32:35]
    ds_read_b64_tr_b16 v[160:161], v180 offset:18496
    v_mfma_f32_16x16x32_bf16 v[36:39], v[136:139], v[100:103], v[36:39]
    s_waitcnt lgkmcnt(14)
    ds_read_b64_tr_b16 v[162:163], v180 offset:19264
    v_mfma_f32_16x16x32_bf16 v[40:43], v[136:139], v[104:107], v[40:43]
    s_waitcnt lgkmcnt(14)
    ds_read_b64_tr_b16 v[164:165], v181 offset:18496
    v_mfma_f32_16x16x32_bf16 v[44:47], v[136:139], v[108:111], v[44:47]
    s_waitcnt lgkmcnt(14)
    ds_read_b64_tr_b16 v[166:167], v181 offset:19264
    v_mfma_f32_16x16x32_bf16 v[48:51], v[140:143], v[96:99], v[48:51]
    s_waitcnt lgkmcnt(14)
    ds_read_b64_tr_b16 v[168:169], v180 offset:18560
    v_mfma_f32_16x16x32_bf16 v[52:55], v[140:143], v[100:103], v[52:55]
    s_waitcnt lgkmcnt(14)
    ds_read_b64_tr_b16 v[170:171], v180 offset:19328
    v_mfma_f32_16x16x32_bf16 v[56:59], v[140:143], v[104:107], v[56:59]
    s_waitcnt lgkmcnt(14)
    ds_read_b64_tr_b16 v[172:173], v181 offset:18560
    v_mfma_f32_16x16x32_bf16 v[60:63], v[140:143], v[108:111], v[60:63]
    s_waitcnt lgkmcnt(14)
    ds_read_b64_tr_b16 v[174:175], v181 offset:19328
    v_mfma_f32_16x16x32_bf16 v[64:67], v[144:147], v[96:99], v[64:67]
    v_mfma_f32_16x16x32_bf16 v[68:71], v[144:147], v[100:103], v[68:71]
    v_mfma_f32_16x16x32_bf16 v[72:75], v[144:147], v[104:107], v[72:75]
    v_mfma_f32_16x16x32_bf16 v[76:79], v[144:147], v[108:111], v[76:79]
    v_mfma_f32_16x16x32_bf16 v[80:83], v[148:151], v[96:99], v[80:83]
    v_mfma_f32_16x16x32_bf16 v[84:87], v[148:151], v[100:103], v[84:87]
    s_waitcnt vmcnt(4) lgkmcnt(0)
    s_barrier
    s_setprio 1
    v_mfma_f32_16x16x32_bf16 v[88:91], v[148:151], v[104:107], v[88:91]
    v_mfma_f32_16x16x32_bf16 v[92:95], v[148:151], v[108:111], v[92:95]
    v_mfma_f32_16x16x32_bf16 v[0:3], v[152:155], v[112:115], v[0:3]
    ds_read_b128 v[96:99], v176 offset:0
    s_add_u32 m0, s37, 110592
    s_nop 0
    buffer_load_dwordx4 v186, s[12:15], s17 offen offset:0 lds
    v_mfma_f32_16x16x32_bf16 v[4:7], v[152:155], v[116:119], v[4:7]
    ds_read_b64_tr_b16 v[128:129], v180 offset:0
    v_mfma_f32_16x16x32_bf16 v[8:11], v[152:155], v[120:123], v[8:11]
    ds_read_b64_tr_b16 v[130:131], v180 offset:768
    buffer_load_dwordx4 v187, s[12:15], s17 offen offset:1024 lds
    v_mfma_f32_16x16x32_bf16 v[12:15], v[152:155], v[124:127], v[12:15]
    ds_read_b128 v[100:103], v176 offset:2048
    v_mfma_f32_16x16x32_bf16 v[16:19], v[156:159], v[112:115], v[16:19]
    v_mfma_f32_16x16x32_bf16 v[20:23], v[156:159], v[116:119], v[20:23]
    ds_read_b128 v[104:107], v176 offset:4096
    buffer_load_dwordx4 v188, s[12:15], s17 offen offset:2048 lds
    s_add_u32 s17, s17, 393216
    s_cmp_ge_u32 s17, 6291456
    s_cselect_b32 s17, s55, s17
    v_mfma_f32_16x16x32_bf16 v[24:27], v[156:159], v[120:123], v[24:27]
    ds_read_b128 v[108:111], v176 offset:6144
    v_mfma_f32_16x16x32_bf16 v[28:31], v[156:159], v[124:127], v[28:31]
    ds_read_b64_tr_b16 v[132:133], v181 offset:0
    v_mfma_f32_16x16x32_bf16 v[32:35], v[160:163], v[112:115], v[32:35]
    s_add_u32 m0, s36, 65536
    s_nop 0
    buffer_load_dwordx4 v182, s[8:11], s16 offen offset:0 lds
    v_mfma_f32_16x16x32_bf16 v[36:39], v[160:163], v[116:119], v[36:39]
    ds_read_b64_tr_b16 v[134:135], v181 offset:768
    v_mfma_f32_16x16x32_bf16 v[40:43], v[160:163], v[120:123], v[40:43]
    ds_read_b64_tr_b16 v[136:137], v180 offset:64
    buffer_load_dwordx4 v183, s[8:11], s16 offen offset:1024 lds
    v_mfma_f32_16x16x32_bf16 v[44:47], v[160:163], v[124:127], v[44:47]
    ds_read_b64_tr_b16 v[138:139], v180 offset:832
    v_mfma_f32_16x16x32_bf16 v[48:51], v[164:167], v[112:115], v[48:51]
    v_mfma_f32_16x16x32_bf16 v[52:55], v[164:167], v[116:119], v[52:55]
    ds_read_b64_tr_b16 v[140:141], v181 offset:64
    buffer_load_dwordx4 v184, s[8:11], s16 offen offset:2048 lds
    v_mfma_f32_16x16x32_bf16 v[56:59], v[164:167], v[120:123], v[56:59]
    ds_read_b64_tr_b16 v[142:143], v181 offset:832
    v_mfma_f32_16x16x32_bf16 v[60:63], v[164:167], v[124:127], v[60:63]
    ds_read_b64_tr_b16 v[144:145], v180 offset:128
    v_mfma_f32_16x16x32_bf16 v[64:67], v[168:171], v[112:115], v[64:67]
    buffer_load_dwordx4 v185, s[8:11], s16 offen offset:3072 lds
    s_add_u32 s16, s16, 128
    s_and_b32 s16, s16, 2047
    v_mfma_f32_16x16x32_bf16 v[68:71], v[168:171], v[116:119], v[68:71]
    ds_read_b64_tr_b16 v[146:147], v180 offset:896
    v_mfma_f32_16x16x32_bf16 v[72:75], v[168:171], v[120:123], v[72:75]
    ds_read_b64_tr_b16 v[148:149], v181 offset:128
    s_setprio 0
    v_mfma_f32_16x16x32_bf16 v[76:79], v[168:171], v[124:127], v[76:79]
    s_waitcnt lgkmcnt(14)
    ds_read_b64_tr_b16 v[150:151], v181 offset:896
    v_mfma_f32_16x16x32_bf16 v[80:83], v[172:175], v[112:115], v[80:83]
    v_mfma_f32_16x16x32_bf16 v[84:87], v[172:175], v[116:119], v[84:87]
    v_mfma_f32_16x16x32_bf16 v[88:91], v[172:175], v[120:123], v[88:91]
    v_mfma_f32_16x16x32_bf16 v[92:95], v[172:175], v[124:127], v[92:95]
    s_waitcnt lgkmcnt(13)
    v_mfma_f32_16x16x32_bf16 v[0:3], v[128:131], v[96:99], v[0:3]
    ds_read_b128 v[112:115], v177 offset:0
    s_waitcnt lgkmcnt(13)
    v_mfma_f32_16x16x32_bf16 v[4:7], v[128:131], v[100:103], v[4:7]
    ds_read_b64_tr_b16 v[152:153], v180 offset:6144
    s_waitcnt lgkmcnt(13)
    v_mfma_f32_16x16x32_bf16 v[8:11], v[128:131], v[104:107], v[8:11]
    ds_read_b64_tr_b16 v[154:155], v180 offset:6912
    s_waitcnt lgkmcnt(13)
    v_mfma_f32_16x16x32_bf16 v[12:15], v[128:131], v[108:111], v[12:15]
    ds_read_b128 v[116:119], v177 offset:2048
    s_waitcnt lgkmcnt(12)
    v_mfma_f32_16x16x32_bf16 v[16:19], v[132:135], v[96:99], v[16:19]
    ds_read_b128 v[120:123], v177 offset:4096
    v_mfma_f32_16x16x32_bf16 v[20:23], v[132:135], v[100:103], v[20:23]
    ds_read_b128 v[124:127], v177 offset:6144
    v_mfma_f32_16x16x32_bf16 v[24:27], v[132:135], v[104:107], v[24:27]
    ds_read_b64_tr_b16 v[156:157], v181 offset:6144
    v_mfma_f32_16x16x32_bf16 v[28:31], v[132:135], v[108:111], v[28:31]
    s_waitcnt lgkmcnt(14)
    ds_read_b64_tr_b16 v[158:159], v181 offset:6912
    s_waitcnt lgkmcnt(14)
    v_mfma_f32_16x16x32_bf16 v[32:35], v[136:139], v[96:99], v[32:35]
    ds_read_b64_tr_b16 v[160:161], v180 offset:6208
    v_mfma_f32_16x16x32_bf16 v[36:39], v[136:139], v[100:103], v[36:39]
    s_waitcnt lgkmcnt(14)
    ds_read_b64_tr_b16 v[162:163], v180 offset:6976
    v_mfma_f32_16x16x32_bf16 v[40:43], v[136:139], v[104:107], v[40:43]
    s_waitcnt lgkmcnt(14)
    ds_read_b64_tr_b16 v[164:165], v181 offset:6208
    v_mfma_f32_16x16x32_bf16 v[44:47], v[136:139], v[108:111], v[44:47]
    s_waitcnt lgkmcnt(14)
    ds_read_b64_tr_b16 v[166:167], v181 offset:6976
    v_mfma_f32_16x16x32_bf16 v[48:51], v[140:143], v[96:99], v[48:51]
    s_waitcnt lgkmcnt(14)
    ds_read_b64_tr_b16 v[168:169], v180 offset:6272
    v_mfma_f32_16x16x32_bf16 v[52:55], v[140:143], v[100:103], v[52:55]
    s_waitcnt lgkmcnt(14)
    ds_read_b64_tr_b16 v[170:171], v180 offset:7040
    v_mfma_f32_16x16x32_bf16 v[56:59], v[140:143], v[104:107], v[56:59]
    s_waitcnt lgkmcnt(14)
    ds_read_b64_tr_b16 v[172:173], v181 offset:6272
    v_mfma_f32_16x16x32_bf16 v[60:63], v[140:143], v[108:111], v[60:63]
    s_waitcnt lgkmcnt(14)
    ds_read_b64_tr_b16 v[174:175], v181 offset:7040
    v_mfma_f32_16x16x32_bf16 v[64:67], v[144:147], v[96:99], v[64:67]
    v_mfma_f32_16x16x32_bf16 v[68:71], v[144:147], v[100:103], v[68:71]
    v_mfma_f32_16x16x32_bf16 v[72:75], v[144:147], v[104:107], v[72:75]
    v_mfma_f32_16x16x32_bf16 v[76:79], v[144:147], v[108:111], v[76:79]
    v_mfma_f32_16x16x32_bf16 v[80:83], v[148:151], v[96:99], v[80:83]
    v_mfma_f32_16x16x32_bf16 v[84:87], v[148:151], v[100:103], v[84:87]
    s_waitcnt vmcnt(4) lgkmcnt(0)
    s_barrier
    s_setprio 1
    v_mfma_f32_16x16x32_bf16 v[88:91], v[148:151], v[104:107], v[88:91]
    v_mfma_f32_16x16x32_bf16 v[92:95], v[148:151], v[108:111], v[92:95]
    v_mfma_f32_16x16x32_bf16 v[0:3], v[152:155], v[112:115], v[0:3]
    ds_read_b128 v[96:99], v176 offset:32768
    s_add_u32 m0, s37, 98304
    s_nop 0
    buffer_load_dwordx4 v186, s[12:15], s17 offen offset:0 lds
    v_mfma_f32_16x16x32_bf16 v[4:7], v[152:155], v[116:119], v[4:7]
    ds_read_b64_tr_b16 v[128:129], v180 offset:12288
    v_mfma_f32_16x16x32_bf16 v[8:11], v[152:155], v[120:123], v[8:11]
    ds_read_b64_tr_b16 v[130:131], v180 offset:13056
    buffer_load_dwordx4 v187, s[12:15], s17 offen offset:1024 lds
    v_mfma_f32_16x16x32_bf16 v[12:15], v[152:155], v[124:127], v[12:15]
    ds_read_b128 v[100:103], v176 offset:34816
    v_mfma_f32_16x16x32_bf16 v[16:19], v[156:159], v[112:115], v[16:19]
    v_mfma_f32_16x16x32_bf16 v[20:23], v[156:159], v[116:119], v[20:23]
    ds_read_b128 v[104:107], v176 offset:36864
    buffer_load_dwordx4 v188, s[12:15], s17 offen offset:2048 lds
    s_add_u32 s17, s17, 393216
    v_mfma_f32_16x16x32_bf16 v[24:27], v[156:159], v[120:123], v[24:27]
    ds_read_b128 v[108:111], v176 offset:38912
    v_mfma_f32_16x16x32_bf16 v[28:31], v[156:159], v[124:127], v[28:31]
    ds_read_b64_tr_b16 v[132:133], v181 offset:12288
    v_mfma_f32_16x16x32_bf16 v[32:35], v[160:163], v[112:115], v[32:35]
    s_add_u32 m0, s36, 0
    s_nop 0
    buffer_load_dwordx4 v182, s[8:11], s16 offen offset:0 lds
    v_mfma_f32_16x16x32_bf16 v[36:39], v[160:163], v[116:119], v[36:39]
    ds_read_b64_tr_b16 v[134:135], v181 offset:13056
    v_mfma_f32_16x16x32_bf16 v[40:43], v[160:163], v[120:123], v[40:43]
    ds_read_b64_tr_b16 v[136:137], v180 offset:12352
    buffer_load_dwordx4 v183, s[8:11], s16 offen offset:1024 lds
    v_mfma_f32_16x16x32_bf16 v[44:47], v[160:163], v[124:127], v[44:47]
    ds_read_b64_tr_b16 v[138:139], v180 offset:13120
    v_mfma_f32_16x16x32_bf16 v[48:51], v[164:167], v[112:115], v[48:51]
    v_mfma_f32_16x16x32_bf16 v[52:55], v[164:167], v[116:119], v[52:55]
    ds_read_b64_tr_b16 v[140:141], v181 offset:12352
    buffer_load_dwordx4 v184, s[8:11], s16 offen offset:2048 lds
    v_mfma_f32_16x16x32_bf16 v[56:59], v[164:167], v[120:123], v[56:59]
    ds_read_b64_tr_b16 v[142:143], v181 offset:13120
    v_mfma_f32_16x16x32_bf16 v[60:63], v[164:167], v[124:127], v[60:63]
    ds_read_b64_tr_b16 v[144:145], v180 offset:12416
    v_mfma_f32_16x16x32_bf16 v[64:67], v[168:171], v[112:115], v[64:67]
    buffer_load_dwordx4 v185, s[8:11], s16 offen offset:3072 lds
    s_add_u32 s16, s16, 128
    s_and_b32 s16, s16, 2047
    v_mfma_f32_16x16x32_bf16 v[68:71], v[168:171], v[116:119], v[68:71]
    ds_read_b64_tr_b16 v[146:147], v180 offset:13184
    v_mfma_f32_16x16x32_bf16 v[72:75], v[168:171], v[120:123], v[72:75]
    ds_read_b64_tr_b16 v[148:149], v181 offset:12416
    s_setprio 0
    v_mfma_f32_16x16x32_bf16 v[76:79], v[168:171], v[124:127], v[76:79]
    s_waitcnt lgkmcnt(14)
    ds_read_b64_tr_b16 v[150:151], v181 offset:13184
    v_mfma_f32_16x16x32_bf16 v[80:83], v[172:175], v[112:115], v[80:83]
    v_mfma_f32_16x16x32_bf16 v[84:87], v[172:175], v[116:119], v[84:87]
    v_mfma_f32_16x16x32_bf16 v[88:91], v[172:175], v[120:123], v[88:91]
    v_mfma_f32_16x16x32_bf16 v[92:95], v[172:175], v[124:127], v[92:95]
    s_waitcnt lgkmcnt(13)
    v_mfma_f32_16x16x32_bf16 v[0:3], v[128:131], v[96:99], v[0:3]
    ds_read_b128 v[112:115], v177 offset:32768
    s_waitcnt lgkmcnt(13)
    v_mfma_f32_16x16x32_bf16 v[4:7], v[128:131], v[100:103], v[4:7]
    ds_read_b64_tr_b16 v[152:153], v180 offset:18432
    s_waitcnt lgkmcnt(13)
    v_mfma_f32_16x16x32_bf16 v[8:11], v[128:131], v[104:107], v[8:11]
    ds_read_b64_tr_b16 v[154:155], v180 offset:19200
    s_waitcnt lgkmcnt(13)
    v_mfma_f32_16x16x32_bf16 v[12:15], v[128:131], v[108:111], v[12:15]
    ds_read_b128 v[116:119], v177 offset:34816
    s_waitcnt lgkmcnt(12)
    v_mfma_f32_16x16x32_bf16 v[16:19], v[132:135], v[96:99], v[16:19]
    ds_read_b128 v[120:123], v177 offset:36864
    v_mfma_f32_16x16x32_bf16 v[20:23], v[132:135], v[100:103], v[20:23]
    ds_read_b128 v[124:127], v177 offset:38912
    v_mfma_f32_16x16x32_bf16 v[24:27], v[132:135], v[104:107], v[24:27]
    ds_read_b64_tr_b16 v[156:157], v181 offset:18432
    v_mfma_f32_16x16x32_bf16 v[28:31], v[132:135], v[108:111], v[28:31]
    s_waitcnt lgkmcnt(14)
    ds_read_b64_tr_b16 v[158:159], v181 offset:19200
    s_waitcnt lgkmcnt(14)
    v_mfma_f32_16x16x32_bf16 v[32:35], v[136:139], v[96:99], v[32:35]
    ds_read_b64_tr_b16 v[160:161], v180 offset:18496
    v_mfma_f32_16x16x32_bf16 v[36:39], v[136:139], v[100:103], v[36:39]
    s_waitcnt lgkmcnt(14)
    ds_read_b64_tr_b16 v[162:163], v180 offset:19264
    v_mfma_f32_16x16x32_bf16 v[40:43], v[136:139], v[104:107], v[40:43]
    s_waitcnt lgkmcnt(14)
    ds_read_b64_tr_b16 v[164:165], v181 offset:18496
    v_mfma_f32_16x16x32_bf16 v[44:47], v[136:139], v[108:111], v[44:47]
    s_waitcnt lgkmcnt(14)
    ds_read_b64_tr_b16 v[166:167], v181 offset:19264
    v_mfma_f32_16x16x32_bf16 v[48:51], v[140:143], v[96:99], v[48:51]
    s_waitcnt lgkmcnt(14)
    ds_read_b64_tr_b16 v[168:169], v180 offset:18560
    v_mfma_f32_16x16x32_bf16 v[52:55], v[140:143], v[100:103], v[52:55]
    s_waitcnt lgkmcnt(14)
    ds_read_b64_tr_b16 v[170:171], v180 offset:19328
    v_mfma_f32_16x16x32_bf16 v[56:59], v[140:143], v[104:107], v[56:59]
    s_waitcnt lgkmcnt(14)
    ds_read_b64_tr_b16 v[172:173], v181 offset:18560
    v_mfma_f32_16x16x32_bf16 v[60:63], v[140:143], v[108:111], v[60:63]
    s_waitcnt lgkmcnt(14)
    ds_read_b64_tr_b16 v[174:175], v181 offset:19328
    v_mfma_f32_16x16x32_bf16 v[64:67], v[144:147], v[96:99], v[64:67]
    v_mfma_f32_16x16x32_bf16 v[68:71], v[144:147], v[100:103], v[68:71]
    v_mfma_f32_16x16x32_bf16 v[72:75], v[144:147], v[104:107], v[72:75]
    v_mfma_f32_16x16x32_bf16 v[76:79], v[144:147], v[108:111], v[76:79]
    v_mfma_f32_16x16x32_bf16 v[80:83], v[148:151], v[96:99], v[80:83]
    v_mfma_f32_16x16x32_bf16 v[84:87], v[148:151], v[100:103], v[84:87]
    s_waitcnt vmcnt(4) lgkmcnt(0)
    s_barrier
    s_setprio 1
    v_mfma_f32_16x16x32_bf16 v[88:91], v[148:151], v[104:107], v[88:91]
    v_mfma_f32_16x16x32_bf16 v[92:95], v[148:151], v[108:111], v[92:95]
    v_mfma_f32_16x16x32_bf16 v[0:3], v[152:155], v[112:115], v[0:3]
    ds_read_b128 v[96:99], v178 offset:0
    s_add_u32 m0, s37, 110592
    s_nop 0
    buffer_load_dwordx4 v186, s[12:15], s17 offen offset:0 lds
    v_mfma_f32_16x16x32_bf16 v[4:7], v[152:155], v[116:119], v[4:7]
    ds_read_b64_tr_b16 v[128:129], v180 offset:0
    v_mfma_f32_16x16x32_bf16 v[8:11], v[152:155], v[120:123], v[8:11]
    ds_read_b64_tr_b16 v[130:131], v180 offset:768
    buffer_load_dwordx4 v187, s[12:15], s17 offen offset:1024 lds
    v_mfma_f32_16x16x32_bf16 v[12:15], v[152:155], v[124:127], v[12:15]
    ds_read_b128 v[100:103], v178 offset:2048
    v_mfma_f32_16x16x32_bf16 v[16:19], v[156:159], v[112:115], v[16:19]
    v_mfma_f32_16x16x32_bf16 v[20:23], v[156:159], v[116:119], v[20:23]
    ds_read_b128 v[104:107], v178 offset:4096
    buffer_load_dwordx4 v188, s[12:15], s17 offen offset:2048 lds
    s_add_u32 s17, s17, 393216
    s_cmp_ge_u32 s17, 6291456
    s_cselect_b32 s17, s55, s17
    v_mfma_f32_16x16x32_bf16 v[24:27], v[156:159], v[120:123], v[24:27]
    ds_read_b128 v[108:111], v178 offset:6144
    v_mfma_f32_16x16x32_bf16 v[28:31], v[156:159], v[124:127], v[28:31]
    ds_read_b64_tr_b16 v[132:133], v181 offset:0
    v_mfma_f32_16x16x32_bf16 v[32:35], v[160:163], v[112:115], v[32:35]
    s_add_u32 m0, s36, 32768
    s_nop 0
    buffer_load_dwordx4 v182, s[8:11], s16 offen offset:0 lds
    v_mfma_f32_16x16x32_bf16 v[36:39], v[160:163], v[116:119], v[36:39]
    ds_read_b64_tr_b16 v[134:135], v181 offset:768
    v_mfma_f32_16x16x32_bf16 v[40:43], v[160:163], v[120:123], v[40:43]
    ds_read_b64_tr_b16 v[136:137], v180 offset:64
    buffer_load_dwordx4 v183, s[8:11], s16 offen offset:1024 lds
    v_mfma_f32_16x16x32_bf16 v[44:47], v[160:163], v[124:127], v[44:47]
    ds_read_b64_tr_b16 v[138:139], v180 offset:832
    v_mfma_f32_16x16x32_bf16 v[48:51], v[164:167], v[112:115], v[48:51]
    v_mfma_f32_16x16x32_bf16 v[52:55], v[164:167], v[116:119], v[52:55]
    ds_read_b64_tr_b16 v[140:141], v181 offset:64
    buffer_load_dwordx4 v184, s[8:11], s16 offen offset:2048 lds
    v_mfma_f32_16x16x32_bf16 v[56:59], v[164:167], v[120:123], v[56:59]
    ds_read_b64_tr_b16 v[142:143], v181 offset:832
    v_mfma_f32_16x16x32_bf16 v[60:63], v[164:167], v[124:127], v[60:63]
    ds_read_b64_tr_b16 v[144:145], v180 offset:128
    v_mfma_f32_16x16x32_bf16 v[64:67], v[168:171], v[112:115], v[64:67]
    buffer_load_dwordx4 v185, s[8:11], s16 offen offset:3072 lds
    s_add_u32 s16, s16, 128
    s_and_b32 s16, s16, 2047
    v_mfma_f32_16x16x32_bf16 v[68:71], v[168:171], v[116:119], v[68:71]
    ds_read_b64_tr_b16 v[146:147], v180 offset:896
    v_mfma_f32_16x16x32_bf16 v[72:75], v[168:171], v[120:123], v[72:75]
    ds_read_b64_tr_b16 v[148:149], v181 offset:128
    s_lshl_b32 s59, s2, 3
    s_add_u32 s59, s59, s24
    v_lshlrev_b32 v253, 6, v254
    s_mov_b32 s96, s62
    s_mov_b32 s97, s63
    s_mov_b32 s98, 7340032
    s_mov_b32 s99, 0x00020000
    s_mul_i32 s23, s59, 3584
    s_mov_b32 exec_hi, 0x00ffffff
    buffer_load_dword v255, v253, s[96:99], s23 offen
    s_mov_b32 s96, s66
    s_mov_b32 s97, s67
    s_mov_b32 s98, 2097152
    s_mov_b32 s99, 0x00020000
    s_lshl_b32 s23, s59, 10
    s_mov_b64 exec, 0xffff
    buffer_load_dword v255, v253, s[96:99], s23 offen
    s_mov_b64 exec, -1
    s_setprio 0
    v_mfma_f32_16x16x32_bf16 v[76:79], v[168:171], v[124:127], v[76:79]
    s_waitcnt lgkmcnt(14)
    ds_read_b64_tr_b16 v[150:151], v181 offset:896
    v_mfma_f32_16x16x32_bf16 v[80:83], v[172:175], v[112:115], v[80:83]
    v_mfma_f32_16x16x32_bf16 v[84:87], v[172:175], v[116:119], v[84:87]
    v_mfma_f32_16x16x32_bf16 v[88:91], v[172:175], v[120:123], v[88:91]
    v_mfma_f32_16x16x32_bf16 v[92:95], v[172:175], v[124:127], v[92:95]
    s_waitcnt lgkmcnt(13)
    v_mfma_f32_16x16x32_bf16 v[0:3], v[128:131], v[96:99], v[0:3]
    ds_read_b128 v[112:115], v179 offset:0
    s_waitcnt lgkmcnt(13)
    v_mfma_f32_16x16x32_bf16 v[4:7], v[128:131], v[100:103], v[4:7]
    ds_read_b64_tr_b16 v[152:153], v180 offset:6144
    s_waitcnt lgkmcnt(13)
    v_mfma_f32_16x16x32_bf16 v[8:11], v[128:131], v[104:107], v[8:11]
    ds_read_b64_tr_b16 v[154:155], v180 offset:6912
    s_waitcnt lgkmcnt(13)
    v_mfma_f32_16x16x32_bf16 v[12:15], v[128:131], v[108:111], v[12:15]
    ds_read_b128 v[116:119], v179 offset:2048
    s_waitcnt lgkmcnt(12)
    v_mfma_f32_16x16x32_bf16 v[16:19], v[132:135], v[96:99], v[16:19]
    ds_read_b128 v[120:123], v179 offset:4096
    v_mfma_f32_16x16x32_bf16 v[20:23], v[132:135], v[100:103], v[20:23]
    ds_read_b128 v[124:127], v179 offset:6144
    v_mfma_f32_16x16x32_bf16 v[24:27], v[132:135], v[104:107], v[24:27]
    ds_read_b64_tr_b16 v[156:157], v181 offset:6144
    v_mfma_f32_16x16x32_bf16 v[28:31], v[132:135], v[108:111], v[28:31]
    s_waitcnt lgkmcnt(14)
    ds_read_b64_tr_b16 v[158:159], v181 offset:6912
    s_waitcnt lgkmcnt(14)
    v_mfma_f32_16x16x32_bf16 v[32:35], v[136:139], v[96:99], v[32:35]
    ds_read_b64_tr_b16 v[160:161], v180 offset:6208
    v_mfma_f32_16x16x32_bf16 v[36:39], v[136:139], v[100:103], v[36:39]
    s_waitcnt lgkmcnt(14)
    ds_read_b64_tr_b16 v[162:163], v180 offset:6976
    v_mfma_f32_16x16x32_bf16 v[40:43], v[136:139], v[104:107], v[40:43]
    s_waitcnt lgkmcnt(14)
    ds_read_b64_tr_b16 v[164:165], v181 offset:6208
    v_mfma_f32_16x16x32_bf16 v[44:47], v[136:139], v[108:111], v[44:47]
    s_waitcnt lgkmcnt(14)
    ds_read_b64_tr_b16 v[166:167], v181 offset:6976
    v_mfma_f32_16x16x32_bf16 v[48:51], v[140:143], v[96:99], v[48:51]
    s_waitcnt lgkmcnt(14)
    ds_read_b64_tr_b16 v[168:169], v180 offset:6272
    v_mfma_f32_16x16x32_bf16 v[52:55], v[140:143], v[100:103], v[52:55]
    s_waitcnt lgkmcnt(14)
    ds_read_b64_tr_b16 v[170:171], v180 offset:7040
    v_mfma_f32_16x16x32_bf16 v[56:59], v[140:143], v[104:107], v[56:59]
    s_waitcnt lgkmcnt(14)
    ds_read_b64_tr_b16 v[172:173], v181 offset:6272
    v_mfma_f32_16x16x32_bf16 v[60:63], v[140:143], v[108:111], v[60:63]
    s_waitcnt lgkmcnt(14)
    ds_read_b64_tr_b16 v[174:175], v181 offset:7040
    v_mfma_f32_16x16x32_bf16 v[64:67], v[144:147], v[96:99], v[64:67]
    v_mfma_f32_16x16x32_bf16 v[68:71], v[144:147], v[100:103], v[68:71]
    v_mfma_f32_16x16x32_bf16 v[72:75], v[144:147], v[104:107], v[72:75]
    v_mfma_f32_16x16x32_bf16 v[76:79], v[144:147], v[108:111], v[76:79]
    v_mfma_f32_16x16x32_bf16 v[80:83], v[148:151], v[96:99], v[80:83]
    v_mfma_f32_16x16x32_bf16 v[84:87], v[148:151], v[100:103], v[84:87]
    s_waitcnt vmcnt(6) lgkmcnt(0)
    s_barrier
    s_setprio 1
    v_mfma_f32_16x16x32_bf16 v[88:91], v[148:151], v[104:107], v[88:91]
    v_mfma_f32_16x16x32_bf16 v[92:95], v[148:151], v[108:111], v[92:95]
    v_mfma_f32_16x16x32_bf16 v[0:3], v[152:155], v[112:115], v[0:3]
    ds_read_b128 v[96:99], v176 offset:0
    s_add_u32 m0, s37, 98304
    s_nop 0
    buffer_load_dwordx4 v186, s[12:15], s17 offen offset:0 lds
    v_mfma_f32_16x16x32_bf16 v[4:7], v[152:155], v[116:119], v[4:7]
    ds_read_b64_tr_b16 v[128:129], v180 offset:12288
    v_mfma_f32_16x16x32_bf16 v[8:11], v[152:155], v[120:123], v[8:11]
    ds_read_b64_tr_b16 v[130:131], v180 offset:13056
    buffer_load_dwordx4 v187, s[12:15], s17 offen offset:1024 lds
    v_mfma_f32_16x16x32_bf16 v[12:15], v[152:155], v[124:127], v[12:15]
    ds_read_b128 v[100:103], v176 offset:2048
    v_mfma_f32_16x16x32_bf16 v[16:19], v[156:159], v[112:115], v[16:19]
    v_mfma_f32_16x16x32_bf16 v[20:23], v[156:159], v[116:119], v[20:23]
    ds_read_b128 v[104:107], v176 offset:4096
    buffer_load_dwordx4 v188, s[12:15], s17 offen offset:2048 lds
    s_add_u32 s17, s17, 393216
    v_mfma_f32_16x16x32_bf16 v[24:27], v[156:159], v[120:123], v[24:27]
    ds_read_b128 v[108:111], v176 offset:6144
    v_mfma_f32_16x16x32_bf16 v[28:31], v[156:159], v[124:127], v[28:31]
    ds_read_b64_tr_b16 v[132:133], v181 offset:12288
    v_mfma_f32_16x16x32_bf16 v[32:35], v[160:163], v[112:115], v[32:35]
    s_add_u32 m0, s36, 65536
    s_nop 0
    buffer_load_dwordx4 v182, s[8:11], s16 offen offset:0 lds
    v_mfma_f32_16x16x32_bf16 v[36:39], v[160:163], v[116:119], v[36:39]
    ds_read_b64_tr_b16 v[134:135], v181 offset:13056
    v_mfma_f32_16x16x32_bf16 v[40:43], v[160:163], v[120:123], v[40:43]
    ds_read_b64_tr_b16 v[136:137], v180 offset:12352
    buffer_load_dwordx4 v183, s[8:11], s16 offen offset:1024 lds
    v_mfma_f32_16x16x32_bf16 v[44:47], v[160:163], v[124:127], v[44:47]
    ds_read_b64_tr_b16 v[138:139], v180 offset:13120
    v_mfma_f32_16x16x32_bf16 v[48:51], v[164:167], v[112:115], v[48:51]
    v_mfma_f32_16x16x32_bf16 v[52:55], v[164:167], v[116:119], v[52:55]
    ds_read_b64_tr_b16 v[140:141], v181 offset:12352
    buffer_load_dwordx4 v184, s[8:11], s16 offen offset:2048 lds
    v_mfma_f32_16x16x32_bf16 v[56:59], v[164:167], v[120:123], v[56:59]
    ds_read_b64_tr_b16 v[142:143], v181 offset:13120
    v_mfma_f32_16x16x32_bf16 v[60:63], v[164:167], v[124:127], v[60:63]
    ds_read_b64_tr_b16 v[144:145], v180 offset:12416
    v_mfma_f32_16x16x32_bf16 v[64:67], v[168:171], v[112:115], v[64:67]
    buffer_load_dwordx4 v185, s[8:11], s16 offen offset:3072 lds
    s_add_u32 s16, s16, 128
    s_and_b32 s16, s16, 2047
    v_mfma_f32_16x16x32_bf16 v[68:71], v[168:171], v[116:119], v[68:71]
    ds_read_b64_tr_b16 v[146:147], v180 offset:13184
    v_mfma_f32_16x16x32_bf16 v[72:75], v[168:171], v[120:123], v[72:75]
    ds_read_b64_tr_b16 v[148:149], v181 offset:12416
    s_setprio 0
    v_mfma_f32_16x16x32_bf16 v[76:79], v[168:171], v[124:127], v[76:79]
    s_waitcnt lgkmcnt(14)
    ds_read_b64_tr_b16 v[150:151], v181 offset:13184
    v_mfma_f32_16x16x32_bf16 v[80:83], v[172:175], v[112:115], v[80:83]
    v_mfma_f32_16x16x32_bf16 v[84:87], v[172:175], v[116:119], v[84:87]
    v_mfma_f32_16x16x32_bf16 v[88:91], v[172:175], v[120:123], v[88:91]
    v_mfma_f32_16x16x32_bf16 v[92:95], v[172:175], v[124:127], v[92:95]
    s_waitcnt lgkmcnt(13)
    v_mfma_f32_16x16x32_bf16 v[0:3], v[128:131], v[96:99], v[0:3]
    ds_read_b128 v[112:115], v177 offset:0
    s_waitcnt lgkmcnt(13)
    v_mfma_f32_16x16x32_bf16 v[4:7], v[128:131], v[100:103], v[4:7]
    ds_read_b64_tr_b16 v[152:153], v180 offset:18432
    s_waitcnt lgkmcnt(13)
    v_mfma_f32_16x16x32_bf16 v[8:11], v[128:131], v[104:107], v[8:11]
    ds_read_b64_tr_b16 v[154:155], v180 offset:19200
    s_waitcnt lgkmcnt(13)
    v_mfma_f32_16x16x32_bf16 v[12:15], v[128:131], v[108:111], v[12:15]
    ds_read_b128 v[116:119], v177 offset:2048
    s_waitcnt lgkmcnt(12)
    v_mfma_f32_16x16x32_bf16 v[16:19], v[132:135], v[96:99], v[16:19]
    ds_read_b128 v[120:123], v177 offset:4096
    v_mfma_f32_16x16x32_bf16 v[20:23], v[132:135], v[100:103], v[20:23]
    ds_read_b128 v[124:127], v177 offset:6144
    v_mfma_f32_16x16x32_bf16 v[24:27], v[132:135], v[104:107], v[24:27]
    ds_read_b64_tr_b16 v[156:157], v181 offset:18432
    v_mfma_f32_16x16x32_bf16 v[28:31], v[132:135], v[108:111], v[28:31]
    s_waitcnt lgkmcnt(14)
    ds_read_b64_tr_b16 v[158:159], v181 offset:19200
    s_waitcnt lgkmcnt(14)
    v_mfma_f32_16x16x32_bf16 v[32:35], v[136:139], v[96:99], v[32:35]
    ds_read_b64_tr_b16 v[160:161], v180 offset:18496
    v_mfma_f32_16x16x32_bf16 v[36:39], v[136:139], v[100:103], v[36:39]
    s_waitcnt lgkmcnt(14)
    ds_read_b64_tr_b16 v[162:163], v180 offset:19264
    v_mfma_f32_16x16x32_bf16 v[40:43], v[136:139], v[104:107], v[40:43]
    s_waitcnt lgkmcnt(14)
    ds_read_b64_tr_b16 v[164:165], v181 offset:18496
    v_mfma_f32_16x16x32_bf16 v[44:47], v[136:139], v[108:111], v[44:47]
    s_waitcnt lgkmcnt(14)
    ds_read_b64_tr_b16 v[166:167], v181 offset:19264
    v_mfma_f32_16x16x32_bf16 v[48:51], v[140:143], v[96:99], v[48:51]
    s_waitcnt lgkmcnt(14)
    ds_read_b64_tr_b16 v[168:169], v180 offset:18560
    v_mfma_f32_16x16x32_bf16 v[52:55], v[140:143], v[100:103], v[52:55]
    s_waitcnt lgkmcnt(14)
    ds_read_b64_tr_b16 v[170:171], v180 offset:19328
    v_mfma_f32_16x16x32_bf16 v[56:59], v[140:143], v[104:107], v[56:59]
    s_waitcnt lgkmcnt(14)
    ds_read_b64_tr_b16 v[172:173], v181 offset:18560
    v_mfma_f32_16x16x32_bf16 v[60:63], v[140:143], v[108:111], v[60:63]
    s_waitcnt lgkmcnt(14)
    ds_read_b64_tr_b16 v[174:175], v181 offset:19328
    v_mfma_f32_16x16x32_bf16 v[64:67], v[144:147], v[96:99], v[64:67]
    v_mfma_f32_16x16x32_bf16 v[68:71], v[144:147], v[100:103], v[68:71]
    v_mfma_f32_16x16x32_bf16 v[72:75], v[144:147], v[104:107], v[72:75]
    v_mfma_f32_16x16x32_bf16 v[76:79], v[144:147], v[108:111], v[76:79]
    v_mfma_f32_16x16x32_bf16 v[80:83], v[148:151], v[96:99], v[80:83]
    v_mfma_f32_16x16x32_bf16 v[84:87], v[148:151], v[100:103], v[84:87]
    s_waitcnt vmcnt(4) lgkmcnt(0)
    s_barrier
    s_setprio 1
    v_mfma_f32_16x16x32_bf16 v[88:91], v[148:151], v[104:107], v[88:91]
    v_mfma_f32_16x16x32_bf16 v[92:95], v[148:151], v[108:111], v[92:95]
    v_mfma_f32_16x16x32_bf16 v[0:3], v[152:155], v[112:115], v[0:3]
    ds_read_b128 v[96:99], v176 offset:32768
    s_add_u32 m0, s37, 110592
    s_nop 0
    buffer_load_dwordx4 v186, s[12:15], s17 offen offset:0 lds
    v_mfma_f32_16x16x32_bf16 v[4:7], v[152:155], v[116:119], v[4:7]
    ds_read_b64_tr_b16 v[128:129], v180 offset:0
    v_mfma_f32_16x16x32_bf16 v[8:11], v[152:155], v[120:123], v[8:11]
    ds_read_b64_tr_b16 v[130:131], v180 offset:768
    buffer_load_dwordx4 v187, s[12:15], s17 offen offset:1024 lds
    v_mfma_f32_16x16x32_bf16 v[12:15], v[152:155], v[124:127], v[12:15]
    ds_read_b128 v[100:103], v176 offset:34816
    v_mfma_f32_16x16x32_bf16 v[16:19], v[156:159], v[112:115], v[16:19]
    v_mfma_f32_16x16x32_bf16 v[20:23], v[156:159], v[116:119], v[20:23]
    ds_read_b128 v[104:107], v176 offset:36864
    buffer_load_dwordx4 v188, s[12:15], s17 offen offset:2048 lds
    s_add_u32 s17, s17, 393216
    s_cmp_ge_u32 s17, 6291456
    s_cselect_b32 s17, s55, s17
    v_mfma_f32_16x16x32_bf16 v[24:27], v[156:159], v[120:123], v[24:27]
    ds_read_b128 v[108:111], v176 offset:38912
    v_mfma_f32_16x16x32_bf16 v[28:31], v[156:159], v[124:127], v[28:31]
    ds_read_b64_tr_b16 v[132:133], v181 offset:0
    v_mfma_f32_16x16x32_bf16 v[32:35], v[160:163], v[112:115], v[32:35]
    s_add_u32 m0, s36, 0
    s_nop 0
    buffer_load_dwordx4 v182, s[8:11], s16 offen offset:0 lds
    v_mfma_f32_16x16x32_bf16 v[36:39], v[160:163], v[116:119], v[36:39]
    ds_read_b64_tr_b16 v[134:135], v181 offset:768
    v_mfma_f32_16x16x32_bf16 v[40:43], v[160:163], v[120:123], v[40:43]
    ds_read_b64_tr_b16 v[136:137], v180 offset:64
    buffer_load_dwordx4 v183, s[8:11], s16 offen offset:1024 lds
    v_mfma_f32_16x16x32_bf16 v[44:47], v[160:163], v[124:127], v[44:47]
    ds_read_b64_tr_b16 v[138:139], v180 offset:832
    v_mfma_f32_16x16x32_bf16 v[48:51], v[164:167], v[112:115], v[48:51]
    v_mfma_f32_16x16x32_bf16 v[52:55], v[164:167], v[116:119], v[52:55]
    ds_read_b64_tr_b16 v[140:141], v181 offset:64
    buffer_load_dwordx4 v184, s[8:11], s16 offen offset:2048 lds
    v_mfma_f32_16x16x32_bf16 v[56:59], v[164:167], v[120:123], v[56:59]
    ds_read_b64_tr_b16 v[142:143], v181 offset:832
    v_mfma_f32_16x16x32_bf16 v[60:63], v[164:167], v[124:127], v[60:63]
    ds_read_b64_tr_b16 v[144:145], v180 offset:128
    v_mfma_f32_16x16x32_bf16 v[64:67], v[168:171], v[112:115], v[64:67]
    buffer_load_dwordx4 v185, s[8:11], s16 offen offset:3072 lds
    s_add_u32 s16, s16, 128
    s_and_b32 s16, s16, 2047
    v_mfma_f32_16x16x32_bf16 v[68:71], v[168:171], v[116:119], v[68:71]
    ds_read_b64_tr_b16 v[146:147], v180 offset:896
    v_mfma_f32_16x16x32_bf16 v[72:75], v[168:171], v[120:123], v[72:75]
    ds_read_b64_tr_b16 v[148:149], v181 offset:128
    s_setprio 0
    v_mfma_f32_16x16x32_bf16 v[76:79], v[168:171], v[124:127], v[76:79]
    s_waitcnt lgkmcnt(14)
    ds_read_b64_tr_b16 v[150:151], v181 offset:896
    v_mfma_f32_16x16x32_bf16 v[80:83], v[172:175], v[112:115], v[80:83]
    v_mfma_f32_16x16x32_bf16 v[84:87], v[172:175], v[116:119], v[84:87]
    v_mfma_f32_16x16x32_bf16 v[88:91], v[172:175], v[120:123], v[88:91]
    v_mfma_f32_16x16x32_bf16 v[92:95], v[172:175], v[124:127], v[92:95]
    s_waitcnt lgkmcnt(13)
    v_mfma_f32_16x16x32_bf16 v[0:3], v[128:131], v[96:99], v[0:3]
    ds_read_b128 v[112:115], v177 offset:32768
    s_waitcnt lgkmcnt(13)
    v_mfma_f32_16x16x32_bf16 v[4:7], v[128:131], v[100:103], v[4:7]
    ds_read_b64_tr_b16 v[152:153], v180 offset:6144
    s_waitcnt lgkmcnt(13)
    v_mfma_f32_16x16x32_bf16 v[8:11], v[128:131], v[104:107], v[8:11]
    ds_read_b64_tr_b16 v[154:155], v180 offset:6912
    s_waitcnt lgkmcnt(13)
    v_mfma_f32_16x16x32_bf16 v[12:15], v[128:131], v[108:111], v[12:15]
    ds_read_b128 v[116:119], v177 offset:34816
    s_waitcnt lgkmcnt(12)
    v_mfma_f32_16x16x32_bf16 v[16:19], v[132:135], v[96:99], v[16:19]
    ds_read_b128 v[120:123], v177 offset:36864
    v_mfma_f32_16x16x32_bf16 v[20:23], v[132:135], v[100:103], v[20:23]
    ds_read_b128 v[124:127], v177 offset:38912
    v_mfma_f32_16x16x32_bf16 v[24:27], v[132:135], v[104:107], v[24:27]
    ds_read_b64_tr_b16 v[156:157], v181 offset:6144
    v_mfma_f32_16x16x32_bf16 v[28:31], v[132:135], v[108:111], v[28:31]
    s_waitcnt lgkmcnt(14)
    ds_read_b64_tr_b16 v[158:159], v181 offset:6912
    s_waitcnt lgkmcnt(14)
    v_mfma_f32_16x16x32_bf16 v[32:35], v[136:139], v[96:99], v[32:35]
    ds_read_b64_tr_b16 v[160:161], v180 offset:6208
    v_mfma_f32_16x16x32_bf16 v[36:39], v[136:139], v[100:103], v[36:39]
    s_waitcnt lgkmcnt(14)
    ds_read_b64_tr_b16 v[162:163], v180 offset:6976
    v_mfma_f32_16x16x32_bf16 v[40:43], v[136:139], v[104:107], v[40:43]
    s_waitcnt lgkmcnt(14)
    ds_read_b64_tr_b16 v[164:165], v181 offset:6208
    v_mfma_f32_16x16x32_bf16 v[44:47], v[136:139], v[108:111], v[44:47]
    s_waitcnt lgkmcnt(14)
    ds_read_b64_tr_b16 v[166:167], v181 offset:6976
    v_mfma_f32_16x16x32_bf16 v[48:51], v[140:143], v[96:99], v[48:51]
    s_waitcnt lgkmcnt(14)
    ds_read_b64_tr_b16 v[168:169], v180 offset:6272
    v_mfma_f32_16x16x32_bf16 v[52:55], v[140:143], v[100:103], v[52:55]
    s_waitcnt lgkmcnt(14)
    ds_read_b64_tr_b16 v[170:171], v180 offset:7040
    v_mfma_f32_16x16x32_bf16 v[56:59], v[140:143], v[104:107], v[56:59]
    s_waitcnt lgkmcnt(14)
    ds_read_b64_tr_b16 v[172:173], v181 offset:6272
    v_mfma_f32_16x16x32_bf16 v[60:63], v[140:143], v[108:111], v[60:63]
    s_waitcnt lgkmcnt(14)
    ds_read_b64_tr_b16 v[174:175], v181 offset:7040
    v_mfma_f32_16x16x32_bf16 v[64:67], v[144:147], v[96:99], v[64:67]
    v_mfma_f32_16x16x32_bf16 v[68:71], v[144:147], v[100:103], v[68:71]
    v_mfma_f32_16x16x32_bf16 v[72:75], v[144:147], v[104:107], v[72:75]
    v_mfma_f32_16x16x32_bf16 v[76:79], v[144:147], v[108:111], v[76:79]
    v_mfma_f32_16x16x32_bf16 v[80:83], v[148:151], v[96:99], v[80:83]
    v_mfma_f32_16x16x32_bf16 v[84:87], v[148:151], v[100:103], v[84:87]
    s_waitcnt vmcnt(4) lgkmcnt(0)
    s_barrier
    s_setprio 1
    v_mfma_f32_16x16x32_bf16 v[88:91], v[148:151], v[104:107], v[88:91]
    v_mfma_f32_16x16x32_bf16 v[92:95], v[148:151], v[108:111], v[92:95]
    v_mfma_f32_16x16x32_bf16 v[0:3], v[152:155], v[112:115], v[0:3]
    ds_read_b128 v[96:99], v178 offset:0
    s_add_u32 m0, s37, 98304
    s_nop 0
    buffer_load_dwordx4 v186, s[12:15], s17 offen offset:0 lds
    v_mfma_f32_16x16x32_bf16 v[4:7], v[152:155], v[116:119], v[4:7]
    ds_read_b64_tr_b16 v[128:129], v180 offset:12288
    v_mfma_f32_16x16x32_bf16 v[8:11], v[152:155], v[120:123], v[8:11]
    ds_read_b64_tr_b16 v[130:131], v180 offset:13056
    buffer_load_dwordx4 v187, s[12:15], s17 offen offset:1024 lds
    v_mfma_f32_16x16x32_bf16 v[12:15], v[152:155], v[124:127], v[12:15]
    ds_read_b128 v[100:103], v178 offset:2048
    v_mfma_f32_16x16x32_bf16 v[16:19], v[156:159], v[112:115], v[16:19]
    v_mfma_f32_16x16x32_bf16 v[20:23], v[156:159], v[116:119], v[20:23]
    ds_read_b128 v[104:107], v178 offset:4096
    buffer_load_dwordx4 v188, s[12:15], s17 offen offset:2048 lds
    s_add_u32 s17, s17, 393216
    v_mfma_f32_16x16x32_bf16 v[24:27], v[156:159], v[120:123], v[24:27]
    ds_read_b128 v[108:111], v178 offset:6144
    v_mfma_f32_16x16x32_bf16 v[28:31], v[156:159], v[124:127], v[28:31]
    ds_read_b64_tr_b16 v[132:133], v181 offset:12288
    v_mfma_f32_16x16x32_bf16 v[32:35], v[160:163], v[112:115], v[32:35]
    s_add_u32 m0, s36, 32768
    s_nop 0
    buffer_load_dwordx4 v182, s[8:11], s16 offen offset:0 lds
    v_mfma_f32_16x16x32_bf16 v[36:39], v[160:163], v[116:119], v[36:39]
    ds_read_b64_tr_b16 v[134:135], v181 offset:13056
    v_mfma_f32_16x16x32_bf16 v[40:43], v[160:163], v[120:123], v[40:43]
    ds_read_b64_tr_b16 v[136:137], v180 offset:12352
    buffer_load_dwordx4 v183, s[8:11], s16 offen offset:1024 lds
    v_mfma_f32_16x16x32_bf16 v[44:47], v[160:163], v[124:127], v[44:47]
    ds_read_b64_tr_b16 v[138:139], v180 offset:13120
    v_mfma_f32_16x16x32_bf16 v[48:51], v[164:167], v[112:115], v[48:51]
    v_mfma_f32_16x16x32_bf16 v[52:55], v[164:167], v[116:119], v[52:55]
    ds_read_b64_tr_b16 v[140:141], v181 offset:12352
    buffer_load_dwordx4 v184, s[8:11], s16 offen offset:2048 lds
    v_mfma_f32_16x16x32_bf16 v[56:59], v[164:167], v[120:123], v[56:59]
    ds_read_b64_tr_b16 v[142:143], v181 offset:13120
    v_mfma_f32_16x16x32_bf16 v[60:63], v[164:167], v[124:127], v[60:63]
    ds_read_b64_tr_b16 v[144:145], v180 offset:12416
    v_mfma_f32_16x16x32_bf16 v[64:67], v[168:171], v[112:115], v[64:67]
    buffer_load_dwordx4 v185, s[8:11], s16 offen offset:3072 lds
    s_add_u32 s16, s16, 128
    s_and_b32 s16, s16, 2047
    v_mfma_f32_16x16x32_bf16 v[68:71], v[168:171], v[116:119], v[68:71]
    ds_read_b64_tr_b16 v[146:147], v180 offset:13184
    v_mfma_f32_16x16x32_bf16 v[72:75], v[168:171], v[120:123], v[72:75]
    ds_read_b64_tr_b16 v[148:149], v181 offset:12416
    s_setprio 0
    v_mfma_f32_16x16x32_bf16 v[76:79], v[168:171], v[124:127], v[76:79]
    s_waitcnt lgkmcnt(14)
    ds_read_b64_tr_b16 v[150:151], v181 offset:13184
    v_mfma_f32_16x16x32_bf16 v[80:83], v[172:175], v[112:115], v[80:83]
    v_mfma_f32_16x16x32_bf16 v[84:87], v[172:175], v[116:119], v[84:87]
    v_mfma_f32_16x16x32_bf16 v[88:91], v[172:175], v[120:123], v[88:91]
    v_mfma_f32_16x16x32_bf16 v[92:95], v[172:175], v[124:127], v[92:95]
    s_waitcnt lgkmcnt(13)
    v_mfma_f32_16x16x32_bf16 v[0:3], v[128:131], v[96:99], v[0:3]
    ds_read_b128 v[112:115], v179 offset:0
    s_waitcnt lgkmcnt(13)
    v_mfma_f32_16x16x32_bf16 v[4:7], v[128:131], v[100:103], v[4:7]
    ds_read_b64_tr_b16 v[152:153], v180 offset:18432
    s_waitcnt lgkmcnt(13)
    v_mfma_f32_16x16x32_bf16 v[8:11], v[128:131], v[104:107], v[8:11]
    ds_read_b64_tr_b16 v[154:155], v180 offset:19200
    s_waitcnt lgkmcnt(13)
    v_mfma_f32_16x16x32_bf16 v[12:15], v[128:131], v[108:111], v[12:15]
    ds_read_b128 v[116:119], v179 offset:2048
    s_waitcnt lgkmcnt(12)
    v_mfma_f32_16x16x32_bf16 v[16:19], v[132:135], v[96:99], v[16:19]
    ds_read_b128 v[120:123], v179 offset:4096
    v_mfma_f32_16x16x32_bf16 v[20:23], v[132:135], v[100:103], v[20:23]
    ds_read_b128 v[124:127], v179 offset:6144
    v_mfma_f32_16x16x32_bf16 v[24:27], v[132:135], v[104:107], v[24:27]
    ds_read_b64_tr_b16 v[156:157], v181 offset:18432
    v_mfma_f32_16x16x32_bf16 v[28:31], v[132:135], v[108:111], v[28:31]
    s_waitcnt lgkmcnt(14)
    ds_read_b64_tr_b16 v[158:159], v181 offset:19200
    s_waitcnt lgkmcnt(14)
    v_mfma_f32_16x16x32_bf16 v[32:35], v[136:139], v[96:99], v[32:35]
    ds_read_b64_tr_b16 v[160:161], v180 offset:18496
    v_mfma_f32_16x16x32_bf16 v[36:39], v[136:139], v[100:103], v[36:39]
    s_waitcnt lgkmcnt(14)
    ds_read_b64_tr_b16 v[162:163], v180 offset:19264
    v_mfma_f32_16x16x32_bf16 v[40:43], v[136:139], v[104:107], v[40:43]
    s_waitcnt lgkmcnt(14)
    ds_read_b64_tr_b16 v[164:165], v181 offset:18496
    v_mfma_f32_16x16x32_bf16 v[44:47], v[136:139], v[108:111], v[44:47]
    s_waitcnt lgkmcnt(14)
    ds_read_b64_tr_b16 v[166:167], v181 offset:19264
    v_mfma_f32_16x16x32_bf16 v[48:51], v[140:143], v[96:99], v[48:51]
    s_waitcnt lgkmcnt(14)
    ds_read_b64_tr_b16 v[168:169], v180 offset:18560
    v_mfma_f32_16x16x32_bf16 v[52:55], v[140:143], v[100:103], v[52:55]
    s_waitcnt lgkmcnt(14)
    ds_read_b64_tr_b16 v[170:171], v180 offset:19328
    v_mfma_f32_16x16x32_bf16 v[56:59], v[140:143], v[104:107], v[56:59]
    s_waitcnt lgkmcnt(14)
    ds_read_b64_tr_b16 v[172:173], v181 offset:18560
    v_mfma_f32_16x16x32_bf16 v[60:63], v[140:143], v[108:111], v[60:63]
    s_waitcnt lgkmcnt(14)
    ds_read_b64_tr_b16 v[174:175], v181 offset:19328
    v_mfma_f32_16x16x32_bf16 v[64:67], v[144:147], v[96:99], v[64:67]
    v_mfma_f32_16x16x32_bf16 v[68:71], v[144:147], v[100:103], v[68:71]
    v_mfma_f32_16x16x32_bf16 v[72:75], v[144:147], v[104:107], v[72:75]
    v_mfma_f32_16x16x32_bf16 v[76:79], v[144:147], v[108:111], v[76:79]
    v_mfma_f32_16x16x32_bf16 v[80:83], v[148:151], v[96:99], v[80:83]
    v_mfma_f32_16x16x32_bf16 v[84:87], v[148:151], v[100:103], v[84:87]
    s_waitcnt vmcnt(4) lgkmcnt(0)
    s_barrier
    s_setprio 1
    v_mfma_f32_16x16x32_bf16 v[88:91], v[148:151], v[104:107], v[88:91]
    v_mfma_f32_16x16x32_bf16 v[92:95], v[148:151], v[108:111], v[92:95]
    v_mfma_f32_16x16x32_bf16 v[0:3], v[152:155], v[112:115], v[0:3]
    ds_read_b128 v[96:99], v176 offset:0
    s_add_u32 m0, s37, 110592
    s_nop 0
    buffer_load_dwordx4 v186, s[12:15], s17 offen offset:0 lds
    v_mfma_f32_16x16x32_bf16 v[4:7], v[152:155], v[116:119], v[4:7]
    ds_read_b64_tr_b16 v[128:129], v180 offset:0
    v_mfma_f32_16x16x32_bf16 v[8:11], v[152:155], v[120:123], v[8:11]
    ds_read_b64_tr_b16 v[130:131], v180 offset:768
    buffer_load_dwordx4 v187, s[12:15], s17 offen offset:1024 lds
    v_mfma_f32_16x16x32_bf16 v[12:15], v[152:155], v[124:127], v[12:15]
    ds_read_b128 v[100:103], v176 offset:2048
    v_mfma_f32_16x16x32_bf16 v[16:19], v[156:159], v[112:115], v[16:19]
    v_mfma_f32_16x16x32_bf16 v[20:23], v[156:159], v[116:119], v[20:23]
    ds_read_b128 v[104:107], v176 offset:4096
    buffer_load_dwordx4 v188, s[12:15], s17 offen offset:2048 lds
    s_add_u32 s17, s17, 393216
    s_cmp_ge_u32 s17, 6291456
    s_cselect_b32 s17, s55, s17
    v_mfma_f32_16x16x32_bf16 v[24:27], v[156:159], v[120:123], v[24:27]
    ds_read_b128 v[108:111], v176 offset:6144
    v_mfma_f32_16x16x32_bf16 v[28:31], v[156:159], v[124:127], v[28:31]
    ds_read_b64_tr_b16 v[132:133], v181 offset:0
    v_mfma_f32_16x16x32_bf16 v[32:35], v[160:163], v[112:115], v[32:35]
    s_add_u32 m0, s36, 65536
    s_nop 0
    buffer_load_dwordx4 v182, s[8:11], s16 offen offset:0 lds
    v_mfma_f32_16x16x32_bf16 v[36:39], v[160:163], v[116:119], v[36:39]
    ds_read_b64_tr_b16 v[134:135], v181 offset:768
    v_mfma_f32_16x16x32_bf16 v[40:43], v[160:163], v[120:123], v[40:43]
    ds_read_b64_tr_b16 v[136:137], v180 offset:64
    buffer_load_dwordx4 v183, s[8:11], s16 offen offset:1024 lds
    v_mfma_f32_16x16x32_bf16 v[44:47], v[160:163], v[124:127], v[44:47]
    ds_read_b64_tr_b16 v[138:139], v180 offset:832
    v_mfma_f32_16x16x32_bf16 v[48:51], v[164:167], v[112:115], v[48:51]
    v_mfma_f32_16x16x32_bf16 v[52:55], v[164:167], v[116:119], v[52:55]
    ds_read_b64_tr_b16 v[140:141], v181 offset:64
    buffer_load_dwordx4 v184, s[8:11], s16 offen offset:2048 lds
    v_mfma_f32_16x16x32_bf16 v[56:59], v[164:167], v[120:123], v[56:59]
    ds_read_b64_tr_b16 v[142:143], v181 offset:832
    v_mfma_f32_16x16x32_bf16 v[60:63], v[164:167], v[124:127], v[60:63]
    ds_read_b64_tr_b16 v[144:145], v180 offset:128
    v_mfma_f32_16x16x32_bf16 v[64:67], v[168:171], v[112:115], v[64:67]
    buffer_load_dwordx4 v185, s[8:11], s16 offen offset:3072 lds
    s_add_u32 s16, s16, 128
    s_and_b32 s16, s16, 2047
    v_mfma_f32_16x16x32_bf16 v[68:71], v[168:171], v[116:119], v[68:71]
    ds_read_b64_tr_b16 v[146:147], v180 offset:896
    v_mfma_f32_16x16x32_bf16 v[72:75], v[168:171], v[120:123], v[72:75]
    ds_read_b64_tr_b16 v[148:149], v181 offset:128
    s_setprio 0
    v_mfma_f32_16x16x32_bf16 v[76:79], v[168:171], v[124:127], v[76:79]
    s_waitcnt lgkmcnt(14)
    ds_read_b64_tr_b16 v[150:151], v181 offset:896
    v_mfma_f32_16x16x32_bf16 v[80:83], v[172:175], v[112:115], v[80:83]
    v_mfma_f32_16x16x32_bf16 v[84:87], v[172:175], v[116:119], v[84:87]
    v_mfma_f32_16x16x32_bf16 v[88:91], v[172:175], v[120:123], v[88:91]
    v_mfma_f32_16x16x32_bf16 v[92:95], v[172:175], v[124:127], v[92:95]
    s_waitcnt lgkmcnt(13)
    v_mfma_f32_16x16x32_bf16 v[0:3], v[128:131], v[96:99], v[0:3]
    ds_read_b128 v[112:115], v177 offset:0
    s_waitcnt lgkmcnt(13)
    v_mfma_f32_16x16x32_bf16 v[4:7], v[128:131], v[100:103], v[4:7]
    ds_read_b64_tr_b16 v[152:153], v180 offset:6144
    s_waitcnt lgkmcnt(13)
    v_mfma_f32_16x16x32_bf16 v[8:11], v[128:131], v[104:107], v[8:11]
    ds_read_b64_tr_b16 v[154:155], v180 offset:6912
    s_waitcnt lgkmcnt(13)
    v_mfma_f32_16x16x32_bf16 v[12:15], v[128:131], v[108:111], v[12:15]
    ds_read_b128 v[116:119], v177 offset:2048
    s_waitcnt lgkmcnt(12)
    v_mfma_f32_16x16x32_bf16 v[16:19], v[132:135], v[96:99], v[16:19]
    ds_read_b128 v[120:123], v177 offset:4096
    v_mfma_f32_16x16x32_bf16 v[20:23], v[132:135], v[100:103], v[20:23]
    ds_read_b128 v[124:127], v177 offset:6144
    v_mfma_f32_16x16x32_bf16 v[24:27], v[132:135], v[104:107], v[24:27]
    ds_read_b64_tr_b16 v[156:157], v181 offset:6144
    v_mfma_f32_16x16x32_bf16 v[28:31], v[132:135], v[108:111], v[28:31]
    s_waitcnt lgkmcnt(14)
    ds_read_b64_tr_b16 v[158:159], v181 offset:6912
    s_waitcnt lgkmcnt(14)
    v_mfma_f32_16x16x32_bf16 v[32:35], v[136:139], v[96:99], v[32:35]
    ds_read_b64_tr_b16 v[160:161], v180 offset:6208
    v_mfma_f32_16x16x32_bf16 v[36:39], v[136:139], v[100:103], v[36:39]
    s_waitcnt lgkmcnt(14)
    ds_read_b64_tr_b16 v[162:163], v180 offset:6976
    v_mfma_f32_16x16x32_bf16 v[40:43], v[136:139], v[104:107], v[40:43]
    s_waitcnt lgkmcnt(14)
    ds_read_b64_tr_b16 v[164:165], v181 offset:6208
    v_mfma_f32_16x16x32_bf16 v[44:47], v[136:139], v[108:111], v[44:47]
    s_waitcnt lgkmcnt(14)
    ds_read_b64_tr_b16 v[166:167], v181 offset:6976
    v_mfma_f32_16x16x32_bf16 v[48:51], v[140:143], v[96:99], v[48:51]
    s_waitcnt lgkmcnt(14)
    ds_read_b64_tr_b16 v[168:169], v180 offset:6272
    v_mfma_f32_16x16x32_bf16 v[52:55], v[140:143], v[100:103], v[52:55]
    s_waitcnt lgkmcnt(14)
    ds_read_b64_tr_b16 v[170:171], v180 offset:7040
    v_mfma_f32_16x16x32_bf16 v[56:59], v[140:143], v[104:107], v[56:59]
    s_waitcnt lgkmcnt(14)
    ds_read_b64_tr_b16 v[172:173], v181 offset:6272
    v_mfma_f32_16x16x32_bf16 v[60:63], v[140:143], v[108:111], v[60:63]
    s_waitcnt lgkmcnt(14)
    ds_read_b64_tr_b16 v[174:175], v181 offset:7040
    v_mfma_f32_16x16x32_bf16 v[64:67], v[144:147], v[96:99], v[64:67]
    v_mfma_f32_16x16x32_bf16 v[68:71], v[144:147], v[100:103], v[68:71]
    v_mfma_f32_16x16x32_bf16 v[72:75], v[144:147], v[104:107], v[72:75]
    v_mfma_f32_16x16x32_bf16 v[76:79], v[144:147], v[108:111], v[76:79]
    v_mfma_f32_16x16x32_bf16 v[80:83], v[148:151], v[96:99], v[80:83]
    v_mfma_f32_16x16x32_bf16 v[84:87], v[148:151], v[100:103], v[84:87]
    s_waitcnt vmcnt(4) lgkmcnt(0)
    s_barrier
    s_setprio 1
    v_mfma_f32_16x16x32_bf16 v[88:91], v[148:151], v[104:107], v[88:91]
    v_mfma_f32_16x16x32_bf16 v[92:95], v[148:151], v[108:111], v[92:95]
    v_mfma_f32_16x16x32_bf16 v[0:3], v[152:155], v[112:115], v[0:3]
    ds_read_b128 v[96:99], v176 offset:32768
    s_add_u32 m0, s37, 98304
    s_nop 0
    buffer_load_dwordx4 v186, s[12:15], s17 offen offset:0 lds
    v_mfma_f32_16x16x32_bf16 v[4:7], v[152:155], v[116:119], v[4:7]
    ds_read_b64_tr_b16 v[128:129], v180 offset:12288
    v_mfma_f32_16x16x32_bf16 v[8:11], v[152:155], v[120:123], v[8:11]
    ds_read_b64_tr_b16 v[130:131], v180 offset:13056
    buffer_load_dwordx4 v187, s[12:15], s17 offen offset:1024 lds
    v_mfma_f32_16x16x32_bf16 v[12:15], v[152:155], v[124:127], v[12:15]
    ds_read_b128 v[100:103], v176 offset:34816
    v_mfma_f32_16x16x32_bf16 v[16:19], v[156:159], v[112:115], v[16:19]
    v_mfma_f32_16x16x32_bf16 v[20:23], v[156:159], v[116:119], v[20:23]
    ds_read_b128 v[104:107], v176 offset:36864
    buffer_load_dwordx4 v188, s[12:15], s17 offen offset:2048 lds
    s_add_u32 s17, s17, 393216
    v_mfma_f32_16x16x32_bf16 v[24:27], v[156:159], v[120:123], v[24:27]
    ds_read_b128 v[108:111], v176 offset:38912
    v_mfma_f32_16x16x32_bf16 v[28:31], v[156:159], v[124:127], v[28:31]
    ds_read_b64_tr_b16 v[132:133], v181 offset:12288
    v_mfma_f32_16x16x32_bf16 v[32:35], v[160:163], v[112:115], v[32:35]
    s_add_u32 m0, s36, 0
    s_nop 0
    buffer_load_dwordx4 v182, s[8:11], s16 offen offset:0 lds
    v_mfma_f32_16x16x32_bf16 v[36:39], v[160:163], v[116:119], v[36:39]
    ds_read_b64_tr_b16 v[134:135], v181 offset:13056
    v_mfma_f32_16x16x32_bf16 v[40:43], v[160:163], v[120:123], v[40:43]
    ds_read_b64_tr_b16 v[136:137], v180 offset:12352
    buffer_load_dwordx4 v183, s[8:11], s16 offen offset:1024 lds
    v_mfma_f32_16x16x32_bf16 v[44:47], v[160:163], v[124:127], v[44:47]
    ds_read_b64_tr_b16 v[138:139], v180 offset:13120
    v_mfma_f32_16x16x32_bf16 v[48:51], v[164:167], v[112:115], v[48:51]
    v_mfma_f32_16x16x32_bf16 v[52:55], v[164:167], v[116:119], v[52:55]
    ds_read_b64_tr_b16 v[140:141], v181 offset:12352
    buffer_load_dwordx4 v184, s[8:11], s16 offen offset:2048 lds
    v_mfma_f32_16x16x32_bf16 v[56:59], v[164:167], v[120:123], v[56:59]
    ds_read_b64_tr_b16 v[142:143], v181 offset:13120
    v_mfma_f32_16x16x32_bf16 v[60:63], v[164:167], v[124:127], v[60:63]
    ds_read_b64_tr_b16 v[144:145], v180 offset:12416
    v_mfma_f32_16x16x32_bf16 v[64:67], v[168:171], v[112:115], v[64:67]
    buffer_load_dwordx4 v185, s[8:11], s16 offen offset:3072 lds
    s_add_u32 s16, s16, 128
    s_and_b32 s16, s16, 2047
    v_mfma_f32_16x16x32_bf16 v[68:71], v[168:171], v[116:119], v[68:71]
    ds_read_b64_tr_b16 v[146:147], v180 offset:13184
    v_mfma_f32_16x16x32_bf16 v[72:75], v[168:171], v[120:123], v[72:75]
    ds_read_b64_tr_b16 v[148:149], v181 offset:12416
    buffer_load_dword v253, v252, s[48:51], 0 offen sc1
    s_setprio 0
    v_mfma_f32_16x16x32_bf16 v[76:79], v[168:171], v[124:127], v[76:79]
    s_waitcnt lgkmcnt(14)
    ds_read_b64_tr_b16 v[150:151], v181 offset:13184
    v_mfma_f32_16x16x32_bf16 v[80:83], v[172:175], v[112:115], v[80:83]
    v_mfma_f32_16x16x32_bf16 v[84:87], v[172:175], v[116:119], v[84:87]
    v_mfma_f32_16x16x32_bf16 v[88:91], v[172:175], v[120:123], v[88:91]
    v_mfma_f32_16x16x32_bf16 v[92:95], v[172:175], v[124:127], v[92:95]
    s_waitcnt lgkmcnt(13)
    v_mfma_f32_16x16x32_bf16 v[0:3], v[128:131], v[96:99], v[0:3]
    ds_read_b128 v[112:115], v177 offset:32768
    s_waitcnt lgkmcnt(13)
    v_mfma_f32_16x16x32_bf16 v[4:7], v[128:131], v[100:103], v[4:7]
    ds_read_b64_tr_b16 v[152:153], v180 offset:18432
    s_waitcnt lgkmcnt(13)
    v_mfma_f32_16x16x32_bf16 v[8:11], v[128:131], v[104:107], v[8:11]
    ds_read_b64_tr_b16 v[154:155], v180 offset:19200
    s_waitcnt lgkmcnt(13)
    v_mfma_f32_16x16x32_bf16 v[12:15], v[128:131], v[108:111], v[12:15]
    ds_read_b128 v[116:119], v177 offset:34816
    s_waitcnt lgkmcnt(12)
    v_mfma_f32_16x16x32_bf16 v[16:19], v[132:135], v[96:99], v[16:19]
    ds_read_b128 v[120:123], v177 offset:36864
    v_mfma_f32_16x16x32_bf16 v[20:23], v[132:135], v[100:103], v[20:23]
    ds_read_b128 v[124:127], v177 offset:38912
    v_mfma_f32_16x16x32_bf16 v[24:27], v[132:135], v[104:107], v[24:27]
    ds_read_b64_tr_b16 v[156:157], v181 offset:18432
    v_mfma_f32_16x16x32_bf16 v[28:31], v[132:135], v[108:111], v[28:31]
    s_waitcnt lgkmcnt(14)
    ds_read_b64_tr_b16 v[158:159], v181 offset:19200
    s_waitcnt lgkmcnt(14)
    v_mfma_f32_16x16x32_bf16 v[32:35], v[136:139], v[96:99], v[32:35]
    ds_read_b64_tr_b16 v[160:161], v180 offset:18496
    v_mfma_f32_16x16x32_bf16 v[36:39], v[136:139], v[100:103], v[36:39]
    s_waitcnt lgkmcnt(14)
    ds_read_b64_tr_b16 v[162:163], v180 offset:19264
    v_mfma_f32_16x16x32_bf16 v[40:43], v[136:139], v[104:107], v[40:43]
    s_waitcnt lgkmcnt(14)
    ds_read_b64_tr_b16 v[164:165], v181 offset:18496
    v_mfma_f32_16x16x32_bf16 v[44:47], v[136:139], v[108:111], v[44:47]
    s_waitcnt lgkmcnt(14)
    ds_read_b64_tr_b16 v[166:167], v181 offset:19264
    v_mfma_f32_16x16x32_bf16 v[48:51], v[140:143], v[96:99], v[48:51]
    s_waitcnt lgkmcnt(14)
    ds_read_b64_tr_b16 v[168:169], v180 offset:18560
    v_mfma_f32_16x16x32_bf16 v[52:55], v[140:143], v[100:103], v[52:55]
    s_waitcnt lgkmcnt(14)
    ds_read_b64_tr_b16 v[170:171], v180 offset:19328
    v_mfma_f32_16x16x32_bf16 v[56:59], v[140:143], v[104:107], v[56:59]
    s_waitcnt lgkmcnt(14)
    ds_read_b64_tr_b16 v[172:173], v181 offset:18560
    v_mfma_f32_16x16x32_bf16 v[60:63], v[140:143], v[108:111], v[60:63]
    s_waitcnt lgkmcnt(14)
    ds_read_b64_tr_b16 v[174:175], v181 offset:19328
    v_mfma_f32_16x16x32_bf16 v[64:67], v[144:147], v[96:99], v[64:67]
    v_mfma_f32_16x16x32_bf16 v[68:71], v[144:147], v[100:103], v[68:71]
    v_mfma_f32_16x16x32_bf16 v[72:75], v[144:147], v[104:107], v[72:75]
    v_mfma_f32_16x16x32_bf16 v[76:79], v[144:147], v[108:111], v[76:79]
    v_mfma_f32_16x16x32_bf16 v[80:83], v[148:151], v[96:99], v[80:83]
    v_mfma_f32_16x16x32_bf16 v[84:87], v[148:151], v[100:103], v[84:87]
    s_waitcnt vmcnt(5) lgkmcnt(0)
    s_barrier
    s_setprio 1
    v_mfma_f32_16x16x32_bf16 v[88:91], v[148:151], v[104:107], v[88:91]
    v_mfma_f32_16x16x32_bf16 v[92:95], v[148:151], v[108:111], v[92:95]
    v_mfma_f32_16x16x32_bf16 v[0:3], v[152:155], v[112:115], v[0:3]
    ds_read_b128 v[96:99], v178 offset:0
    s_add_u32 m0, s37, 110592
    s_nop 0
    buffer_load_dwordx4 v186, s[12:15], s17 offen offset:0 lds
    v_mfma_f32_16x16x32_bf16 v[4:7], v[152:155], v[116:119], v[4:7]
    ds_read_b64_tr_b16 v[128:129], v180 offset:0
    v_mfma_f32_16x16x32_bf16 v[8:11], v[152:155], v[120:123], v[8:11]
    ds_read_b64_tr_b16 v[130:131], v180 offset:768
    v_mfma_f32_16x16x32_bf16 v[12:15], v[152:155], v[124:127], v[12:15]
    ds_read_b128 v[100:103], v178 offset:2048
    v_mfma_f32_16x16x32_bf16 v[16:19], v[156:159], v[112:115], v[16:19]
    v_mfma_f32_16x16x32_bf16 v[20:23], v[156:159], v[116:119], v[20:23]
    ds_read_b128 v[104:107], v178 offset:4096
    v_mfma_f32_16x16x32_bf16 v[24:27], v[156:159], v[120:123], v[24:27]
    ds_read_b128 v[108:111], v178 offset:6144
    buffer_load_dwordx4 v187, s[12:15], s17 offen offset:1024 lds
    v_mfma_f32_16x16x32_bf16 v[28:31], v[156:159], v[124:127], v[28:31]
    ds_read_b64_tr_b16 v[132:133], v181 offset:0
    v_mfma_f32_16x16x32_bf16 v[32:35], v[160:163], v[112:115], v[32:35]
    v_mfma_f32_16x16x32_bf16 v[36:39], v[160:163], v[116:119], v[36:39]
    ds_read_b64_tr_b16 v[134:135], v181 offset:768
    v_mfma_f32_16x16x32_bf16 v[40:43], v[160:163], v[120:123], v[40:43]
    ds_read_b64_tr_b16 v[136:137], v180 offset:64
    v_mfma_f32_16x16x32_bf16 v[44:47], v[160:163], v[124:127], v[44:47]
    ds_read_b64_tr_b16 v[138:139], v180 offset:832
    v_mfma_f32_16x16x32_bf16 v[48:51], v[164:167], v[112:115], v[48:51]
    buffer_load_dwordx4 v188, s[12:15], s17 offen offset:2048 lds
    s_add_u32 s17, s17, 393216
    s_cmp_ge_u32 s17, 6291456
    s_cselect_b32 s17, s55, s17
    v_mfma_f32_16x16x32_bf16 v[52:55], v[164:167], v[116:119], v[52:55]
    ds_read_b64_tr_b16 v[140:141], v181 offset:64
    v_mfma_f32_16x16x32_bf16 v[56:59], v[164:167], v[120:123], v[56:59]
    ds_read_b64_tr_b16 v[142:143], v181 offset:832
    v_mfma_f32_16x16x32_bf16 v[60:63], v[164:167], v[124:127], v[60:63]
    ds_read_b64_tr_b16 v[144:145], v180 offset:128
    v_mfma_f32_16x16x32_bf16 v[64:67], v[168:171], v[112:115], v[64:67]
    v_mfma_f32_16x16x32_bf16 v[68:71], v[168:171], v[116:119], v[68:71]
    ds_read_b64_tr_b16 v[146:147], v180 offset:896
    v_mfma_f32_16x16x32_bf16 v[72:75], v[168:171], v[120:123], v[72:75]
    ds_read_b64_tr_b16 v[148:149], v181 offset:128
    s_setprio 0
    v_mfma_f32_16x16x32_bf16 v[76:79], v[168:171], v[124:127], v[76:79]
    s_waitcnt lgkmcnt(14)
    ds_read_b64_tr_b16 v[150:151], v181 offset:896
    v_mfma_f32_16x16x32_bf16 v[80:83], v[172:175], v[112:115], v[80:83]
    v_mfma_f32_16x16x32_bf16 v[84:87], v[172:175], v[116:119], v[84:87]
    v_mfma_f32_16x16x32_bf16 v[88:91], v[172:175], v[120:123], v[88:91]
    v_mfma_f32_16x16x32_bf16 v[92:95], v[172:175], v[124:127], v[92:95]
    s_waitcnt lgkmcnt(13)
    v_mfma_f32_16x16x32_bf16 v[0:3], v[128:131], v[96:99], v[0:3]
    ds_read_b128 v[112:115], v179 offset:0
    s_waitcnt lgkmcnt(13)
    v_mfma_f32_16x16x32_bf16 v[4:7], v[128:131], v[100:103], v[4:7]
    ds_read_b64_tr_b16 v[152:153], v180 offset:6144
    s_waitcnt lgkmcnt(13)
    v_mfma_f32_16x16x32_bf16 v[8:11], v[128:131], v[104:107], v[8:11]
    ds_read_b64_tr_b16 v[154:155], v180 offset:6912
    s_waitcnt lgkmcnt(13)
    v_mfma_f32_16x16x32_bf16 v[12:15], v[128:131], v[108:111], v[12:15]
    ds_read_b128 v[116:119], v179 offset:2048
    s_waitcnt lgkmcnt(12)
    v_mfma_f32_16x16x32_bf16 v[16:19], v[132:135], v[96:99], v[16:19]
    ds_read_b128 v[120:123], v179 offset:4096
    v_mfma_f32_16x16x32_bf16 v[20:23], v[132:135], v[100:103], v[20:23]
    ds_read_b128 v[124:127], v179 offset:6144
    v_mfma_f32_16x16x32_bf16 v[24:27], v[132:135], v[104:107], v[24:27]
    ds_read_b64_tr_b16 v[156:157], v181 offset:6144
    v_mfma_f32_16x16x32_bf16 v[28:31], v[132:135], v[108:111], v[28:31]
    s_waitcnt lgkmcnt(14)
    ds_read_b64_tr_b16 v[158:159], v181 offset:6912
    s_waitcnt lgkmcnt(14)
    v_mfma_f32_16x16x32_bf16 v[32:35], v[136:139], v[96:99], v[32:35]
    ds_read_b64_tr_b16 v[160:161], v180 offset:6208
    v_mfma_f32_16x16x32_bf16 v[36:39], v[136:139], v[100:103], v[36:39]
    s_waitcnt lgkmcnt(14)
    ds_read_b64_tr_b16 v[162:163], v180 offset:6976
    v_mfma_f32_16x16x32_bf16 v[40:43], v[136:139], v[104:107], v[40:43]
    s_waitcnt lgkmcnt(14)
    ds_read_b64_tr_b16 v[164:165], v181 offset:6208
    v_mfma_f32_16x16x32_bf16 v[44:47], v[136:139], v[108:111], v[44:47]
    s_waitcnt lgkmcnt(14)
    ds_read_b64_tr_b16 v[166:167], v181 offset:6976
    v_mfma_f32_16x16x32_bf16 v[48:51], v[140:143], v[96:99], v[48:51]
    s_waitcnt lgkmcnt(14)
    ds_read_b64_tr_b16 v[168:169], v180 offset:6272
    v_mfma_f32_16x16x32_bf16 v[52:55], v[140:143], v[100:103], v[52:55]
    s_waitcnt lgkmcnt(14)
    ds_read_b64_tr_b16 v[170:171], v180 offset:7040
    v_mfma_f32_16x16x32_bf16 v[56:59], v[140:143], v[104:107], v[56:59]
    s_waitcnt lgkmcnt(14)
    ds_read_b64_tr_b16 v[172:173], v181 offset:6272
    v_mfma_f32_16x16x32_bf16 v[60:63], v[140:143], v[108:111], v[60:63]
    s_waitcnt lgkmcnt(14)
    ds_read_b64_tr_b16 v[174:175], v181 offset:7040
    v_mfma_f32_16x16x32_bf16 v[64:67], v[144:147], v[96:99], v[64:67]
    v_mfma_f32_16x16x32_bf16 v[68:71], v[144:147], v[100:103], v[68:71]
    v_mfma_f32_16x16x32_bf16 v[72:75], v[144:147], v[104:107], v[72:75]
    v_mfma_f32_16x16x32_bf16 v[76:79], v[144:147], v[108:111], v[76:79]
    v_mfma_f32_16x16x32_bf16 v[80:83], v[148:151], v[96:99], v[80:83]
    v_mfma_f32_16x16x32_bf16 v[84:87], v[148:151], v[100:103], v[84:87]
    s_waitcnt vmcnt(0) lgkmcnt(0)
    s_barrier
    s_setprio 1
    v_mfma_f32_16x16x32_bf16 v[88:91], v[148:151], v[104:107], v[88:91]
    v_mfma_f32_16x16x32_bf16 v[92:95], v[148:151], v[108:111], v[92:95]
    v_mfma_f32_16x16x32_bf16 v[0:3], v[152:155], v[112:115], v[0:3]
    s_waitcnt vmcnt(3)
    v_cmp_eq_u32 vcc, 32, v253
    s_nop 0
    s_cmp_eq_u64 vcc, -1
    s_cbranch_scc1 polld_13
    s_mov_b32 s70, 1048576
poll_12:
    s_sleep 1
    buffer_load_dword v253, v252, s[48:51], 0 offen sc1
    s_waitcnt vmcnt(0)
    v_cmp_eq_u32 vcc, 32, v253
    s_nop 0
    s_cmp_eq_u64 vcc, -1
    s_cbranch_scc1 polld_13
    s_sub_u32 s70, s70, 1
    s_cmp_lg_u32 s70, 0
    s_cbranch_scc1 poll_12
polld_13:
    s_and_b32 s59, s71, 7
    s_add_u32 s59, s59, 32
    v_and_b32 v252, 7, v254
    v_mov_b32 v253, s59
    v_cmp_gt_u32 vcc, 8, v254
    s_nop 1
    v_cndmask_b32 v252, v253, v252, vcc
    v_lshlrev_b32 v252, 7, v252
    s_andn2_b32 s59, s71, 7
    s_lshl_b32 s59, s59, 7
    s_add_u32 s59, s59, 9437184
    buffer_load_dword v255, v252, s[44:47], s59 offen offset:40 sc1
    v_and_b32 v252, 15, v254
    v_lshlrev_b32 v252, 5, v252
    s_lshl_b32 s59, s52, 2
    s_add_u32 s59, s59, s25
    s_lshl_b32 s59, s59, 11
    s_add_u32 s59, s59, 8388608
    buffer_load_dwordx4 v[236:239], v252, s[44:47], s59 offen offset:0 sc1
    buffer_load_dwordx2 v[200:201], v252, s[44:47], s59 offen offset:16 sc1
    buffer_load_dwordx4 v[240:243], v252, s[44:47], s59 offen offset:512 sc1
    buffer_load_dwordx2 v[202:203], v252, s[44:47], s59 offen offset:528 sc1
    buffer_load_dwordx4 v[244:247], v252, s[44:47], s59 offen offset:1024 sc1
    buffer_load_dwordx2 v[204:205], v252, s[44:47], s59 offen offset:1040 sc1
    buffer_load_dwordx4 v[248:251], v252, s[44:47], s59 offen offset:1536 sc1
    buffer_load_dwordx2 v[206:207], v252, s[44:47], s59 offen offset:1552 sc1
    v_lshrrev_b32 v253, 4, v254
    v_lshl_add_u32 v253, v253, 3, v252
    s_lshl_b32 s59, s53, 13
    s_add_u32 s59, s59, 8454144
    v_pk_mov_b32 v[210:211], 0, 0
    buffer_load_dwordx2 v[208:209], v253, s[44:47], s59 offen offset:0 sc1
    v_pk_mov_b32 v[214:215], 0, 0
    buffer_load_dwordx2 v[212:213], v253, s[44:47], s59 offen offset:512 sc1
    v_pk_mov_b32 v[218:219], 0, 0
    buffer_load_dwordx2 v[216:217], v253, s[44:47], s59 offen offset:1024 sc1
    v_pk_mov_b32 v[222:223], 0, 0
    buffer_load_dwordx2 v[220:221], v253, s[44:47], s59 offen offset:1536 sc1
    v_pk_mov_b32 v[226:227], 0, 0
    buffer_load_dwordx2 v[224:225], v253, s[44:47], s59 offen offset:2048 sc1
    v_pk_mov_b32 v[230:231], 0, 0
    buffer_load_dwordx2 v[228:229], v253, s[44:47], s59 offen offset:2560 sc1
    ds_read_b128 v[96:99], v176 offset:0
    v_mfma_f32_16x16x32_bf16 v[4:7], v[152:155], v[116:119], v[4:7]
    ds_read_b64_tr_b16 v[128:129], v180 offset:12288
    v_mfma_f32_16x16x32_bf16 v[8:11], v[152:155], v[120:123], v[8:11]
    ds_read_b64_tr_b16 v[130:131], v180 offset:13056
    v_mfma_f32_16x16x32_bf16 v[12:15], v[152:155], v[124:127], v[12:15]
    ds_read_b128 v[100:103], v176 offset:2048
    v_mfma_f32_16x16x32_bf16 v[16:19], v[156:159], v[112:115], v[16:19]
    v_mfma_f32_16x16x32_bf16 v[20:23], v[156:159], v[116:119], v[20:23]
    ds_read_b128 v[104:107], v176 offset:4096
    v_mfma_f32_16x16x32_bf16 v[24:27], v[156:159], v[120:123], v[24:27]
    ds_read_b128 v[108:111], v176 offset:6144
    v_mfma_f32_16x16x32_bf16 v[28:31], v[156:159], v[124:127], v[28:31]
    ds_read_b64_tr_b16 v[132:133], v181 offset:12288
    v_mfma_f32_16x16x32_bf16 v[32:35], v[160:163], v[112:115], v[32:35]
    v_mfma_f32_16x16x32_bf16 v[36:39], v[160:163], v[116:119], v[36:39]
    ds_read_b64_tr_b16 v[134:135], v181 offset:13056
    v_mfma_f32_16x16x32_bf16 v[40:43], v[160:163], v[120:123], v[40:43]
    ds_read_b64_tr_b16 v[136:137], v180 offset:12352
    v_mfma_f32_16x16x32_bf16 v[44:47], v[160:163], v[124:127], v[44:47]
    ds_read_b64_tr_b16 v[138:139], v180 offset:13120
    v_mfma_f32_16x16x32_bf16 v[48:51], v[164:167], v[112:115], v[48:51]
    v_mfma_f32_16x16x32_bf16 v[52:55], v[164:167], v[116:119], v[52:55]
    ds_read_b64_tr_b16 v[140:141], v181 offset:12352
    v_mfma_f32_16x16x32_bf16 v[56:59], v[164:167], v[120:123], v[56:59]
    ds_read_b64_tr_b16 v[142:143], v181 offset:13120
    v_mfma_f32_16x16x32_bf16 v[60:63], v[164:167], v[124:127], v[60:63]
    ds_read_b64_tr_b16 v[144:145], v180 offset:12416
    v_mfma_f32_16x16x32_bf16 v[64:67], v[168:171], v[112:115], v[64:67]
    v_mfma_f32_16x16x32_bf16 v[68:71], v[168:171], v[116:119], v[68:71]
    ds_read_b64_tr_b16 v[146:147], v180 offset:13184
    v_mfma_f32_16x16x32_bf16 v[72:75], v[168:171], v[120:123], v[72:75]
    ds_read_b64_tr_b16 v[148:149], v181 offset:12416
    v_mov_b32 v196, 49152
    v_pk_mov_b32 v[192:193], 0, 0
    v_pk_mov_b32 v[194:195], 0, 0
    s_waitcnt lgkmcnt(14)
    ds_write_b128 v196, v[192:195]
    s_setprio 0
    v_mfma_f32_16x16x32_bf16 v[76:79], v[168:171], v[124:127], v[76:79]
    s_waitcnt lgkmcnt(14)
    ds_read_b64_tr_b16 v[150:151], v181 offset:13184
    v_mfma_f32_16x16x32_bf16 v[80:83], v[172:175], v[112:115], v[80:83]
    v_mfma_f32_16x16x32_bf16 v[84:87], v[172:175], v[116:119], v[84:87]
    v_mfma_f32_16x16x32_bf16 v[88:91], v[172:175], v[120:123], v[88:91]
    v_mfma_f32_16x16x32_bf16 v[92:95], v[172:175], v[124:127], v[92:95]
    s_waitcnt lgkmcnt(14)
    v_mfma_f32_16x16x32_bf16 v[0:3], v[128:131], v[96:99], v[0:3]
    ds_read_b128 v[112:115], v177 offset:0
    s_waitcnt lgkmcnt(14)
    v_mfma_f32_16x16x32_bf16 v[4:7], v[128:131], v[100:103], v[4:7]
    ds_read_b64_tr_b16 v[152:153], v180 offset:18432
    s_waitcnt lgkmcnt(14)
    v_mfma_f32_16x16x32_bf16 v[8:11], v[128:131], v[104:107], v[8:11]
    ds_read_b64_tr_b16 v[154:155], v180 offset:19200
    s_waitcnt lgkmcnt(14)
    v_mfma_f32_16x16x32_bf16 v[12:15], v[128:131], v[108:111], v[12:15]
    ds_read_b128 v[116:119], v177 offset:2048
    s_waitcnt lgkmcnt(13)
    v_mfma_f32_16x16x32_bf16 v[16:19], v[132:135], v[96:99], v[16:19]
    ds_read_b128 v[120:123], v177 offset:4096
    v_mfma_f32_16x16x32_bf16 v[20:23], v[132:135], v[100:103], v[20:23]
    ds_read_b128 v[124:127], v177 offset:6144
    v_mfma_f32_16x16x32_bf16 v[24:27], v[132:135], v[104:107], v[24:27]
    s_waitcnt lgkmcnt(14)
    ds_read_b64_tr_b16 v[156:157], v181 offset:18432
    v_mfma_f32_16x16x32_bf16 v[28:31], v[132:135], v[108:111], v[28:31]
    s_waitcnt lgkmcnt(14)
    ds_read_b64_tr_b16 v[158:159], v181 offset:19200
    v_mfma_f32_16x16x32_bf16 v[32:35], v[136:139], v[96:99], v[32:35]
    s_waitcnt lgkmcnt(14)
    ds_read_b64_tr_b16 v[160:161], v180 offset:18496
    v_mfma_f32_16x16x32_bf16 v[36:39], v[136:139], v[100:103], v[36:39]
    s_waitcnt lgkmcnt(14)
    ds_read_b64_tr_b16 v[162:163], v180 offset:19264
    v_mfma_f32_16x16x32_bf16 v[40:43], v[136:139], v[104:107], v[40:43]
    s_waitcnt lgkmcnt(14)
    ds_read_b64_tr_b16 v[164:165], v181 offset:18496
    v_mfma_f32_16x16x32_bf16 v[44:47], v[136:139], v[108:111], v[44:47]
    s_waitcnt lgkmcnt(14)
    ds_read_b64_tr_b16 v[166:167], v181 offset:19264
    v_mfma_f32_16x16x32_bf16 v[48:51], v[140:143], v[96:99], v[48:51]
    s_waitcnt lgkmcnt(14)
    ds_read_b64_tr_b16 v[168:169], v180 offset:18560
    v_mfma_f32_16x16x32_bf16 v[52:55], v[140:143], v[100:103], v[52:55]
    s_waitcnt lgkmcnt(14)
    ds_read_b64_tr_b16 v[170:171], v180 offset:19328
    v_mfma_f32_16x16x32_bf16 v[56:59], v[140:143], v[104:107], v[56:59]
    s_waitcnt lgkmcnt(14)
    ds_read_b64_tr_b16 v[172:173], v181 offset:18560
    v_mfma_f32_16x16x32_bf16 v[60:63], v[140:143], v[108:111], v[60:63]
    s_waitcnt lgkmcnt(14)
    ds_read_b64_tr_b16 v[174:175], v181 offset:19328
    v_mfma_f32_16x16x32_bf16 v[64:67], v[144:147], v[96:99], v[64:67]
    v_mfma_f32_16x16x32_bf16 v[68:71], v[144:147], v[100:103], v[68:71]
    v_mfma_f32_16x16x32_bf16 v[72:75], v[144:147], v[104:107], v[72:75]
    v_mfma_f32_16x16x32_bf16 v[76:79], v[144:147], v[108:111], v[76:79]
    v_mfma_f32_16x16x32_bf16 v[80:83], v[148:151], v[96:99], v[80:83]
    v_mfma_f32_16x16x32_bf16 v[84:87], v[148:151], v[100:103], v[84:87]
    s_waitcnt lgkmcnt(0)
    s_barrier
    v_mfma_f32_16x16x32_bf16 v[88:91], v[148:151], v[104:107], v[88:91]
    v_mfma_f32_16x16x32_bf16 v[92:95], v[148:151], v[108:111], v[92:95]
    v_mfma_f32_16x16x32_bf16 v[0:3], v[152:155], v[112:115], v[0:3]
    v_mfma_f32_16x16x32_bf16 v[4:7], v[152:155], v[116:119], v[4:7]
    v_mfma_f32_16x16x32_bf16 v[8:11], v[152:155], v[120:123], v[8:11]
    v_mfma_f32_16x16x32_bf16 v[12:15], v[152:155], v[124:127], v[12:15]
    v_mfma_f32_16x16x32_bf16 v[16:19], v[156:159], v[112:115], v[16:19]
    v_mfma_f32_16x16x32_bf16 v[20:23], v[156:159], v[116:119], v[20:23]
    v_mfma_f32_16x16x32_bf16 v[24:27], v[156:159], v[120:123], v[24:27]
    v_mfma_f32_16x16x32_bf16 v[28:31], v[156:159], v[124:127], v[28:31]
    v_mfma_f32_16x16x32_bf16 v[32:35], v[160:163], v[112:115], v[32:35]
    v_mfma_f32_16x16x32_bf16 v[36:39], v[160:163], v[116:119], v[36:39]
    v_mfma_f32_16x16x32_bf16 v[40:43], v[160:163], v[120:123], v[40:43]
    v_mfma_f32_16x16x32_bf16 v[44:47], v[160:163], v[124:127], v[44:47]
    v_mfma_f32_16x16x32_bf16 v[48:51], v[164:167], v[112:115], v[48:51]
    v_mfma_f32_16x16x32_bf16 v[52:55], v[164:167], v[116:119], v[52:55]
    v_mfma_f32_16x16x32_bf16 v[56:59], v[164:167], v[120:123], v[56:59]
    v_mfma_f32_16x16x32_bf16 v[60:63], v[164:167], v[124:127], v[60:63]
    v_mfma_f32_16x16x32_bf16 v[64:67], v[168:171], v[112:115], v[64:67]
    v_mfma_f32_16x16x32_bf16 v[68:71], v[168:171], v[116:119], v[68:71]
    v_mfma_f32_16x16x32_bf16 v[72:75], v[168:171], v[120:123], v[72:75]
    s_setprio 0
    v_mfma_f32_16x16x32_bf16 v[76:79], v[168:171], v[124:127], v[76:79]
    v_mfma_f32_16x16x32_bf16 v[80:83], v[172:175], v[112:115], v[80:83]
    v_mfma_f32_16x16x32_bf16 v[84:87], v[172:175], v[116:119], v[84:87]
    v_mfma_f32_16x16x32_bf16 v[88:91], v[172:175], v[120:123], v[88:91]
    v_mfma_f32_16x16x32_bf16 v[92:95], v[172:175], v[124:127], v[92:95]
    s_waitcnt vmcnt(0)
    s_setprio 3
    v_cmp_eq_u32 vcc, s28, v255
    s_nop 0
    s_and_b32 s29, vcc_lo, 0xff
    s_bfe_u32 s31, vcc_lo, 0x80008
    s_mov_b32 s31, 0
    v_mfma_f32_16x16x32_bf16 v[32:35], v[216:219], v[236:239], v[32:35]
    v_mfma_f32_16x16x32_bf16 v[36:39], v[216:219], v[240:243], v[36:39]
    v_mfma_f32_16x16x32_bf16 v[40:43], v[216:219], v[244:247], v[40:43]
    v_mfma_f32_16x16x32_bf16 v[44:47], v[216:219], v[248:251], v[44:47]
    v_mfma_f32_16x16x32_bf16 v[48:51], v[220:223], v[236:239], v[48:51]
    v_mfma_f32_16x16x32_bf16 v[52:55], v[220:223], v[240:243], v[52:55]
    v_mfma_f32_16x16x32_bf16 v[56:59], v[220:223], v[244:247], v[56:59]
    v_mfma_f32_16x16x32_bf16 v[60:63], v[220:223], v[248:251], v[60:63]
    v_mfma_f32_16x16x32_bf16 v[64:67], v[224:227], v[236:239], v[64:67]
    v_mfma_f32_16x16x32_bf16 v[68:71], v[224:227], v[240:243], v[68:71]
    v_mfma_f32_16x16x32_bf16 v[72:75], v[224:227], v[244:247], v[72:75]
    v_mfma_f32_16x16x32_bf16 v[76:79], v[224:227], v[248:251], v[76:79]
    v_mfma_f32_16x16x32_bf16 v[80:83], v[228:231], v[236:239], v[80:83]
    v_mfma_f32_16x16x32_bf16 v[84:87], v[228:231], v[240:243], v[84:87]
    v_mfma_f32_16x16x32_bf16 v[88:91], v[228:231], v[244:247], v[88:91]
    v_mfma_f32_16x16x32_bf16 v[92:95], v[228:231], v[248:251], v[92:95]
    v_mfma_f32_16x16x32_bf16 v[0:3], v[208:211], v[236:239], v[0:3]
    v_mfma_f32_16x16x32_bf16 v[4:7], v[208:211], v[240:243], v[4:7]
    v_mfma_f32_16x16x32_bf16 v[8:11], v[208:211], v[244:247], v[8:11]
    v_mfma_f32_16x16x32_bf16 v[12:15], v[208:211], v[248:251], v[12:15]
    v_mfma_f32_16x16x32_bf16 v[16:19], v[212:215], v[236:239], v[16:19]
    v_mfma_f32_16x16x32_bf16 v[20:23], v[212:215], v[240:243], v[20:23]
    v_mfma_f32_16x16x32_bf16 v[24:27], v[212:215], v[244:247], v[24:27]
    v_mfma_f32_16x16x32_bf16 v[28:31], v[212:215], v[248:251], v[28:31]
    v_and_b32 v96, 15, v254
    s_lshl_b32 s23, s25, 6
    v_add_u32 v96, s23, v96
    v_lshlrev_b32 v96, 6, v96
    v_bfe_u32 v97, v254, 4, 1
    v_lshrrev_b32 v98, 5, v254
    v_lshl_add_u32 v97, v97, 1, v98
    v_bfe_u32 v98, v254, 2, 2
    v_xor_b32 v98, v98, v97
    v_lshl_add_u32 v98, v98, 4, v96
    v_lshl_add_u32 v97, v97, 4, v96
    s_lshl_b32 s58, s71, 15
    s_add_u32 s59, s58, 16384
    v_pk_mul_f32 v[32:33], v[32:33], v[200:201]
    v_pk_mul_f32 v[34:35], v[34:35], v[200:201]
    v_pk_mul_f32 v[48:49], v[48:49], v[200:201]
    v_pk_mul_f32 v[50:51], v[50:51], v[200:201]
    v_pk_mul_f32 v[36:37], v[36:37], v[202:203]
    v_pk_mul_f32 v[38:39], v[38:39], v[202:203]
    v_pk_mul_f32 v[52:53], v[52:53], v[202:203]
    v_pk_mul_f32 v[54:55], v[54:55], v[202:203]
    v_pk_mul_f32 v[40:41], v[40:41], v[204:205]
    v_pk_mul_f32 v[42:43], v[42:43], v[204:205]
    v_pk_mul_f32 v[56:57], v[56:57], v[204:205]
    v_pk_mul_f32 v[58:59], v[58:59], v[204:205]
    v_pk_mul_f32 v[44:45], v[44:45], v[206:207]
    v_pk_mul_f32 v[46:47], v[46:47], v[206:207]
    v_pk_mul_f32 v[60:61], v[60:61], v[206:207]
    v_pk_mul_f32 v[62:63], v[62:63], v[206:207]
    v_cvt_pk_bf16_f32 v144, v32, v33
    v_cvt_pk_bf16_f32 v145, v34, v35
    v_cvt_pk_bf16_f32 v146, v48, v49
    v_cvt_pk_bf16_f32 v147, v50, v51
    s_nop 0
    v_permlane16_swap_b32 v144, v146
    v_permlane16_swap_b32 v145, v147
    buffer_store_dwordx4 v[144:147], v98, s[44:47], s58 offen offset:0 sc1
    v_cvt_pk_bf16_f32 v148, v36, v37
    v_cvt_pk_bf16_f32 v149, v38, v39
    v_cvt_pk_bf16_f32 v150, v52, v53
    v_cvt_pk_bf16_f32 v151, v54, v55
    s_nop 0
    v_permlane16_swap_b32 v148, v150
    v_permlane16_swap_b32 v149, v151
    buffer_store_dwordx4 v[148:151], v98, s[44:47], s58 offen offset:1024 sc1
    v_cvt_pk_bf16_f32 v152, v40, v41
    v_cvt_pk_bf16_f32 v153, v42, v43
    v_cvt_pk_bf16_f32 v154, v56, v57
    v_cvt_pk_bf16_f32 v155, v58, v59
    s_nop 0
    v_permlane16_swap_b32 v152, v154
    v_permlane16_swap_b32 v153, v155
    buffer_store_dwordx4 v[152:155], v98, s[44:47], s58 offen offset:2048 sc1
    v_cvt_pk_bf16_f32 v156, v44, v45
    v_cvt_pk_bf16_f32 v157, v46, v47
    v_cvt_pk_bf16_f32 v158, v60, v61
    v_cvt_pk_bf16_f32 v159, v62, v63
    s_nop 0
    v_permlane16_swap_b32 v156, v158
    v_permlane16_swap_b32 v157, v159
    buffer_store_dwordx4 v[156:159], v98, s[44:47], s58 offen offset:3072 sc1
    v_pk_mul_f32 v[64:65], v[64:65], v[200:201]
    v_pk_mul_f32 v[66:67], v[66:67], v[200:201]
    v_pk_mul_f32 v[80:81], v[80:81], v[200:201]
    v_pk_mul_f32 v[82:83], v[82:83], v[200:201]
    v_pk_mul_f32 v[68:69], v[68:69], v[202:203]
    v_pk_mul_f32 v[70:71], v[70:71], v[202:203]
    v_pk_mul_f32 v[84:85], v[84:85], v[202:203]
    v_pk_mul_f32 v[86:87], v[86:87], v[202:203]
    v_pk_mul_f32 v[72:73], v[72:73], v[204:205]
    v_pk_mul_f32 v[74:75], v[74:75], v[204:205]
    v_pk_mul_f32 v[88:89], v[88:89], v[204:205]
    v_pk_mul_f32 v[90:91], v[90:91], v[204:205]
    v_pk_mul_f32 v[76:77], v[76:77], v[206:207]
    v_pk_mul_f32 v[78:79], v[78:79], v[206:207]
    v_pk_mul_f32 v[92:93], v[92:93], v[206:207]
    v_pk_mul_f32 v[94:95], v[94:95], v[206:207]
    v_cvt_pk_bf16_f32 v160, v64, v65
    v_cvt_pk_bf16_f32 v161, v66, v67
    v_cvt_pk_bf16_f32 v162, v80, v81
    v_cvt_pk_bf16_f32 v163, v82, v83
    s_nop 0
    v_permlane16_swap_b32 v160, v162
    v_permlane16_swap_b32 v161, v163
    buffer_store_dwordx4 v[160:163], v97, s[44:47], s59 offen offset:0 sc1
    v_cvt_pk_bf16_f32 v164, v68, v69
    v_cvt_pk_bf16_f32 v165, v70, v71
    v_cvt_pk_bf16_f32 v166, v84, v85
    v_cvt_pk_bf16_f32 v167, v86, v87
    s_nop 0
    v_permlane16_swap_b32 v164, v166
    v_permlane16_swap_b32 v165, v167
    buffer_store_dwordx4 v[164:167], v97, s[44:47], s59 offen offset:1024 sc1
    v_cvt_pk_bf16_f32 v168, v72, v73
    v_cvt_pk_bf16_f32 v169, v74, v75
    v_cvt_pk_bf16_f32 v170, v88, v89
    v_cvt_pk_bf16_f32 v171, v90, v91
    s_nop 0
    v_permlane16_swap_b32 v168, v170
    v_permlane16_swap_b32 v169, v171
    buffer_store_dwordx4 v[168:171], v97, s[44:47], s59 offen offset:2048 sc1
    v_cvt_pk_bf16_f32 v172, v76, v77
    v_cvt_pk_bf16_f32 v173, v78, v79
    v_cvt_pk_bf16_f32 v174, v92, v93
    v_cvt_pk_bf16_f32 v175, v94, v95
    s_nop 0
    v_permlane16_swap_b32 v172, v174
    v_permlane16_swap_b32 v173, v175
    buffer_store_dwordx4 v[172:175], v97, s[44:47], s59 offen offset:3072 sc1
    v_mul_f32 v200, 0x3e8293ee, v200
    v_mul_f32 v201, 0x3e8293ee, v201
    v_mul_f32 v202, 0x3e8293ee, v202
    v_mul_f32 v203, 0x3e8293ee, v203
    v_mul_f32 v204, 0x3e8293ee, v204
    v_mul_f32 v205, 0x3e8293ee, v205
    v_mul_f32 v206, 0x3e8293ee, v206
    v_mul_f32 v207, 0x3e8293ee, v207
    v_pk_mul_f32 v[0:1], v[0:1], v[200:201]
    v_pk_mul_f32 v[2:3], v[2:3], v[200:201]
    v_pk_mul_f32 v[16:17], v[16:17], v[200:201]
    v_pk_mul_f32 v[18:19], v[18:19], v[200:201]
    v_pk_mul_f32 v[4:5], v[4:5], v[202:203]
    v_pk_mul_f32 v[6:7], v[6:7], v[202:203]
    v_pk_mul_f32 v[20:21], v[20:21], v[202:203]
    v_pk_mul_f32 v[22:23], v[22:23], v[202:203]
    v_pk_mul_f32 v[8:9], v[8:9], v[204:205]
    v_pk_mul_f32 v[10:11], v[10:11], v[204:205]
    v_pk_mul_f32 v[24:25], v[24:25], v[204:205]
    v_pk_mul_f32 v[26:27], v[26:27], v[204:205]
    v_pk_mul_f32 v[12:13], v[12:13], v[206:207]
    v_pk_mul_f32 v[14:15], v[14:15], v[206:207]
    v_pk_mul_f32 v[28:29], v[28:29], v[206:207]
    v_pk_mul_f32 v[30:31], v[30:31], v[206:207]
    v_cvt_pk_bf16_f32 v128, v0, v1
    v_cvt_pk_bf16_f32 v129, v2, v3
    v_cvt_pk_bf16_f32 v130, v16, v17
    v_cvt_pk_bf16_f32 v131, v18, v19
    s_nop 0
    v_permlane16_swap_b32 v128, v130
    v_permlane16_swap_b32 v129, v131
    v_cvt_pk_bf16_f32 v132, v4, v5
    v_cvt_pk_bf16_f32 v133, v6, v7
    v_cvt_pk_bf16_f32 v134, v20, v21
    v_cvt_pk_bf16_f32 v135, v22, v23
    s_nop 0
    v_permlane16_swap_b32 v132, v134
    v_permlane16_swap_b32 v133, v135
    v_cvt_pk_bf16_f32 v136, v8, v9
    v_cvt_pk_bf16_f32 v137, v10, v11
    v_cvt_pk_bf16_f32 v138, v24, v25
    v_cvt_pk_bf16_f32 v139, v26, v27
    s_nop 0
    v_permlane16_swap_b32 v136, v138
    v_permlane16_swap_b32 v137, v139
    v_cvt_pk_bf16_f32 v140, v12, v13
    v_cvt_pk_bf16_f32 v141, v14, v15
    v_cvt_pk_bf16_f32 v142, v28, v29
    v_cvt_pk_bf16_f32 v143, v30, v31
    s_nop 0
    v_permlane16_swap_b32 v140, v142
    v_permlane16_swap_b32 v141, v143
    s_mov_b64 s[32:33], s[66:67]
    s_mov_b32 s12, s62
    s_mov_b32 s13, s63
    s_mov_b32 s14, 7340032
    s_mov_b32 s15, 0x00020000
    s_bfe_u32 s54, s2, 0x20001
    s_and_b32 s18, s2, 1
    s_lshl_b32 s18, s18, 2
    s_bfe_u32 s3, s2, 0x20003
    s_add_u32 s18, s18, s3
    s_lshr_b32 s19, s2, 5
    s_lshl_b32 s55, s54, 4
    s_lshl_b32 s35, s18, 14
    s_mul_i32 s16, s54, 3670016
    s_add_u32 s16, s16, 4194304
    s_add_u32 s16, s16, s35
    s_lshl_b32 s23, s54, 20
    s_add_u32 s35, s35, s23
    s_lshl_b32 s63, s19, 8
    s_mul_i32 s17, s54, 1835008
    s_add_u32 s17, s17, s63
    s_lshl_b32 s30, s54, 19
    s_add_u32 s30, s30, s63
    s_mov_b32 s8, s6
    s_mov_b32 s9, s7
    s_mov_b32 s10, 18878464
    s_mov_b32 s11, 0x00020000
    s_lshl_b32 s20, s71, 7
    s_add_u32 s21, s20, 9437216
    s_lshl_b32 s23, s24, 2
    s_add_u32 s20, s20, s23
    s_add_u32 s20, s20, 9437184
    s_lshl_b32 s22, s18, 2
    s_add_u32 s22, s22, s54
    s_lshl_b32 s22, s22, 10
    s_add_u32 s22, s22, 9437184
    v_mov_b32 v0, 0
    v_mov_b32 v1, 1
    s_waitcnt vmcnt(0)
    s_mov_b64 exec, 1
    buffer_store_dword v1, v0, s[44:47], s20 offen sc1
    s_mov_b64 exec, -1
    s_sub_u32 s59, s20, 4096
    buffer_load_dword v4, v0, s[44:47], s59 offen sc1
    v_add_u32 v97, 0x10000, v97
    ds_write_b128 v98, v[144:147] offset:32768
    ds_write_b128 v98, v[148:151] offset:33792
    ds_write_b128 v98, v[152:155] offset:34816
    ds_write_b128 v98, v[156:159] offset:35840
    ds_write_b128 v97, v[160:163] offset:0
    ds_write_b128 v97, v[164:167] offset:1024
    ds_write_b128 v97, v[168:171] offset:2048
    ds_write_b128 v97, v[172:175] offset:3072
    ds_write_b128 v98, v[128:131] offset:0
    ds_write_b128 v98, v[132:135] offset:1024
    ds_write_b128 v98, v[136:139] offset:2048
    ds_write_b128 v98, v[140:143] offset:3072
    v_lshlrev_b32 v40, 4, v254
    s_lshl_b32 s23, s25, 12
    v_add_u32 v40, s23, v40
    s_waitcnt vmcnt(0)
    s_cmp_eq_u32 s52, 0
    s_cbranch_scc1 mz_14
    v_readfirstlane_b32 s3, v4
    s_nop 0
    s_cmp_eq_u32 s3, 1
    s_cbranch_scc1 polld_17
    s_mov_b32 s70, 1048576
poll_16:
    s_sleep 1
    buffer_load_dword v4, v0, s[44:47], s59 offen sc1
    s_waitcnt vmcnt(0)
    v_readfirstlane_b32 s3, v4
    s_nop 0
    s_cmp_eq_u32 s3, 1
    s_cbranch_scc1 polld_17
    s_sub_u32 s70, s70, 1
    s_cmp_lg_u32 s70, 0
    s_cbranch_scc1 poll_16
polld_17:
    s_sub_u32 s58, s58, 1048576
    s_add_u32 s59, s58, 16384
    buffer_load_dwordx4 v[8:11], v40, s[44:47], s58 offen offset:0 sc1
    buffer_load_dwordx4 v[12:15], v40, s[44:47], s58 offen offset:1024 sc1
    buffer_load_dwordx4 v[16:19], v40, s[44:47], s58 offen offset:2048 sc1
    buffer_load_dwordx4 v[20:23], v40, s[44:47], s58 offen offset:3072 sc1
    buffer_load_dwordx4 v[24:27], v40, s[44:47], s59 offen offset:0 sc1
    buffer_load_dwordx4 v[28:31], v40, s[44:47], s59 offen offset:1024 sc1
    buffer_load_dwordx4 v[32:35], v40, s[44:47], s59 offen offset:2048 sc1
    buffer_load_dwordx4 v[36:39], v40, s[44:47], s59 offen offset:3072 sc1
    s_branch mw_15
mz_14:
    v_pk_mov_b32 v[8:9], 0, 0
    v_pk_mov_b32 v[10:11], 0, 0
    v_pk_mov_b32 v[12:13], 0, 0
    v_pk_mov_b32 v[14:15], 0, 0
    v_pk_mov_b32 v[16:17], 0, 0
    v_pk_mov_b32 v[18:19], 0, 0
    v_pk_mov_b32 v[20:21], 0, 0
    v_pk_mov_b32 v[22:23], 0, 0
    v_pk_mov_b32 v[24:25], 0, 0
    v_pk_mov_b32 v[26:27], 0, 0
    v_pk_mov_b32 v[28:29], 0, 0
    v_pk_mov_b32 v[30:31], 0, 0
    v_pk_mov_b32 v[32:33], 0, 0
    v_pk_mov_b32 v[34:35], 0, 0
    v_pk_mov_b32 v[36:37], 0, 0
    v_pk_mov_b32 v[38:39], 0, 0
mw_15:
    s_mov_b32 s27, s24
    s_mov_b32 s57, 0xf149f2ca
    v_and_b32 v244, 31, v254
    v_lshrrev_b32 v245, 5, v254
    v_bfe_u32 v246, v254, 2, 2
    v_xor_b32 v246, v246, v245
    v_lshlrev_b32 v246, 4, v246
    v_lshl_add_u32 v240, v244, 6, v246
    s_lshl_b32 s23, s24, 11
    v_add_u32 v240, s23, v240
    v_xor_b32 v241, 32, v240
    v_bfe_u32 v246, v254, 2, 2
    v_lshl_add_u32 v246, v245, 2, v246
    v_lshlrev_b32 v246, 6, v246
    v_bfe_u32 v247, v254, 4, 1
    v_lshl_add_u32 v246, v247, 5, v246
    v_and_b32 v247, 3, v254
    v_lshl_add_u32 v246, v247, 3, v246
    s_add_u32 s23, s23, 49152
    v_add_u32 v242, s23, v246
    s_lshl_b32 s58, s52, 3
    s_add_u32 s58, s58, s24
    s_lshl_b32 s58, s58, 11
    s_lshl_b32 s59, s53, 17
    s_add_u32 s58, s58, s59
    v_lshlrev_b32 v250, 6, v244
    v_lshl_add_u32 v250, v245, 4, v250
    v_lshlrev_b32 v245, 2, v245
    v_sub_u32 v244, v244, v245
    v_add_u32 v244, 1, v244
    v_max_i32 v244, 0, v244
    v_lshrrev_b32 v245, 3, v244
    v_and_b32 v244, 7, v244
    v_min_u32 v244, 4, v244
    v_lshl_add_u32 v244, v245, 2, v244
    v_bfm_b32 v243, v244, 0
    s_cmp_eq_u32 s52, 0
    s_cselect_b32 s3, -1, 0
    s_cselect_b32 s56, 7, 64
    s_sub_u32 s56, s56, s24
    v_or_b32 v244, s3, v243
    v_bfe_i32 v176, v243, 0, 1
    v_bfe_i32 v192, v244, 0, 1
    v_bfi_b32 v176, v176, 0, s57
    v_and_b32 v192, s57, v192
    v_bfe_i32 v177, v243, 1, 1
    v_bfe_i32 v193, v244, 1, 1
    v_bfi_b32 v177, v177, 0, s57
    v_and_b32 v193, s57, v193
    v_bfe_i32 v178, v243, 2, 1
    v_bfe_i32 v194, v244, 2, 1
    v_bfi_b32 v178, v178, 0, s57
    v_and_b32 v194, s57, v194
    v_bfe_i32 v179, v243, 3, 1
    v_bfe_i32 v195, v244, 3, 1
    v_bfi_b32 v179, v179, 0, s57
    v_and_b32 v195, s57, v195
    v_bfe_i32 v180, v243, 4, 1
    v_bfe_i32 v196, v244, 4, 1
    v_bfi_b32 v180, v180, 0, s57
    v_and_b32 v196, s57, v196
    v_bfe_i32 v181, v243, 5, 1
    v_bfe_i32 v197, v244, 5, 1
    v_bfi_b32 v181, v181, 0, s57
    v_and_b32 v197, s57, v197
    v_bfe_i32 v182, v243, 6, 1
    v_bfe_i32 v198, v244, 6, 1
    v_bfi_b32 v182, v182, 0, s57
    v_and_b32 v198, s57, v198
    v_bfe_i32 v183, v243, 7, 1
    v_bfe_i32 v199, v244, 7, 1
    v_bfi_b32 v183, v183, 0, s57
    v_and_b32 v199, s57, v199
    v_bfe_i32 v184, v243, 8, 1
    v_bfe_i32 v200, v244, 8, 1
    v_bfi_b32 v184, v184, 0, s57
    v_and_b32 v200, s57, v200
    v_bfe_i32 v185, v243, 9, 1
    v_bfe_i32 v201, v244, 9, 1
    v_bfi_b32 v185, v185, 0, s57
    v_and_b32 v201, s57, v201
    v_bfe_i32 v186, v243, 10, 1
    v_bfe_i32 v202, v244, 10, 1
    v_bfi_b32 v186, v186, 0, s57
    v_and_b32 v202, s57, v202
    v_bfe_i32 v187, v243, 11, 1
    v_bfe_i32 v203, v244, 11, 1
    v_bfi_b32 v187, v187, 0, s57
    v_and_b32 v203, s57, v203
    v_bfe_i32 v188, v243, 12, 1
    v_bfe_i32 v204, v244, 12, 1
    v_bfi_b32 v188, v188, 0, s57
    v_and_b32 v204, s57, v204
    v_bfe_i32 v189, v243, 13, 1
    v_bfe_i32 v205, v244, 13, 1
    v_bfi_b32 v189, v189, 0, s57
    v_and_b32 v205, s57, v205
    v_bfe_i32 v190, v243, 14, 1
    v_bfe_i32 v206, v244, 14, 1
    v_bfi_b32 v190, v190, 0, s57
    v_and_b32 v206, s57, v206
    v_bfe_i32 v191, v243, 15, 1
    v_bfe_i32 v207, v244, 15, 1
    v_bfi_b32 v191, v191, 0, s57
    v_and_b32 v207, s57, v207
    v_mov_b32 v208, 0x3f803f80
    v_mov_b32 v209, 0x3f803f80
    v_mov_b32 v210, 0x3f803f80
    v_mov_b32 v211, 0x3f803f80
    s_waitcnt vmcnt(7)
    ds_write_b128 v40, v[8:11] offset:16384
    s_waitcnt vmcnt(6)
    ds_write_b128 v40, v[12:15] offset:17408
    s_waitcnt vmcnt(5)
    ds_write_b128 v40, v[16:19] offset:18432
    s_waitcnt vmcnt(4)
    s_waitcnt lgkmcnt(14)
    ds_write_b128 v40, v[20:23] offset:19456
    s_waitcnt vmcnt(3)
    s_cmp_eq_u32 s24, 0
    s_cselect_b32 exec_lo, -2, -1
    s_waitcnt lgkmcnt(14)
    ds_write_b128 v40, v[24:27] offset:49152
    s_waitcnt vmcnt(2)
    s_mov_b32 exec_lo, -1
    s_waitcnt lgkmcnt(14)
    ds_write_b128 v40, v[28:31] offset:50176
    s_waitcnt vmcnt(1)
    s_waitcnt lgkmcnt(14)
    ds_write_b128 v40, v[32:35] offset:51200
    s_waitcnt vmcnt(0)
    s_waitcnt lgkmcnt(14)
    ds_write_b128 v40, v[36:39] offset:52224
    v_mov_b32 v0, 49152
    v_mov_b32 v1, 1
    s_waitcnt lgkmcnt(0)
    s_mov_b64 exec, 1
    ds_add_u32 v0, v1
    s_mov_b64 exec, -1
    v_lshrrev_b32 v2, 4, v254
    s_and_b32 s23, s24, 1
    s_lshl_b32 s23, s23, 3
    v_lshlrev_b32 v3, 1, v2
    v_xor_b32 v3, s23, v3
    v_and_b32 v4, 15, v254
    v_xor_b32 v3, v3, v4
    s_lshl_b32 s23, s24, 3
    v_add_u32 v2, s23, v2
    v_lshlrev_b32 v2, 11, v2
    v_lshl_add_u32 v140, v3, 4, v2
    v_add_u32 v141, 7168, v140
    s_mul_i32 s37, s24, 2048
    s_add_u32 s23, s17, 0
    s_add_u32 m0, s37, 114688
    s_nop 0
    buffer_load_dwordx4 v140, s[12:15], s23 offen offset:0 lds
    buffer_load_dwordx4 v141, s[12:15], s23 offen offset:1024 lds
    s_add_u32 s23, s17, 65536
    s_add_u32 m0, s37, 122880
    s_nop 0
    buffer_load_dwordx4 v140, s[12:15], s23 offen offset:0 lds
    buffer_load_dwordx4 v141, s[12:15], s23 offen offset:1024 lds
    s_add_u32 s23, s17, 131072
    s_add_u32 m0, s37, 131072
    s_nop 0
    buffer_load_dwordx4 v140, s[12:15], s23 offen offset:0 lds
    buffer_load_dwordx4 v141, s[12:15], s23 offen offset:1024 lds
    s_add_u32 s23, s17, 196608
    s_add_u32 m0, s37, 139264
    s_nop 0
    buffer_load_dwordx4 v140, s[12:15], s23 offen offset:0 lds
    buffer_load_dwordx4 v141, s[12:15], s23 offen offset:1024 lds
    s_add_u32 s23, s17, 262144
    s_add_u32 m0, s37, 147456
    s_nop 0
    buffer_load_dwordx4 v140, s[12:15], s23 offen offset:0 lds
    buffer_load_dwordx4 v141, s[12:15], s23 offen offset:1024 lds
    s_add_u32 s23, s17, 327680
    s_add_u32 m0, s37, 155648
    s_nop 0
    buffer_load_dwordx4 v140, s[12:15], s23 offen offset:0 lds
    buffer_load_dwordx4 v141, s[12:15], s23 offen offset:1024 lds
    s_branch f1_attn
f1_h:
    s_and_b32 s54, s53, 1
    s_lshl_b32 s54, s54, 1
    s_lshl_b32 s57, s53, 3
    s_add_u32 s57, s57, s24
    s_lshl_b32 s58, s57, 11
    v_lshlrev_b32 v8, 4, v254
    v_lshrrev_b32 v2, 3, v254
    s_lshl_b32 s23, s24, 5
    v_add_u32 v2, s23, v2
    v_lshrrev_b32 v3, 4, v254
    v_and_b32 v4, 7, v254
    v_xor_b32 v3, v3, v4
    v_lshlrev_b32 v2, 11, v2
    v_lshl_add_u32 v208, v3, 4, v2
    v_xor_b32 v2, 64, v208
    v_add_u32 v209, 15360, v2
    v_add_u32 v210, 30720, v208
    v_add_u32 v211, 46080, v2
    s_lshl_b32 s36, s24, 12
    s_lshl_b32 s56, s52, 1
    s_lshl_b32 s16, s56, 7
    s_mul_i32 s55, s53, 224
    s_mul_i32 s17, s56, 458752
    s_add_u32 s17, s17, s55
    s_lshl_b32 s59, s52, 19
    s_waitcnt lgkmcnt(0)
    s_add_u32 s8, s4, s59
    s_addc_u32 s9, s5, 0
    s_mov_b32 s10, 524288
    s_mov_b32 s11, 0x00020000
    buffer_load_dwordx4 v[112:115], v8, s[8:11], s58 offen
    buffer_load_dwordx4 v[116:119], v8, s[8:11], s58 offen offset:1024
    s_add_u32 m0, s36, 0
    s_nop 0
    buffer_load_dwordx4 v208, s[8:11], s16 offen offset:0 lds
    buffer_load_dwordx4 v209, s[8:11], s16 offen offset:1024 lds
    buffer_load_dwordx4 v210, s[8:11], s16 offen offset:2048 lds
    buffer_load_dwordx4 v211, s[8:11], s16 offen offset:3072 lds
    s_add_u32 s16, s16, 128
    s_and_b32 s16, s16, 2047
    v_mul_u32_u24 v2, 4682, v254
    v_lshrrev_b32 v2, 16, v2
    v_mul_u32_u24 v3, 14, v2
    v_sub_u32 v3, v254, v3
    v_add_u32 v3, s54, v3
    v_subrev_u32 v4, 14, v3
    v_min_u32 v3, v3, v4
    v_lshlrev_b32 v3, 4, v3
    v_lshrrev_b32 v4, 2, v2
    v_lshl_add_u32 v3, v4, 30, v3
    s_lshl_b32 s23, s25, 4
    v_add_u32 v2, s23, v2
    v_mul_u32_u24 v2, 7168, v2
    v_add_u32 v212, v2, v3
    v_add_u32 v213, 27584, v212
    v_add_u32 v214, 55168, v212
    v_add_u32 v215, 82752, v212
    s_mul_i32 s37, s25, 4352
    s_mov_b32 s12, s60
    s_mov_b32 s13, s61
    s_mov_b32 s14, 7340032
    s_mov_b32 s15, 0x00020000
    s_add_u32 m0, s37, 122880
    s_nop 0
    buffer_load_dwordx4 v212, s[12:15], s17 offen offset:0 lds
    buffer_load_dwordx4 v213, s[12:15], s17 offen offset:1088 lds
    buffer_load_dwordx4 v214, s[12:15], s17 offen offset:2176 lds
    buffer_load_dwordx4 v215, s[12:15], s17 offen offset:3264 lds
    s_add_u32 s17, s17, 458752
    v_and_b32 v2, 15, v254
    s_lshl_b32 s23, s25, 6
    v_add_u32 v3, s23, v2
    v_lshlrev_b32 v3, 7, v3
    v_lshrrev_b32 v2, 1, v2
    v_lshrrev_b32 v4, 4, v254
    v_xor_b32 v2, v2, v4
    v_lshl_add_u32 v200, v2, 4, v3
    v_xor_b32 v201, 64, v200
    v_add_u32 v202, 65536, v200
    v_add_u32 v203, 65536, v201
    v_bfe_u32 v2, v254, 2, 2
    v_mul_u32_u24 v3, 2176, v4
    v_mul_u32_u24 v2, 224, v2
    v_and_b32 v5, 3, v254
    v_lshl_add_u32 v2, v5, 3, v2
    v_add_u32 v2, 122880, v2
    v_add_u32 v204, v2, v3
    s_mov_b64 s[6:7], s[70:71]
    s_add_u32 s44, s6, 33554432
    s_addc_u32 s45, s7, 0
    s_mov_b32 s46, 25165824
    s_mov_b32 s47, 0x00020000
    s_add_u32 s40, s6, 4096
    s_addc_u32 s41, s7, 0
    s_mov_b32 s42, 18874368
    s_mov_b32 s43, 0x00020000
    s_mov_b32 s48, s68
    s_mov_b32 s49, s69
    s_mov_b32 s50, 256
    s_mov_b32 s51, 0x00020000
    s_lshl_b32 s71, s52, 5
    s_add_u32 s71, s71, s53
    s_lshl_b32 s59, s71, 3
    s_add_u32 s59, s59, s24
    s_lshl_b32 s59, s59, 5
    s_add_u32 s59, s59, 8388608
    s_waitcnt vmcnt(8)
    s_mov_b32 s56, 0x3a800000
    s_mov_b32 s57, 0x3727c5ac
    s_mov_b32 s58, 0xffff0000
    v_lshlrev_b32 v16, 16, v112
    v_and_b32 v17, s58, v112
    v_lshlrev_b32 v18, 16, v113
    v_and_b32 v19, s58, v113
    v_lshlrev_b32 v20, 16, v114
    v_and_b32 v21, s58, v114
    v_lshlrev_b32 v22, 16, v115
    v_and_b32 v23, s58, v115
    v_lshlrev_b32 v24, 16, v116
    v_and_b32 v25, s58, v116
    v_lshlrev_b32 v26, 16, v117
    v_and_b32 v27, s58, v117
    v_lshlrev_b32 v28, 16, v118
    v_and_b32 v29, s58, v118
    v_lshlrev_b32 v30, 16, v119
    v_and_b32 v31, s58, v119
    v_pk_add_f32 v[36:37], v[16:17], v[24:25]
    v_pk_add_f32 v[38:39], v[18:19], v[26:27]
    v_pk_add_f32 v[40:41], v[20:21], v[28:29]
    v_pk_add_f32 v[42:43], v[22:23], v[30:31]
    v_pk_add_f32 v[36:37], v[36:37], v[40:41]
    v_pk_add_f32 v[38:39], v[38:39], v[42:43]
    v_pk_add_f32 v[36:37], v[36:37], v[38:39]
    v_add_f32 v32, v36, v37
    s_nop 1
    v_add_f32 v32, v32, v32 quad_perm:[1,0,3,2] row_mask:0xf bank_mask:0xf
    s_nop 1
    v_add_f32 v32, v32, v32 quad_perm:[2,3,0,1] row_mask:0xf bank_mask:0xf
    s_nop 1
    v_add_f32 v32, v32, v32 row_half_mirror row_mask:0xf bank_mask:0xf
    s_nop 1
    v_add_f32 v32, v32, v32 row_mirror row_mask:0xf bank_mask:0xf
    v_mov_b32 v33, v32
    s_nop 1
    v_permlane16_swap_b32 v33, v32
    v_add_f32 v32, v32, v33
    v_mov_b32 v33, v32
    s_nop 1
    v_permlane32_swap_b32 v33, v32
    v_add_f32 v32, v32, v33
    v_mul_f32 v34, s56, v32
    v_mul_f32 v35, s56, v32
    v_pk_add_f32 v[36:37], v[16:17], v[34:35] neg_lo:[0,1] neg_hi:[0,1]
    v_pk_add_f32 v[38:39], v[18:19], v[34:35] neg_lo:[0,1] neg_hi:[0,1]
    v_pk_add_f32 v[40:41], v[20:21], v[34:35] neg_lo:[0,1] neg_hi:[0,1]
    v_pk_add_f32 v[42:43], v[22:23], v[34:35] neg_lo:[0,1] neg_hi:[0,1]
    v_pk_add_f32 v[44:45], v[24:25], v[34:35] neg_lo:[0,1] neg_hi:[0,1]
    v_pk_add_f32 v[46:47], v[26:27], v[34:35] neg_lo:[0,1] neg_hi:[0,1]
    v_pk_add_f32 v[48:49], v[28:29], v[34:35] neg_lo:[0,1] neg_hi:[0,1]
    v_pk_add_f32 v[50:51], v[30:31], v[34:35] neg_lo:[0,1] neg_hi:[0,1]
    v_pk_mul_f32 v[32:33], v[36:37], v[36:37]
    v_pk_mul_f32 v[60:61], v[38:39], v[38:39]
    v_pk_fma_f32 v[32:33], v[40:41], v[40:41], v[32:33]
    v_pk_fma_f32 v[60:61], v[42:43], v[42:43], v[60:61]
    v_pk_fma_f32 v[32:33], v[44:45], v[44:45], v[32:33]
    v_pk_fma_f32 v[60:61], v[46:47], v[46:47], v[60:61]
    v_pk_fma_f32 v[32:33], v[48:49], v[48:49], v[32:33]
    v_pk_fma_f32 v[60:61], v[50:51], v[50:51], v[60:61]
    v_pk_add_f32 v[32:33], v[32:33], v[60:61]
    v_add_f32 v32, v32, v33
    s_nop 1
    v_add_f32 v32, v32, v32 quad_perm:[1,0,3,2] row_mask:0xf bank_mask:0xf
    s_nop 1
    v_add_f32 v32, v32, v32 quad_perm:[2,3,0,1] row_mask:0xf bank_mask:0xf
    s_nop 1
    v_add_f32 v32, v32, v32 row_half_mirror row_mask:0xf bank_mask:0xf
    s_nop 1
    v_add_f32 v32, v32, v32 row_mirror row_mask:0xf bank_mask:0xf
    v_mov_b32 v33, v32
    s_nop 1
    v_permlane16_swap_b32 v33, v32
    v_add_f32 v32, v32, v33
    v_mov_b32 v33, v32
    s_nop 1
    v_permlane32_swap_b32 v33, v32
    v_add_f32 v32, v32, v33
    v_mul_f32 v32, s56, v32
    v_cvt_pk_bf16_f32 v34, v34, v34
    v_and_b32 v34, s58, v34
    v_cvt_pk_bf16_f32 v32, v32, v32
    v_and_b32 v32, s58, v32
    v_add_f32 v32, s57, v32
    v_cvt_pk_bf16_f32 v32, v32, v32
    v_and_b32 v32, s58, v32
    v_sqrt_f32 v32, v32
    s_nop 0
    v_cvt_pk_bf16_f32 v32, v32, v32
    v_and_b32 v32, s58, v32
    v_cvt_pk_bf16_f32 v8, -v34, -v34
    v_mov_b32 v13, v32
    v_rcp_f32 v12, v32
    v_mov_b32 v9, v8
    v_mov_b32 v35, v34
    v_mov_b32 v62, v12
    v_mov_b32 v63, v12
    v_pk_add_f32 v[36:37], v[16:17], v[34:35] neg_lo:[0,1] neg_hi:[0,1]
    v_pk_add_f32 v[38:39], v[18:19], v[34:35] neg_lo:[0,1] neg_hi:[0,1]
    v_pk_add_f32 v[40:41], v[20:21], v[34:35] neg_lo:[0,1] neg_hi:[0,1]
    v_pk_add_f32 v[42:43], v[22:23], v[34:35] neg_lo:[0,1] neg_hi:[0,1]
    v_pk_add_f32 v[44:45], v[24:25], v[34:35] neg_lo:[0,1] neg_hi:[0,1]
    v_pk_add_f32 v[46:47], v[26:27], v[34:35] neg_lo:[0,1] neg_hi:[0,1]
    v_pk_add_f32 v[48:49], v[28:29], v[34:35] neg_lo:[0,1] neg_hi:[0,1]
    v_pk_add_f32 v[50:51], v[30:31], v[34:35] neg_lo:[0,1] neg_hi:[0,1]
    v_cvt_pk_bf16_f32 v52, v36, v37
    v_cvt_pk_bf16_f32 v53, v38, v39
    v_cvt_pk_bf16_f32 v54, v40, v41
    v_cvt_pk_bf16_f32 v55, v42, v43
    v_cvt_pk_bf16_f32 v56, v44, v45
    v_cvt_pk_bf16_f32 v57, v46, v47
    v_cvt_pk_bf16_f32 v58, v48, v49
    v_cvt_pk_bf16_f32 v59, v50, v51
    v_lshlrev_b32 v16, 16, v52
    v_and_b32 v17, s58, v52
    v_lshlrev_b32 v18, 16, v53
    v_and_b32 v19, s58, v53
    v_lshlrev_b32 v20, 16, v54
    v_and_b32 v21, s58, v54
    v_lshlrev_b32 v22, 16, v55
    v_and_b32 v23, s58, v55
    v_lshlrev_b32 v24, 16, v56
    v_and_b32 v25, s58, v56
    v_lshlrev_b32 v26, 16, v57
    v_and_b32 v27, s58, v57
    v_lshlrev_b32 v28, 16, v58
    v_and_b32 v29, s58, v58
    v_lshlrev_b32 v30, 16, v59
    v_and_b32 v31, s58, v59
    v_pk_mul_f32 v[36:37], v[16:17], v[62:63]
    v_pk_mul_f32 v[38:39], v[18:19], v[62:63]
    v_pk_mul_f32 v[40:41], v[20:21], v[62:63]
    v_pk_mul_f32 v[42:43], v[22:23], v[62:63]
    v_pk_mul_f32 v[44:45], v[24:25], v[62:63]
    v_pk_mul_f32 v[46:47], v[26:27], v[62:63]
    v_pk_mul_f32 v[48:49], v[28:29], v[62:63]
    v_pk_mul_f32 v[50:51], v[30:31], v[62:63]
    v_cvt_pk_bf16_f32 v52, v36, v37
    v_cvt_pk_bf16_f32 v53, v38, v39
    v_cvt_pk_bf16_f32 v54, v40, v41
    v_cvt_pk_bf16_f32 v55, v42, v43
    v_cvt_pk_bf16_f32 v56, v44, v45
    v_cvt_pk_bf16_f32 v57, v46, v47
    v_cvt_pk_bf16_f32 v58, v48, v49
    v_cvt_pk_bf16_f32 v59, v50, v51
    v_lshlrev_b32 v16, 16, v52
    v_and_b32 v17, s58, v52
    v_lshlrev_b32 v18, 16, v53
    v_and_b32 v19, s58, v53
    v_lshlrev_b32 v20, 16, v54
    v_and_b32 v21, s58, v54
    v_lshlrev_b32 v22, 16, v55
    v_and_b32 v23, s58, v55
    v_lshlrev_b32 v24, 16, v56
    v_and_b32 v25, s58, v56
    v_lshlrev_b32 v26, 16, v57
    v_and_b32 v27, s58, v57
    v_lshlrev_b32 v28, 16, v58
    v_and_b32 v29, s58, v58
    v_lshlrev_b32 v30, 16, v59
    v_and_b32 v31, s58, v59
    v_pk_add_f32 v[36:37], v[16:17], v[24:25]
    v_pk_add_f32 v[38:39], v[18:19], v[26:27]
    v_pk_add_f32 v[40:41], v[20:21], v[28:29]
    v_pk_add_f32 v[42:43], v[22:23], v[30:31]
    v_pk_add_f32 v[36:37], v[36:37], v[40:41]
    v_pk_add_f32 v[38:39], v[38:39], v[42:43]
    v_pk_add_f32 v[36:37], v[36:37], v[38:39]
    v_add_f32 v32, v36, v37
    s_nop 1
    v_add_f32 v32, v32, v32 quad_perm:[1,0,3,2] row_mask:0xf bank_mask:0xf
    s_nop 1
    v_add_f32 v32, v32, v32 quad_perm:[2,3,0,1] row_mask:0xf bank_mask:0xf
    s_nop 1
    v_add_f32 v32, v32, v32 row_half_mirror row_mask:0xf bank_mask:0xf
    s_nop 1
    v_add_f32 v32, v32, v32 row_mirror row_mask:0xf bank_mask:0xf
    v_mov_b32 v33, v32
    s_nop 1
    v_permlane16_swap_b32 v33, v32
    v_add_f32 v32, v32, v33
    v_mov_b32 v33, v32
    s_nop 1
    v_permlane32_swap_b32 v33, v32
    v_add_f32 v32, v32, v33
    v_mul_f32 v34, s56, v32
    v_mul_f32 v35, s56, v32
    v_pk_add_f32 v[36:37], v[16:17], v[34:35] neg_lo:[0,1] neg_hi:[0,1]
    v_pk_add_f32 v[38:39], v[18:19], v[34:35] neg_lo:[0,1] neg_hi:[0,1]
    v_pk_add_f32 v[40:41], v[20:21], v[34:35] neg_lo:[0,1] neg_hi:[0,1]
    v_pk_add_f32 v[42:43], v[22:23], v[34:35] neg_lo:[0,1] neg_hi:[0,1]
    v_pk_add_f32 v[44:45], v[24:25], v[34:35] neg_lo:[0,1] neg_hi:[0,1]
    v_pk_add_f32 v[46:47], v[26:27], v[34:35] neg_lo:[0,1] neg_hi:[0,1]
    v_pk_add_f32 v[48:49], v[28:29], v[34:35] neg_lo:[0,1] neg_hi:[0,1]
    v_pk_add_f32 v[50:51], v[30:31], v[34:35] neg_lo:[0,1] neg_hi:[0,1]
    v_pk_mul_f32 v[32:33], v[36:37], v[36:37]
    v_pk_mul_f32 v[60:61], v[38:39], v[38:39]
    v_pk_fma_f32 v[32:33], v[40:41], v[40:41], v[32:33]
    v_pk_fma_f32 v[60:61], v[42:43], v[42:43], v[60:61]
    v_pk_fma_f32 v[32:33], v[44:45], v[44:45], v[32:33]
    v_pk_fma_f32 v[60:61], v[46:47], v[46:47], v[60:61]
    v_pk_fma_f32 v[32:33], v[48:49], v[48:49], v[32:33]
    v_pk_fma_f32 v[60:61], v[50:51], v[50:51], v[60:61]
    v_pk_add_f32 v[32:33], v[32:33], v[60:61]
    v_add_f32 v32, v32, v33
    s_nop 1
    v_add_f32 v32, v32, v32 quad_perm:[1,0,3,2] row_mask:0xf bank_mask:0xf
    s_nop 1
    v_add_f32 v32, v32, v32 quad_perm:[2,3,0,1] row_mask:0xf bank_mask:0xf
    s_nop 1
    v_add_f32 v32, v32, v32 row_half_mirror row_mask:0xf bank_mask:0xf
    s_nop 1
    v_add_f32 v32, v32, v32 row_mirror row_mask:0xf bank_mask:0xf
    v_mov_b32 v33, v32
    s_nop 1
    v_permlane16_swap_b32 v33, v32
    v_add_f32 v32, v32, v33
    v_mov_b32 v33, v32
    s_nop 1
    v_permlane32_swap_b32 v33, v32
    v_add_f32 v32, v32, v33
    v_mul_f32 v32, s56, v32
    v_cvt_pk_bf16_f32 v34, v34, v34
    v_and_b32 v34, s58, v34
    v_cvt_pk_bf16_f32 v32, v32, v32
    v_and_b32 v32, s58, v32
    v_add_f32 v32, s57, v32
    v_cvt_pk_bf16_f32 v32, v32, v32
    v_and_b32 v32, s58, v32
    v_sqrt_f32 v32, v32
    s_nop 0
    v_cvt_pk_bf16_f32 v32, v32, v32
    v_and_b32 v32, s58, v32
    v_mul_f32 v10, v34, v13
    v_cvt_pk_bf16_f32 v10, -v10, -v10
    v_mul_f32 v11, v13, v32
    v_and_b32 v14, s58, v11
    v_sub_f32 v15, v11, v14
    v_cvt_pk_bf16_f32 v11, v14, v15
    v_mov_b32 v2, 0
    s_lshl_b32 s58, s71, 7
    s_lshl_b32 s23, s24, 2
    s_add_u32 s58, s58, s23
    s_add_u32 s58, s58, 9437184
    s_mov_b64 exec, 1
    buffer_store_dwordx4 v[8:11], v2, s[44:47], s59 offen sc1
    buffer_store_dwordx2 v[62:63], v2, s[44:47], s59 offen offset:16 sc1
    buffer_store_dword v2, v2, s[44:47], s58 offen sc1
    s_cmp_eq_u32 s24, 2
    s_cselect_b32 s3, s28, 0
    v_mov_b32 v4, s3
    buffer_store_dword v4, v2, s[44:47], s58 offen offset:32 sc1
    s_mov_b64 exec, -1
    s_add_u32 m0, s36, 32768
    s_nop 0
    buffer_load_dwordx4 v208, s[8:11], s16 offen offset:0 lds
    buffer_load_dwordx4 v209, s[8:11], s16 offen offset:1024 lds
    buffer_load_dwordx4 v210, s[8:11], s16 offen offset:2048 lds
    buffer_load_dwordx4 v211, s[8:11], s16 offen offset:3072 lds
    s_add_u32 s16, s16, 128
    s_and_b32 s16, s16, 2047
    s_add_u32 m0, s37, 140288
    s_nop 0
    buffer_load_dwordx4 v212, s[12:15], s17 offen offset:0 lds
    buffer_load_dwordx4 v213, s[12:15], s17 offen offset:1088 lds
    buffer_load_dwordx4 v214, s[12:15], s17 offen offset:2176 lds
    buffer_load_dwordx4 v215, s[12:15], s17 offen offset:3264 lds
    s_add_u32 s17, s17, 458752
    s_cmp_ge_u32 s17, 7340032
    s_cselect_b32 s17, s55, s17
    v_pk_mov_b32 v[216:217], 0, 0
    v_pk_mov_b32 v[218:219], 0, 0
    v_pk_mov_b32 v[220:221], 0, 0
    v_pk_mov_b32 v[222:223], 0, 0
    v_mov_b32 v224, 0x3f803f80
    v_mov_b32 v225, 0x3f803f80
    v_mov_b32 v226, 0x3f803f80
    v_mov_b32 v227, 0x3f803f80
    v_and_b32 v252, 7, v254
    v_lshlrev_b32 v252, 2, v252
    s_waitcnt vmcnt(12)
    s_barrier
    ds_read_b128 v[112:115], v200 offset:0
    ds_read_b64_tr_b16 v[144:145], v204 offset:0
    ds_read_b64_tr_b16 v[146:147], v204 offset:1088
    ds_read_b128 v[116:119], v200 offset:2048
    ds_read_b128 v[120:123], v200 offset:4096
    ds_read_b128 v[124:127], v200 offset:6144
    ds_read_b64_tr_b16 v[148:149], v204 offset:32
    ds_read_b64_tr_b16 v[150:151], v204 offset:1120
    ds_read_b64_tr_b16 v[152:153], v204 offset:64
    ds_read_b64_tr_b16 v[154:155], v204 offset:1152
    ds_read_b64_tr_b16 v[156:157], v204 offset:96
    ds_read_b64_tr_b16 v[158:159], v204 offset:1184
    ds_read_b64_tr_b16 v[160:161], v204 offset:128
    ds_read_b64_tr_b16 v[162:163], v204 offset:1216
    ds_read_b64_tr_b16 v[164:165], v204 offset:160
    s_waitcnt lgkmcnt(14)
    ds_read_b64_tr_b16 v[166:167], v204 offset:1248
    s_waitcnt lgkmcnt(14)
    ds_read_b64_tr_b16 v[168:169], v204 offset:192
    s_waitcnt lgkmcnt(14)
    ds_read_b64_tr_b16 v[170:171], v204 offset:1280
    s_add_u32 m0, s36, 65536
    s_nop 0
    buffer_load_dwordx4 v208, s[8:11], s16 offen offset:0 lds
    buffer_load_dwordx4 v209, s[8:11], s16 offen offset:1024 lds
    buffer_load_dwordx4 v210, s[8:11], s16 offen offset:2048 lds
    buffer_load_dwordx4 v211, s[8:11], s16 offen offset:3072 lds
    s_add_u32 s16, s16, 128
    s_and_b32 s16, s16, 2047
    v_mfma_f32_16x16x32_bf16 v[0:3], v[144:147], v[112:115], 0
    s_waitcnt lgkmcnt(14)
    ds_read_b128 v[128:131], v201 offset:0
    v_mfma_f32_16x16x32_bf16 v[4:7], v[144:147], v[116:119], 0
    s_waitcnt lgkmcnt(14)
    ds_read_b64_tr_b16 v[172:173], v204 offset:8704
    v_mfma_f32_16x16x32_bf16 v[8:11], v[144:147], v[120:123], 0
    s_waitcnt lgkmcnt(14)
    ds_read_b64_tr_b16 v[174:175], v204 offset:9792
    v_mfma_f32_16x16x32_bf16 v[12:15], v[144:147], v[124:127], 0
    s_waitcnt lgkmcnt(14)
    ds_read_b128 v[132:135], v201 offset:2048
    s_waitcnt lgkmcnt(14)
    v_mfma_f32_16x16x32_bf16 v[16:19], v[148:151], v[112:115], 0
    ds_read_b128 v[136:139], v201 offset:4096
    v_mfma_f32_16x16x32_bf16 v[20:23], v[148:151], v[116:119], 0
    s_waitcnt lgkmcnt(14)
    ds_read_b128 v[140:143], v201 offset:6144
    v_mfma_f32_16x16x32_bf16 v[24:27], v[148:151], v[120:123], 0
    v_mfma_f32_16x16x32_bf16 v[28:31], v[148:151], v[124:127], 0
    s_waitcnt lgkmcnt(14)
    ds_read_b64_tr_b16 v[176:177], v204 offset:8736
    v_mfma_f32_16x16x32_bf16 v[32:35], v[152:155], v[112:115], 0
    s_waitcnt lgkmcnt(14)
    ds_read_b64_tr_b16 v[178:179], v204 offset:9824
    v_mfma_f32_16x16x32_bf16 v[36:39], v[152:155], v[116:119], 0
    s_waitcnt lgkmcnt(14)
    ds_read_b64_tr_b16 v[180:181], v204 offset:8768
    v_mfma_f32_16x16x32_bf16 v[40:43], v[152:155], v[120:123], 0
    s_waitcnt lgkmcnt(14)
    ds_read_b64_tr_b16 v[182:183], v204 offset:9856
    v_mfma_f32_16x16x32_bf16 v[44:47], v[152:155], v[124:127], 0
    s_waitcnt lgkmcnt(14)
    ds_read_b64_tr_b16 v[184:185], v204 offset:8800
    v_mfma_f32_16x16x32_bf16 v[48:51], v[156:159], v[112:115], 0
    s_waitcnt lgkmcnt(14)
    ds_read_b64_tr_b16 v[186:187], v204 offset:9888
    v_mfma_f32_16x16x32_bf16 v[52:55], v[156:159], v[116:119], 0
    v_mfma_f32_16x16x32_bf16 v[56:59], v[156:159], v[120:123], 0
    s_waitcnt lgkmcnt(14)
    ds_read_b64_tr_b16 v[188:189], v204 offset:8832
    v_mfma_f32_16x16x32_bf16 v[60:63], v[156:159], v[124:127], 0
    s_waitcnt lgkmcnt(14)
    ds_read_b64_tr_b16 v[190:191], v204 offset:9920
    v_mfma_f32_16x16x32_bf16 v[64:67], v[160:163], v[112:115], 0
    s_waitcnt lgkmcnt(14)
    ds_read_b64_tr_b16 v[192:193], v204 offset:8864
    v_mfma_f32_16x16x32_bf16 v[68:71], v[160:163], v[116:119], 0
    s_waitcnt lgkmcnt(14)
    ds_read_b64_tr_b16 v[194:195], v204 offset:9952
    v_mfma_f32_16x16x32_bf16 v[72:75], v[160:163], v[120:123], 0
    s_waitcnt lgkmcnt(14)
    ds_read_b64_tr_b16 v[196:197], v204 offset:8896
    v_mfma_f32_16x16x32_bf16 v[76:79], v[160:163], v[124:127], 0
    s_waitcnt lgkmcnt(14)
    ds_read_b64_tr_b16 v[198:199], v204 offset:9984
    v_mfma_f32_16x16x32_bf16 v[80:83], v[164:167], v[112:115], 0
    v_mfma_f32_16x16x32_bf16 v[84:87], v[164:167], v[116:119], 0
    v_mfma_f32_16x16x32_bf16 v[88:91], v[164:167], v[120:123], 0
    v_mfma_f32_16x16x32_bf16 v[92:95], v[164:167], v[124:127], 0
    v_mfma_f32_16x16x32_bf16 v[96:99], v[168:171], v[112:115], 0
    v_mfma_f32_16x16x32_bf16 v[100:103], v[168:171], v[116:119], 0
    s_waitcnt vmcnt(4) lgkmcnt(0)
    s_barrier
    s_setprio 1
    v_mfma_f32_16x16x32_bf16 v[104:107], v[168:171], v[120:123], 0
    v_mfma_f32_16x16x32_bf16 v[108:111], v[168:171], v[124:127], 0
    v_mfma_f32_16x16x32_bf16 v[0:3], v[172:175], v[128:131], v[0:3]
    s_cmp_eq_u32 s25, 1
    s_cbranch_scc1 cs_20
    s_cmp_eq_u32 s25, 2
    s_cbranch_scc1 cs_21
    s_cmp_eq_u32 s25, 3
    s_cbranch_scc1 cs_22
cs_19:
    v_mfma_f32_16x16x32_bf16 v[216:219], v[144:147], v[224:227], v[216:219]
    v_mfma_f32_16x16x32_bf16 v[216:219], v[172:175], v[224:227], v[216:219]
    v_mfma_f32_16x16x32_bf16 v[220:223], v[160:163], v[224:227], v[220:223]
    v_mfma_f32_16x16x32_bf16 v[220:223], v[188:191], v[224:227], v[220:223]
    s_branch csd_18
cs_20:
    v_mfma_f32_16x16x32_bf16 v[216:219], v[148:151], v[224:227], v[216:219]
    v_mfma_f32_16x16x32_bf16 v[216:219], v[176:179], v[224:227], v[216:219]
    v_mfma_f32_16x16x32_bf16 v[220:223], v[164:167], v[224:227], v[220:223]
    v_mfma_f32_16x16x32_bf16 v[220:223], v[192:195], v[224:227], v[220:223]
    s_branch csd_18
cs_21:
    v_mfma_f32_16x16x32_bf16 v[216:219], v[152:155], v[224:227], v[216:219]
    v_mfma_f32_16x16x32_bf16 v[216:219], v[180:183], v[224:227], v[216:219]
    v_mfma_f32_16x16x32_bf16 v[220:223], v[168:171], v[224:227], v[220:223]
    v_mfma_f32_16x16x32_bf16 v[220:223], v[196:199], v[224:227], v[220:223]
    s_branch csd_18
cs_22:
    v_mfma_f32_16x16x32_bf16 v[216:219], v[156:159], v[224:227], v[216:219]
    v_mfma_f32_16x16x32_bf16 v[216:219], v[184:187], v[224:227], v[216:219]
csd_18:
    ds_read_b128 v[112:115], v200 offset:32768
    s_add_u32 m0, s37, 122880
    s_nop 0
    buffer_load_dwordx4 v212, s[12:15], s17 offen offset:0 lds
    v_mfma_f32_16x16x32_bf16 v[4:7], v[172:175], v[132:135], v[4:7]
    ds_read_b64_tr_b16 v[144:145], v204 offset:17408
    v_mfma_f32_16x16x32_bf16 v[8:11], v[172:175], v[136:139], v[8:11]
    ds_read_b64_tr_b16 v[146:147], v204 offset:18496
    buffer_load_dwordx4 v213, s[12:15], s17 offen offset:1088 lds
    v_mfma_f32_16x16x32_bf16 v[12:15], v[172:175], v[140:143], v[12:15]
    v_mfma_f32_16x16x32_bf16 v[16:19], v[176:179], v[128:131], v[16:19]
    ds_read_b128 v[116:119], v200 offset:34816
    v_mfma_f32_16x16x32_bf16 v[20:23], v[176:179], v[132:135], v[20:23]
    ds_read_b128 v[120:123], v200 offset:36864
    buffer_load_dwordx4 v214, s[12:15], s17 offen offset:2176 lds
    v_mfma_f32_16x16x32_bf16 v[24:27], v[176:179], v[136:139], v[24:27]
    ds_read_b128 v[124:127], v200 offset:38912
    v_mfma_f32_16x16x32_bf16 v[28:31], v[176:179], v[140:143], v[28:31]
    v_mfma_f32_16x16x32_bf16 v[32:35], v[180:183], v[128:131], v[32:35]
    ds_read_b64_tr_b16 v[148:149], v204 offset:17440
    buffer_load_dwordx4 v215, s[12:15], s17 offen offset:3264 lds
    s_add_u32 s17, s17, 458752
    v_mfma_f32_16x16x32_bf16 v[36:39], v[180:183], v[132:135], v[36:39]
    ds_read_b64_tr_b16 v[150:151], v204 offset:18528
    v_mfma_f32_16x16x32_bf16 v[40:43], v[180:183], v[136:139], v[40:43]
    v_mfma_f32_16x16x32_bf16 v[44:47], v[180:183], v[140:143], v[44:47]
    ds_read_b64_tr_b16 v[152:153], v204 offset:17472
    s_add_u32 m0, s36, 0
    s_nop 0
    buffer_load_dwordx4 v208, s[8:11], s16 offen offset:0 lds
    v_mfma_f32_16x16x32_bf16 v[48:51], v[184:187], v[128:131], v[48:51]
    ds_read_b64_tr_b16 v[154:155], v204 offset:18560
    v_mfma_f32_16x16x32_bf16 v[52:55], v[184:187], v[132:135], v[52:55]
    ds_read_b64_tr_b16 v[156:157], v204 offset:17504
    v_mfma_f32_16x16x32_bf16 v[56:59], v[184:187], v[136:139], v[56:59]
    buffer_load_dwordx4 v209, s[8:11], s16 offen offset:1024 lds
    v_mfma_f32_16x16x32_bf16 v[60:63], v[184:187], v[140:143], v[60:63]
    ds_read_b64_tr_b16 v[158:159], v204 offset:18592
    v_mfma_f32_16x16x32_bf16 v[64:67], v[188:191], v[128:131], v[64:67]
    ds_read_b64_tr_b16 v[160:161], v204 offset:17536
    v_mfma_f32_16x16x32_bf16 v[68:71], v[188:191], v[132:135], v[68:71]
    buffer_load_dwordx4 v210, s[8:11], s16 offen offset:2048 lds
    v_mfma_f32_16x16x32_bf16 v[72:75], v[188:191], v[136:139], v[72:75]
    ds_read_b64_tr_b16 v[162:163], v204 offset:18624
    v_mfma_f32_16x16x32_bf16 v[76:79], v[188:191], v[140:143], v[76:79]
    ds_read_b64_tr_b16 v[164:165], v204 offset:17568
    v_mfma_f32_16x16x32_bf16 v[80:83], v[192:195], v[128:131], v[80:83]
    s_waitcnt lgkmcnt(14)
    ds_read_b64_tr_b16 v[166:167], v204 offset:18656
    buffer_load_dwordx4 v211, s[8:11], s16 offen offset:3072 lds
    s_add_u32 s16, s16, 128
    s_and_b32 s16, s16, 2047
    v_mfma_f32_16x16x32_bf16 v[84:87], v[192:195], v[132:135], v[84:87]
    v_mfma_f32_16x16x32_bf16 v[88:91], v[192:195], v[136:139], v[88:91]
    s_waitcnt lgkmcnt(14)
    ds_read_b64_tr_b16 v[168:169], v204 offset:17600
    s_setprio 0
    v_mfma_f32_16x16x32_bf16 v[92:95], v[192:195], v[140:143], v[92:95]
    s_waitcnt lgkmcnt(14)
    ds_read_b64_tr_b16 v[170:171], v204 offset:18688
    v_mfma_f32_16x16x32_bf16 v[96:99], v[196:199], v[128:131], v[96:99]
    v_mfma_f32_16x16x32_bf16 v[100:103], v[196:199], v[132:135], v[100:103]
    v_mfma_f32_16x16x32_bf16 v[104:107], v[196:199], v[136:139], v[104:107]
    v_mfma_f32_16x16x32_bf16 v[108:111], v[196:199], v[140:143], v[108:111]
    v_mfma_f32_16x16x32_bf16 v[0:3], v[144:147], v[112:115], v[0:3]
    s_waitcnt lgkmcnt(14)
    ds_read_b128 v[128:131], v201 offset:32768
    v_mfma_f32_16x16x32_bf16 v[4:7], v[144:147], v[116:119], v[4:7]
    s_waitcnt lgkmcnt(14)
    ds_read_b64_tr_b16 v[172:173], v204 offset:26112
    v_mfma_f32_16x16x32_bf16 v[8:11], v[144:147], v[120:123], v[8:11]
    s_waitcnt lgkmcnt(14)
    ds_read_b64_tr_b16 v[174:175], v204 offset:27200
    v_mfma_f32_16x16x32_bf16 v[12:15], v[144:147], v[124:127], v[12:15]
    s_waitcnt lgkmcnt(14)
    ds_read_b128 v[132:135], v201 offset:34816
    s_waitcnt lgkmcnt(14)
    v_mfma_f32_16x16x32_bf16 v[16:19], v[148:151], v[112:115], v[16:19]
    ds_read_b128 v[136:139], v201 offset:36864
    v_mfma_f32_16x16x32_bf16 v[20:23], v[148:151], v[116:119], v[20:23]
    s_waitcnt lgkmcnt(14)
    ds_read_b128 v[140:143], v201 offset:38912
    v_mfma_f32_16x16x32_bf16 v[24:27], v[148:151], v[120:123], v[24:27]
    v_mfma_f32_16x16x32_bf16 v[28:31], v[148:151], v[124:127], v[28:31]
    s_waitcnt lgkmcnt(14)
    ds_read_b64_tr_b16 v[176:177], v204 offset:26144
    v_mfma_f32_16x16x32_bf16 v[32:35], v[152:155], v[112:115], v[32:35]
    s_waitcnt lgkmcnt(14)
    ds_read_b64_tr_b16 v[178:179], v204 offset:27232
    v_mfma_f32_16x16x32_bf16 v[36:39], v[152:155], v[116:119], v[36:39]
    s_waitcnt lgkmcnt(14)
    ds_read_b64_tr_b16 v[180:181], v204 offset:26176
    v_mfma_f32_16x16x32_bf16 v[40:43], v[152:155], v[120:123], v[40:43]
    s_waitcnt lgkmcnt(14)
    ds_read_b64_tr_b16 v[182:183], v204 offset:27264
    v_mfma_f32_16x16x32_bf16 v[44:47], v[152:155], v[124:127], v[44:47]
    s_waitcnt lgkmcnt(14)
    ds_read_b64_tr_b16 v[184:185], v204 offset:26208
    v_mfma_f32_16x16x32_bf16 v[48:51], v[156:159], v[112:115], v[48:51]
    s_waitcnt lgkmcnt(14)
    ds_read_b64_tr_b16 v[186:187], v204 offset:27296
    v_mfma_f32_16x16x32_bf16 v[52:55], v[156:159], v[116:119], v[52:55]
    v_mfma_f32_16x16x32_bf16 v[56:59], v[156:159], v[120:123], v[56:59]
    s_waitcnt lgkmcnt(14)
    ds_read_b64_tr_b16 v[188:189], v204 offset:26240
    v_mfma_f32_16x16x32_bf16 v[60:63], v[156:159], v[124:127], v[60:63]
    s_waitcnt lgkmcnt(14)
    ds_read_b64_tr_b16 v[190:191], v204 offset:27328
    v_mfma_f32_16x16x32_bf16 v[64:67], v[160:163], v[112:115], v[64:67]
    s_waitcnt lgkmcnt(14)
    ds_read_b64_tr_b16 v[192:193], v204 offset:26272
    v_mfma_f32_16x16x32_bf16 v[68:71], v[160:163], v[116:119], v[68:71]
    s_waitcnt lgkmcnt(14)
    ds_read_b64_tr_b16 v[194:195], v204 offset:27360
    v_mfma_f32_16x16x32_bf16 v[72:75], v[160:163], v[120:123], v[72:75]
    s_waitcnt lgkmcnt(14)
    ds_read_b64_tr_b16 v[196:197], v204 offset:26304
    v_mfma_f32_16x16x32_bf16 v[76:79], v[160:163], v[124:127], v[76:79]
    s_waitcnt lgkmcnt(14)
    ds_read_b64_tr_b16 v[198:199], v204 offset:27392
    v_mfma_f32_16x16x32_bf16 v[80:83], v[164:167], v[112:115], v[80:83]
    v_mfma_f32_16x16x32_bf16 v[84:87], v[164:167], v[116:119], v[84:87]
    v_mfma_f32_16x16x32_bf16 v[88:91], v[164:167], v[120:123], v[88:91]
    v_mfma_f32_16x16x32_bf16 v[92:95], v[164:167], v[124:127], v[92:95]
    v_mfma_f32_16x16x32_bf16 v[96:99], v[168:171], v[112:115], v[96:99]
    v_mfma_f32_16x16x32_bf16 v[100:103], v[168:171], v[116:119], v[100:103]
    s_waitcnt vmcnt(4) lgkmcnt(0)
    s_barrier
    s_setprio 1
    v_mfma_f32_16x16x32_bf16 v[104:107], v[168:171], v[120:123], v[104:107]
    v_mfma_f32_16x16x32_bf16 v[108:111], v[168:171], v[124:127], v[108:111]
    v_mfma_f32_16x16x32_bf16 v[0:3], v[172:175], v[128:131], v[0:3]
    s_cmp_eq_u32 s25, 1
    s_cbranch_scc1 cs_25
    s_cmp_eq_u32 s25, 2
    s_cbranch_scc1 cs_26
    s_cmp_eq_u32 s25, 3
    s_cbranch_scc1 cs_27
cs_24:
    v_mfma_f32_16x16x32_bf16 v[216:219], v[144:147], v[224:227], v[216:219]
    v_mfma_f32_16x16x32_bf16 v[216:219], v[172:175], v[224:227], v[216:219]
    v_mfma_f32_16x16x32_bf16 v[220:223], v[160:163], v[224:227], v[220:223]
    v_mfma_f32_16x16x32_bf16 v[220:223], v[188:191], v[224:227], v[220:223]
    s_branch csd_23
cs_25:
    v_mfma_f32_16x16x32_bf16 v[216:219], v[148:151], v[224:227], v[216:219]
    v_mfma_f32_16x16x32_bf16 v[216:219], v[176:179], v[224:227], v[216:219]
    v_mfma_f32_16x16x32_bf16 v[220:223], v[164:167], v[224:227], v[220:223]
    v_mfma_f32_16x16x32_bf16 v[220:223], v[192:195], v[224:227], v[220:223]
    s_branch csd_23
cs_26:
    v_mfma_f32_16x16x32_bf16 v[216:219], v[152:155], v[224:227], v[216:219]
    v_mfma_f32_16x16x32_bf16 v[216:219], v[180:183], v[224:227], v[216:219]
    v_mfma_f32_16x16x32_bf16 v[220:223], v[168:171], v[224:227], v[220:223]
    v_mfma_f32_16x16x32_bf16 v[220:223], v[196:199], v[224:227], v[220:223]
    s_branch csd_23
cs_27:
    v_mfma_f32_16x16x32_bf16 v[216:219], v[156:159], v[224:227], v[216:219]
    v_mfma_f32_16x16x32_bf16 v[216:219], v[184:187], v[224:227], v[216:219]
csd_23:
    v_and_b32 v228, 3, v254
    v_lshrrev_b32 v229, 4, v254
    v_lshl_add_u32 v229, v229, 2, v228
    v_lshlrev_b32 v229, 5, v229
    s_lshl_b32 s59, s53, 13
    s_lshl_b32 s23, s25, 9
    s_add_u32 s59, s59, s23
    s_lshl_b32 s23, s52, 2
    s_add_u32 s59, s59, s23
    s_add_u32 s59, s59, 8458240
    s_nop 7
    v_cmp_eq_u32 vcc, 1, v228
    s_nop 1
    v_cndmask_b32 v216, v216, v217, vcc
    v_cndmask_b32 v220, v220, v221, vcc
    v_cmp_eq_u32 vcc, 2, v228
    s_nop 1
    v_cndmask_b32 v216, v216, v218, vcc
    v_cndmask_b32 v220, v220, v222, vcc
    v_cmp_eq_u32 vcc, 3, v228
    s_nop 1
    v_cndmask_b32 v216, v216, v219, vcc
    v_cndmask_b32 v220, v220, v223, vcc
    v_cvt_pk_bf16_f32 v217, v216, v216
    v_lshlrev_b32 v217, 16, v217
    v_sub_f32 v217, v216, v217
    v_cvt_pk_bf16_f32 v216, v216, v217
    v_cvt_pk_bf16_f32 v221, v220, v220
    v_lshlrev_b32 v221, 16, v221
    v_sub_f32 v221, v220, v221
    v_cvt_pk_bf16_f32 v220, v220, v221
    s_mov_b32 exec_lo, 0x000f000f
    s_mov_b32 exec_hi, 0x000f000f
    buffer_store_dword v216, v229, s[44:47], s59 offen offset:0 sc1
    buffer_store_dword v220, v229, s[44:47], s59 offen offset:2048 sc1
    s_mov_b64 exec, -1
    ds_read_b128 v[112:115], v202 offset:0
    s_add_u32 m0, s37, 140288
    s_nop 0
    buffer_load_dwordx4 v212, s[12:15], s17 offen offset:0 lds
    v_mfma_f32_16x16x32_bf16 v[4:7], v[172:175], v[132:135], v[4:7]
    ds_read_b64_tr_b16 v[144:145], v204 offset:0
    v_mfma_f32_16x16x32_bf16 v[8:11], v[172:175], v[136:139], v[8:11]
    ds_read_b64_tr_b16 v[146:147], v204 offset:1088
    buffer_load_dwordx4 v213, s[12:15], s17 offen offset:1088 lds
    v_mfma_f32_16x16x32_bf16 v[12:15], v[172:175], v[140:143], v[12:15]
    v_mfma_f32_16x16x32_bf16 v[16:19], v[176:179], v[128:131], v[16:19]
    ds_read_b128 v[116:119], v202 offset:2048
    v_mfma_f32_16x16x32_bf16 v[20:23], v[176:179], v[132:135], v[20:23]
    ds_read_b128 v[120:123], v202 offset:4096
    buffer_load_dwordx4 v214, s[12:15], s17 offen offset:2176 lds
    v_mfma_f32_16x16x32_bf16 v[24:27], v[176:179], v[136:139], v[24:27]
    ds_read_b128 v[124:127], v202 offset:6144
    v_mfma_f32_16x16x32_bf16 v[28:31], v[176:179], v[140:143], v[28:31]
    v_mfma_f32_16x16x32_bf16 v[32:35], v[180:183], v[128:131], v[32:35]
    ds_read_b64_tr_b16 v[148:149], v204 offset:32
    buffer_load_dwordx4 v215, s[12:15], s17 offen offset:3264 lds
    s_add_u32 s17, s17, 458752
    s_cmp_ge_u32 s17, 7340032
    s_cselect_b32 s17, s55, s17
    v_mfma_f32_16x16x32_bf16 v[36:39], v[180:183], v[132:135], v[36:39]
    ds_read_b64_tr_b16 v[150:151], v204 offset:1120
    v_mfma_f32_16x16x32_bf16 v[40:43], v[180:183], v[136:139], v[40:43]
    v_mfma_f32_16x16x32_bf16 v[44:47], v[180:183], v[140:143], v[44:47]
    ds_read_b64_tr_b16 v[152:153], v204 offset:64
    s_add_u32 m0, s36, 32768
    s_nop 0
    buffer_load_dwordx4 v208, s[8:11], s16 offen offset:0 lds
    v_mfma_f32_16x16x32_bf16 v[48:51], v[184:187], v[128:131], v[48:51]
    ds_read_b64_tr_b16 v[154:155], v204 offset:1152
    v_mfma_f32_16x16x32_bf16 v[52:55], v[184:187], v[132:135], v[52:55]
    ds_read_b64_tr_b16 v[156:157], v204 offset:96
    v_mfma_f32_16x16x32_bf16 v[56:59], v[184:187], v[136:139], v[56:59]
    buffer_load_dwordx4 v209, s[8:11], s16 offen offset:1024 lds
    v_mfma_f32_16x16x32_bf16 v[60:63], v[184:187], v[140:143], v[60:63]
    ds_read_b64_tr_b16 v[158:159], v204 offset:1184
    v_mfma_f32_16x16x32_bf16 v[64:67], v[188:191], v[128:131], v[64:67]
    ds_read_b64_tr_b16 v[160:161], v204 offset:128
    v_mfma_f32_16x16x32_bf16 v[68:71], v[188:191], v[132:135], v[68:71]
    buffer_load_dwordx4 v210, s[8:11], s16 offen offset:2048 lds
    v_mfma_f32_16x16x32_bf16 v[72:75], v[188:191], v[136:139], v[72:75]
    ds_read_b64_tr_b16 v[162:163], v204 offset:1216
    v_mfma_f32_16x16x32_bf16 v[76:79], v[188:191], v[140:143], v[76:79]
    ds_read_b64_tr_b16 v[164:165], v204 offset:160
    v_mfma_f32_16x16x32_bf16 v[80:83], v[192:195], v[128:131], v[80:83]
    s_waitcnt lgkmcnt(14)
    ds_read_b64_tr_b16 v[166:167], v204 offset:1248
    buffer_load_dwordx4 v211, s[8:11], s16 offen offset:3072 lds
    s_add_u32 s16, s16, 128
    s_and_b32 s16, s16, 2047
    v_mfma_f32_16x16x32_bf16 v[84:87], v[192:195], v[132:135], v[84:87]
    v_mfma_f32_16x16x32_bf16 v[88:91], v[192:195], v[136:139], v[88:91]
    s_waitcnt lgkmcnt(14)
    ds_read_b64_tr_b16 v[168:169], v204 offset:192
    s_setprio 0
    v_mfma_f32_16x16x32_bf16 v[92:95], v[192:195], v[140:143], v[92:95]
    s_waitcnt lgkmcnt(14)
    ds_read_b64_tr_b16 v[170:171], v204 offset:1280
    v_mfma_f32_16x16x32_bf16 v[96:99], v[196:199], v[128:131], v[96:99]
    v_mfma_f32_16x16x32_bf16 v[100:103], v[196:199], v[132:135], v[100:103]
    v_mfma_f32_16x16x32_bf16 v[104:107], v[196:199], v[136:139], v[104:107]
    v_mfma_f32_16x16x32_bf16 v[108:111], v[196:199], v[140:143], v[108:111]
    v_mfma_f32_16x16x32_bf16 v[0:3], v[144:147], v[112:115], v[0:3]
    s_waitcnt lgkmcnt(14)
    ds_read_b128 v[128:131], v203 offset:0
    v_mfma_f32_16x16x32_bf16 v[4:7], v[144:147], v[116:119], v[4:7]
    s_waitcnt lgkmcnt(14)
    ds_read_b64_tr_b16 v[172:173], v204 offset:8704
    v_mfma_f32_16x16x32_bf16 v[8:11], v[144:147], v[120:123], v[8:11]
    s_waitcnt lgkmcnt(14)
    ds_read_b64_tr_b16 v[174:175], v204 offset:9792
    v_mfma_f32_16x16x32_bf16 v[12:15], v[144:147], v[124:127], v[12:15]
    s_waitcnt lgkmcnt(14)
    ds_read_b128 v[132:135], v203 offset:2048
    s_waitcnt lgkmcnt(14)
    v_mfma_f32_16x16x32_bf16 v[16:19], v[148:151], v[112:115], v[16:19]
    ds_read_b128 v[136:139], v203 offset:4096
    v_mfma_f32_16x16x32_bf16 v[20:23], v[148:151], v[116:119], v[20:23]
    s_waitcnt lgkmcnt(14)
    ds_read_b128 v[140:143], v203 offset:6144
    v_mfma_f32_16x16x32_bf16 v[24:27], v[148:151], v[120:123], v[24:27]
    v_mfma_f32_16x16x32_bf16 v[28:31], v[148:151], v[124:127], v[28:31]
    s_waitcnt lgkmcnt(14)
    ds_read_b64_tr_b16 v[176:177], v204 offset:8736
    v_mfma_f32_16x16x32_bf16 v[32:35], v[152:155], v[112:115], v[32:35]
    s_waitcnt lgkmcnt(14)
    ds_read_b64_tr_b16 v[178:179], v204 offset:9824
    v_mfma_f32_16x16x32_bf16 v[36:39], v[152:155], v[116:119], v[36:39]
    s_waitcnt lgkmcnt(14)
    ds_read_b64_tr_b16 v[180:181], v204 offset:8768
    v_mfma_f32_16x16x32_bf16 v[40:43], v[152:155], v[120:123], v[40:43]
    s_waitcnt lgkmcnt(14)
    ds_read_b64_tr_b16 v[182:183], v204 offset:9856
    v_mfma_f32_16x16x32_bf16 v[44:47], v[152:155], v[124:127], v[44:47]
    s_waitcnt lgkmcnt(14)
    ds_read_b64_tr_b16 v[184:185], v204 offset:8800
    v_mfma_f32_16x16x32_bf16 v[48:51], v[156:159], v[112:115], v[48:51]
    s_waitcnt lgkmcnt(14)
    ds_read_b64_tr_b16 v[186:187], v204 offset:9888
    v_mfma_f32_16x16x32_bf16 v[52:55], v[156:159], v[116:119], v[52:55]
    v_mfma_f32_16x16x32_bf16 v[56:59], v[156:159], v[120:123], v[56:59]
    s_waitcnt lgkmcnt(14)
    ds_read_b64_tr_b16 v[188:189], v204 offset:8832
    v_mfma_f32_16x16x32_bf16 v[60:63], v[156:159], v[124:127], v[60:63]
    s_waitcnt lgkmcnt(14)
    ds_read_b64_tr_b16 v[190:191], v204 offset:9920
    v_mfma_f32_16x16x32_bf16 v[64:67], v[160:163], v[112:115], v[64:67]
    s_waitcnt lgkmcnt(14)
    ds_read_b64_tr_b16 v[192:193], v204 offset:8864
    v_mfma_f32_16x16x32_bf16 v[68:71], v[160:163], v[116:119], v[68:71]
    s_waitcnt lgkmcnt(14)
    ds_read_b64_tr_b16 v[194:195], v204 offset:9952
    v_mfma_f32_16x16x32_bf16 v[72:75], v[160:163], v[120:123], v[72:75]
    s_waitcnt lgkmcnt(14)
    ds_read_b64_tr_b16 v[196:197], v204 offset:8896
    v_mfma_f32_16x16x32_bf16 v[76:79], v[160:163], v[124:127], v[76:79]
    s_waitcnt lgkmcnt(14)
    ds_read_b64_tr_b16 v[198:199], v204 offset:9984
    v_mfma_f32_16x16x32_bf16 v[80:83], v[164:167], v[112:115], v[80:83]
    v_mfma_f32_16x16x32_bf16 v[84:87], v[164:167], v[116:119], v[84:87]
    v_mfma_f32_16x16x32_bf16 v[88:91], v[164:167], v[120:123], v[88:91]
    v_mfma_f32_16x16x32_bf16 v[92:95], v[164:167], v[124:127], v[92:95]
    v_mfma_f32_16x16x32_bf16 v[96:99], v[168:171], v[112:115], v[96:99]
    v_mfma_f32_16x16x32_bf16 v[100:103], v[168:171], v[116:119], v[100:103]
    s_waitcnt vmcnt(4) lgkmcnt(0)
    s_barrier
    s_setprio 1
    v_mfma_f32_16x16x32_bf16 v[104:107], v[168:171], v[120:123], v[104:107]
    v_mfma_f32_16x16x32_bf16 v[108:111], v[168:171], v[124:127], v[108:111]
    v_mfma_f32_16x16x32_bf16 v[0:3], v[172:175], v[128:131], v[0:3]
    ds_read_b128 v[112:115], v200 offset:0
    s_add_u32 m0, s37, 122880
    s_nop 0
    buffer_load_dwordx4 v212, s[12:15], s17 offen offset:0 lds
    v_mfma_f32_16x16x32_bf16 v[4:7], v[172:175], v[132:135], v[4:7]
    ds_read_b64_tr_b16 v[144:145], v204 offset:17408
    v_mfma_f32_16x16x32_bf16 v[8:11], v[172:175], v[136:139], v[8:11]
    ds_read_b64_tr_b16 v[146:147], v204 offset:18496
    buffer_load_dwordx4 v213, s[12:15], s17 offen offset:1088 lds
    v_mfma_f32_16x16x32_bf16 v[12:15], v[172:175], v[140:143], v[12:15]
    v_mfma_f32_16x16x32_bf16 v[16:19], v[176:179], v[128:131], v[16:19]
    ds_read_b128 v[116:119], v200 offset:2048
    v_mfma_f32_16x16x32_bf16 v[20:23], v[176:179], v[132:135], v[20:23]
    ds_read_b128 v[120:123], v200 offset:4096
    buffer_load_dwordx4 v214, s[12:15], s17 offen offset:2176 lds
    v_mfma_f32_16x16x32_bf16 v[24:27], v[176:179], v[136:139], v[24:27]
    ds_read_b128 v[124:127], v200 offset:6144
    v_mfma_f32_16x16x32_bf16 v[28:31], v[176:179], v[140:143], v[28:31]
    v_mfma_f32_16x16x32_bf16 v[32:35], v[180:183], v[128:131], v[32:35]
    ds_read_b64_tr_b16 v[148:149], v204 offset:17440
    buffer_load_dwordx4 v215, s[12:15], s17 offen offset:3264 lds
    s_add_u32 s17, s17, 458752
    v_mfma_f32_16x16x32_bf16 v[36:39], v[180:183], v[132:135], v[36:39]
    ds_read_b64_tr_b16 v[150:151], v204 offset:18528
    v_mfma_f32_16x16x32_bf16 v[40:43], v[180:183], v[136:139], v[40:43]
    v_mfma_f32_16x16x32_bf16 v[44:47], v[180:183], v[140:143], v[44:47]
    ds_read_b64_tr_b16 v[152:153], v204 offset:17472
    s_add_u32 m0, s36, 65536
    s_nop 0
    buffer_load_dwordx4 v208, s[8:11], s16 offen offset:0 lds
    v_mfma_f32_16x16x32_bf16 v[48:51], v[184:187], v[128:131], v[48:51]
    ds_read_b64_tr_b16 v[154:155], v204 offset:18560
    v_mfma_f32_16x16x32_bf16 v[52:55], v[184:187], v[132:135], v[52:55]
    ds_read_b64_tr_b16 v[156:157], v204 offset:17504
    v_mfma_f32_16x16x32_bf16 v[56:59], v[184:187], v[136:139], v[56:59]
    buffer_load_dwordx4 v209, s[8:11], s16 offen offset:1024 lds
    v_mfma_f32_16x16x32_bf16 v[60:63], v[184:187], v[140:143], v[60:63]
    ds_read_b64_tr_b16 v[158:159], v204 offset:18592
    v_mfma_f32_16x16x32_bf16 v[64:67], v[188:191], v[128:131], v[64:67]
    ds_read_b64_tr_b16 v[160:161], v204 offset:17536
    v_mfma_f32_16x16x32_bf16 v[68:71], v[188:191], v[132:135], v[68:71]
    buffer_load_dwordx4 v210, s[8:11], s16 offen offset:2048 lds
    v_mfma_f32_16x16x32_bf16 v[72:75], v[188:191], v[136:139], v[72:75]
    ds_read_b64_tr_b16 v[162:163], v204 offset:18624
    v_mfma_f32_16x16x32_bf16 v[76:79], v[188:191], v[140:143], v[76:79]
    ds_read_b64_tr_b16 v[164:165], v204 offset:17568
    v_mfma_f32_16x16x32_bf16 v[80:83], v[192:195], v[128:131], v[80:83]
    s_waitcnt lgkmcnt(14)
    ds_read_b64_tr_b16 v[166:167], v204 offset:18656
    buffer_load_dwordx4 v211, s[8:11], s16 offen offset:3072 lds
    s_add_u32 s16, s16, 128
    s_and_b32 s16, s16, 2047
    v_mfma_f32_16x16x32_bf16 v[84:87], v[192:195], v[132:135], v[84:87]
    v_mfma_f32_16x16x32_bf16 v[88:91], v[192:195], v[136:139], v[88:91]
    s_waitcnt lgkmcnt(14)
    ds_read_b64_tr_b16 v[168:169], v204 offset:17600
    s_setprio 0
    v_mfma_f32_16x16x32_bf16 v[92:95], v[192:195], v[140:143], v[92:95]
    s_waitcnt lgkmcnt(14)
    ds_read_b64_tr_b16 v[170:171], v204 offset:18688
    v_mfma_f32_16x16x32_bf16 v[96:99], v[196:199], v[128:131], v[96:99]
    v_mfma_f32_16x16x32_bf16 v[100:103], v[196:199], v[132:135], v[100:103]
    v_mfma_f32_16x16x32_bf16 v[104:107], v[196:199], v[136:139], v[104:107]
    v_mfma_f32_16x16x32_bf16 v[108:111], v[196:199], v[140:143], v[108:111]
    v_mfma_f32_16x16x32_bf16 v[0:3], v[144:147], v[112:115], v[0:3]
    s_waitcnt lgkmcnt(14)
    ds_read_b128 v[128:131], v201 offset:0
    v_mfma_f32_16x16x32_bf16 v[4:7], v[144:147], v[116:119], v[4:7]
    s_waitcnt lgkmcnt(14)
    ds_read_b64_tr_b16 v[172:173], v204 offset:26112
    v_mfma_f32_16x16x32_bf16 v[8:11], v[144:147], v[120:123], v[8:11]
    s_waitcnt lgkmcnt(14)
    ds_read_b64_tr_b16 v[174:175], v204 offset:27200
    v_mfma_f32_16x16x32_bf16 v[12:15], v[144:147], v[124:127], v[12:15]
    s_waitcnt lgkmcnt(14)
    ds_read_b128 v[132:135], v201 offset:2048
    s_waitcnt lgkmcnt(14)
    v_mfma_f32_16x16x32_bf16 v[16:19], v[148:151], v[112:115], v[16:19]
    ds_read_b128 v[136:139], v201 offset:4096
    v_mfma_f32_16x16x32_bf16 v[20:23], v[148:151], v[116:119], v[20:23]
    s_waitcnt lgkmcnt(14)
    ds_read_b128 v[140:143], v201 offset:6144
    v_mfma_f32_16x16x32_bf16 v[24:27], v[148:151], v[120:123], v[24:27]
    v_mfma_f32_16x16x32_bf16 v[28:31], v[148:151], v[124:127], v[28:31]
    s_waitcnt lgkmcnt(14)
    ds_read_b64_tr_b16 v[176:177], v204 offset:26144
    v_mfma_f32_16x16x32_bf16 v[32:35], v[152:155], v[112:115], v[32:35]
    s_waitcnt lgkmcnt(14)
    ds_read_b64_tr_b16 v[178:179], v204 offset:27232
    v_mfma_f32_16x16x32_bf16 v[36:39], v[152:155], v[116:119], v[36:39]
    s_waitcnt lgkmcnt(14)
    ds_read_b64_tr_b16 v[180:181], v204 offset:26176
    v_mfma_f32_16x16x32_bf16 v[40:43], v[152:155], v[120:123], v[40:43]
    s_waitcnt lgkmcnt(14)
    ds_read_b64_tr_b16 v[182:183], v204 offset:27264
    v_mfma_f32_16x16x32_bf16 v[44:47], v[152:155], v[124:127], v[44:47]
    s_waitcnt lgkmcnt(14)
    ds_read_b64_tr_b16 v[184:185], v204 offset:26208
    v_mfma_f32_16x16x32_bf16 v[48:51], v[156:159], v[112:115], v[48:51]
    s_waitcnt lgkmcnt(14)
    ds_read_b64_tr_b16 v[186:187], v204 offset:27296
    v_mfma_f32_16x16x32_bf16 v[52:55], v[156:159], v[116:119], v[52:55]
    v_mfma_f32_16x16x32_bf16 v[56:59], v[156:159], v[120:123], v[56:59]
    s_waitcnt lgkmcnt(14)
    ds_read_b64_tr_b16 v[188:189], v204 offset:26240
    v_mfma_f32_16x16x32_bf16 v[60:63], v[156:159], v[124:127], v[60:63]
    s_waitcnt lgkmcnt(14)
    ds_read_b64_tr_b16 v[190:191], v204 offset:27328
    v_mfma_f32_16x16x32_bf16 v[64:67], v[160:163], v[112:115], v[64:67]
    s_waitcnt lgkmcnt(14)
    ds_read_b64_tr_b16 v[192:193], v204 offset:26272
    v_mfma_f32_16x16x32_bf16 v[68:71], v[160:163], v[116:119], v[68:71]
    s_waitcnt lgkmcnt(14)
    ds_read_b64_tr_b16 v[194:195], v204 offset:27360
    v_mfma_f32_16x16x32_bf16 v[72:75], v[160:163], v[120:123], v[72:75]
    s_waitcnt lgkmcnt(14)
    ds_read_b64_tr_b16 v[196:197], v204 offset:26304
    v_mfma_f32_16x16x32_bf16 v[76:79], v[160:163], v[124:127], v[76:79]
    s_waitcnt lgkmcnt(14)
    ds_read_b64_tr_b16 v[198:199], v204 offset:27392
    v_mfma_f32_16x16x32_bf16 v[80:83], v[164:167], v[112:115], v[80:83]
    v_mfma_f32_16x16x32_bf16 v[84:87], v[164:167], v[116:119], v[84:87]
    v_mfma_f32_16x16x32_bf16 v[88:91], v[164:167], v[120:123], v[88:91]
    v_mfma_f32_16x16x32_bf16 v[92:95], v[164:167], v[124:127], v[92:95]
    v_mfma_f32_16x16x32_bf16 v[96:99], v[168:171], v[112:115], v[96:99]
    v_mfma_f32_16x16x32_bf16 v[100:103], v[168:171], v[116:119], v[100:103]
    s_waitcnt vmcnt(4) lgkmcnt(0)
    s_barrier
    s_setprio 1
    v_mfma_f32_16x16x32_bf16 v[104:107], v[168:171], v[120:123], v[104:107]
    v_mfma_f32_16x16x32_bf16 v[108:111], v[168:171], v[124:127], v[108:111]
    v_mfma_f32_16x16x32_bf16 v[0:3], v[172:175], v[128:131], v[0:3]
    ds_read_b128 v[112:115], v200 offset:32768
    s_add_u32 m0, s37, 140288
    s_nop 0
    buffer_load_dwordx4 v212, s[12:15], s17 offen offset:0 lds
    v_mfma_f32_16x16x32_bf16 v[4:7], v[172:175], v[132:135], v[4:7]
    ds_read_b64_tr_b16 v[144:145], v204 offset:0
    v_mfma_f32_16x16x32_bf16 v[8:11], v[172:175], v[136:139], v[8:11]
    ds_read_b64_tr_b16 v[146:147], v204 offset:1088
    buffer_load_dwordx4 v213, s[12:15], s17 offen offset:1088 lds
    v_mfma_f32_16x16x32_bf16 v[12:15], v[172:175], v[140:143], v[12:15]
    v_mfma_f32_16x16x32_bf16 v[16:19], v[176:179], v[128:131], v[16:19]
    ds_read_b128 v[116:119], v200 offset:34816
    v_mfma_f32_16x16x32_bf16 v[20:23], v[176:179], v[132:135], v[20:23]
    ds_read_b128 v[120:123], v200 offset:36864
    buffer_load_dwordx4 v214, s[12:15], s17 offen offset:2176 lds
    v_mfma_f32_16x16x32_bf16 v[24:27], v[176:179], v[136:139], v[24:27]
    ds_read_b128 v[124:127], v200 offset:38912
    v_mfma_f32_16x16x32_bf16 v[28:31], v[176:179], v[140:143], v[28:31]
    v_mfma_f32_16x16x32_bf16 v[32:35], v[180:183], v[128:131], v[32:35]
    ds_read_b64_tr_b16 v[148:149], v204 offset:32
    buffer_load_dwordx4 v215, s[12:15], s17 offen offset:3264 lds
    s_add_u32 s17, s17, 458752
    s_cmp_ge_u32 s17, 7340032
    s_cselect_b32 s17, s55, s17
    v_mfma_f32_16x16x32_bf16 v[36:39], v[180:183], v[132:135], v[36:39]
    ds_read_b64_tr_b16 v[150:151], v204 offset:1120
    v_mfma_f32_16x16x32_bf16 v[40:43], v[180:183], v[136:139], v[40:43]
    v_mfma_f32_16x16x32_bf16 v[44:47], v[180:183], v[140:143], v[44:47]
    ds_read_b64_tr_b16 v[152:153], v204 offset:64
    s_add_u32 m0, s36, 0
    s_nop 0
    buffer_load_dwordx4 v208, s[8:11], s16 offen offset:0 lds
    v_mfma_f32_16x16x32_bf16 v[48:51], v[184:187], v[128:131], v[48:51]
    ds_read_b64_tr_b16 v[154:155], v204 offset:1152
    v_mfma_f32_16x16x32_bf16 v[52:55], v[184:187], v[132:135], v[52:55]
    ds_read_b64_tr_b16 v[156:157], v204 offset:96
    v_mfma_f32_16x16x32_bf16 v[56:59], v[184:187], v[136:139], v[56:59]
    buffer_load_dwordx4 v209, s[8:11], s16 offen offset:1024 lds
    v_mfma_f32_16x16x32_bf16 v[60:63], v[184:187], v[140:143], v[60:63]
    ds_read_b64_tr_b16 v[158:159], v204 offset:1184
    v_mfma_f32_16x16x32_bf16 v[64:67], v[188:191], v[128:131], v[64:67]
    ds_read_b64_tr_b16 v[160:161], v204 offset:128
    v_mfma_f32_16x16x32_bf16 v[68:71], v[188:191], v[132:135], v[68:71]
    buffer_load_dwordx4 v210, s[8:11], s16 offen offset:2048 lds
    v_mfma_f32_16x16x32_bf16 v[72:75], v[188:191], v[136:139], v[72:75]
    ds_read_b64_tr_b16 v[162:163], v204 offset:1216
    v_mfma_f32_16x16x32_bf16 v[76:79], v[188:191], v[140:143], v[76:79]
    ds_read_b64_tr_b16 v[164:165], v204 offset:160
    v_mfma_f32_16x16x32_bf16 v[80:83], v[192:195], v[128:131], v[80:83]
    s_waitcnt lgkmcnt(14)
    ds_read_b64_tr_b16 v[166:167], v204 offset:1248
    buffer_load_dwordx4 v211, s[8:11], s16 offen offset:3072 lds
    s_add_u32 s16, s16, 128
    s_and_b32 s16, s16, 2047
    v_mfma_f32_16x16x32_bf16 v[84:87], v[192:195], v[132:135], v[84:87]
    v_mfma_f32_16x16x32_bf16 v[88:91], v[192:195], v[136:139], v[88:91]
    s_waitcnt lgkmcnt(14)
    ds_read_b64_tr_b16 v[168:169], v204 offset:192
    s_setprio 0
    v_mfma_f32_16x16x32_bf16 v[92:95], v[192:195], v[140:143], v[92:95]
    s_waitcnt lgkmcnt(14)
    ds_read_b64_tr_b16 v[170:171], v204 offset:1280
    v_mfma_f32_16x16x32_bf16 v[96:99], v[196:199], v[128:131], v[96:99]
    v_mfma_f32_16x16x32_bf16 v[100:103], v[196:199], v[132:135], v[100:103]
    v_mfma_f32_16x16x32_bf16 v[104:107], v[196:199], v[136:139], v[104:107]
    v_mfma_f32_16x16x32_bf16 v[108:111], v[196:199], v[140:143], v[108:111]
    v_mfma_f32_16x16x32_bf16 v[0:3], v[144:147], v[112:115], v[0:3]
    s_waitcnt lgkmcnt(14)
    ds_read_b128 v[128:131], v201 offset:32768
    v_mfma_f32_16x16x32_bf16 v[4:7], v[144:147], v[116:119], v[4:7]
    s_waitcnt lgkmcnt(14)
    ds_read_b64_tr_b16 v[172:173], v204 offset:8704
    v_mfma_f32_16x16x32_bf16 v[8:11], v[144:147], v[120:123], v[8:11]
    s_waitcnt lgkmcnt(14)
    ds_read_b64_tr_b16 v[174:175], v204 offset:9792
    v_mfma_f32_16x16x32_bf16 v[12:15], v[144:147], v[124:127], v[12:15]
    s_waitcnt lgkmcnt(14)
    ds_read_b128 v[132:135], v201 offset:34816
    s_waitcnt lgkmcnt(14)
    v_mfma_f32_16x16x32_bf16 v[16:19], v[148:151], v[112:115], v[16:19]
    ds_read_b128 v[136:139], v201 offset:36864
    v_mfma_f32_16x16x32_bf16 v[20:23], v[148:151], v[116:119], v[20:23]
    s_waitcnt lgkmcnt(14)
    ds_read_b128 v[140:143], v201 offset:38912
    v_mfma_f32_16x16x32_bf16 v[24:27], v[148:151], v[120:123], v[24:27]
    v_mfma_f32_16x16x32_bf16 v[28:31], v[148:151], v[124:127], v[28:31]
    s_waitcnt lgkmcnt(14)
    ds_read_b64_tr_b16 v[176:177], v204 offset:8736
    v_mfma_f32_16x16x32_bf16 v[32:35], v[152:155], v[112:115], v[32:35]
    s_waitcnt lgkmcnt(14)
    ds_read_b64_tr_b16 v[178:179], v204 offset:9824
    v_mfma_f32_16x16x32_bf16 v[36:39], v[152:155], v[116:119], v[36:39]
    s_waitcnt lgkmcnt(14)
    ds_read_b64_tr_b16 v[180:181], v204 offset:8768
    v_mfma_f32_16x16x32_bf16 v[40:43], v[152:155], v[120:123], v[40:43]
    s_waitcnt lgkmcnt(14)
    ds_read_b64_tr_b16 v[182:183], v204 offset:9856
    v_mfma_f32_16x16x32_bf16 v[44:47], v[152:155], v[124:127], v[44:47]
    s_waitcnt lgkmcnt(14)
    ds_read_b64_tr_b16 v[184:185], v204 offset:8800
    v_mfma_f32_16x16x32_bf16 v[48:51], v[156:159], v[112:115], v[48:51]
    s_waitcnt lgkmcnt(14)
    ds_read_b64_tr_b16 v[186:187], v204 offset:9888
    v_mfma_f32_16x16x32_bf16 v[52:55], v[156:159], v[116:119], v[52:55]
    v_mfma_f32_16x16x32_bf16 v[56:59], v[156:159], v[120:123], v[56:59]
    s_waitcnt lgkmcnt(14)
    ds_read_b64_tr_b16 v[188:189], v204 offset:8832
    v_mfma_f32_16x16x32_bf16 v[60:63], v[156:159], v[124:127], v[60:63]
    s_waitcnt lgkmcnt(14)
    ds_read_b64_tr_b16 v[190:191], v204 offset:9920
    v_mfma_f32_16x16x32_bf16 v[64:67], v[160:163], v[112:115], v[64:67]
    s_waitcnt lgkmcnt(14)
    ds_read_b64_tr_b16 v[192:193], v204 offset:8864
    v_mfma_f32_16x16x32_bf16 v[68:71], v[160:163], v[116:119], v[68:71]
    s_waitcnt lgkmcnt(14)
    ds_read_b64_tr_b16 v[194:195], v204 offset:9952
    v_mfma_f32_16x16x32_bf16 v[72:75], v[160:163], v[120:123], v[72:75]
    s_waitcnt lgkmcnt(14)
    ds_read_b64_tr_b16 v[196:197], v204 offset:8896
    v_mfma_f32_16x16x32_bf16 v[76:79], v[160:163], v[124:127], v[76:79]
    s_waitcnt lgkmcnt(14)
    ds_read_b64_tr_b16 v[198:199], v204 offset:9984
    v_mfma_f32_16x16x32_bf16 v[80:83], v[164:167], v[112:115], v[80:83]
    v_mfma_f32_16x16x32_bf16 v[84:87], v[164:167], v[116:119], v[84:87]
    v_mfma_f32_16x16x32_bf16 v[88:91], v[164:167], v[120:123], v[88:91]
    v_mfma_f32_16x16x32_bf16 v[92:95], v[164:167], v[124:127], v[92:95]
    v_mfma_f32_16x16x32_bf16 v[96:99], v[168:171], v[112:115], v[96:99]
    v_mfma_f32_16x16x32_bf16 v[100:103], v[168:171], v[116:119], v[100:103]
    s_waitcnt vmcnt(4) lgkmcnt(0)
    s_barrier
    s_setprio 1
    v_mfma_f32_16x16x32_bf16 v[104:107], v[168:171], v[120:123], v[104:107]
    v_mfma_f32_16x16x32_bf16 v[108:111], v[168:171], v[124:127], v[108:111]
    v_mfma_f32_16x16x32_bf16 v[0:3], v[172:175], v[128:131], v[0:3]
    ds_read_b128 v[112:115], v202 offset:0
    s_add_u32 m0, s37, 122880
    s_nop 0
    buffer_load_dwordx4 v212, s[12:15], s17 offen offset:0 lds
    v_mfma_f32_16x16x32_bf16 v[4:7], v[172:175], v[132:135], v[4:7]
    ds_read_b64_tr_b16 v[144:145], v204 offset:17408
    v_mfma_f32_16x16x32_bf16 v[8:11], v[172:175], v[136:139], v[8:11]
    ds_read_b64_tr_b16 v[146:147], v204 offset:18496
    buffer_load_dwordx4 v213, s[12:15], s17 offen offset:1088 lds
    v_mfma_f32_16x16x32_bf16 v[12:15], v[172:175], v[140:143], v[12:15]
    v_mfma_f32_16x16x32_bf16 v[16:19], v[176:179], v[128:131], v[16:19]
    ds_read_b128 v[116:119], v202 offset:2048
    v_mfma_f32_16x16x32_bf16 v[20:23], v[176:179], v[132:135], v[20:23]
    ds_read_b128 v[120:123], v202 offset:4096
    buffer_load_dwordx4 v214, s[12:15], s17 offen offset:2176 lds
    v_mfma_f32_16x16x32_bf16 v[24:27], v[176:179], v[136:139], v[24:27]
    ds_read_b128 v[124:127], v202 offset:6144
    v_mfma_f32_16x16x32_bf16 v[28:31], v[176:179], v[140:143], v[28:31]
    v_mfma_f32_16x16x32_bf16 v[32:35], v[180:183], v[128:131], v[32:35]
    ds_read_b64_tr_b16 v[148:149], v204 offset:17440
    buffer_load_dwordx4 v215, s[12:15], s17 offen offset:3264 lds
    s_add_u32 s17, s17, 458752
    v_mfma_f32_16x16x32_bf16 v[36:39], v[180:183], v[132:135], v[36:39]
    ds_read_b64_tr_b16 v[150:151], v204 offset:18528
    v_mfma_f32_16x16x32_bf16 v[40:43], v[180:183], v[136:139], v[40:43]
    v_mfma_f32_16x16x32_bf16 v[44:47], v[180:183], v[140:143], v[44:47]
    ds_read_b64_tr_b16 v[152:153], v204 offset:17472
    s_add_u32 m0, s36, 32768
    s_nop 0
    buffer_load_dwordx4 v208, s[8:11], s16 offen offset:0 lds
    v_mfma_f32_16x16x32_bf16 v[48:51], v[184:187], v[128:131], v[48:51]
    ds_read_b64_tr_b16 v[154:155], v204 offset:18560
    v_mfma_f32_16x16x32_bf16 v[52:55], v[184:187], v[132:135], v[52:55]
    ds_read_b64_tr_b16 v[156:157], v204 offset:17504
    v_mfma_f32_16x16x32_bf16 v[56:59], v[184:187], v[136:139], v[56:59]
    buffer_load_dwordx4 v209, s[8:11], s16 offen offset:1024 lds
    v_mfma_f32_16x16x32_bf16 v[60:63], v[184:187], v[140:143], v[60:63]
    ds_read_b64_tr_b16 v[158:159], v204 offset:18592
    v_mfma_f32_16x16x32_bf16 v[64:67], v[188:191], v[128:131], v[64:67]
    ds_read_b64_tr_b16 v[160:161], v204 offset:17536
    v_mfma_f32_16x16x32_bf16 v[68:71], v[188:191], v[132:135], v[68:71]
    buffer_load_dwordx4 v210, s[8:11], s16 offen offset:2048 lds
    v_mfma_f32_16x16x32_bf16 v[72:75], v[188:191], v[136:139], v[72:75]
    ds_read_b64_tr_b16 v[162:163], v204 offset:18624
    v_mfma_f32_16x16x32_bf16 v[76:79], v[188:191], v[140:143], v[76:79]
    ds_read_b64_tr_b16 v[164:165], v204 offset:17568
    v_mfma_f32_16x16x32_bf16 v[80:83], v[192:195], v[128:131], v[80:83]
    s_waitcnt lgkmcnt(14)
    ds_read_b64_tr_b16 v[166:167], v204 offset:18656
    buffer_load_dwordx4 v211, s[8:11], s16 offen offset:3072 lds
    s_add_u32 s16, s16, 128
    s_and_b32 s16, s16, 2047
    v_mfma_f32_16x16x32_bf16 v[84:87], v[192:195], v[132:135], v[84:87]
    v_mfma_f32_16x16x32_bf16 v[88:91], v[192:195], v[136:139], v[88:91]
    s_waitcnt lgkmcnt(14)
    ds_read_b64_tr_b16 v[168:169], v204 offset:17600
    s_setprio 0
    v_mfma_f32_16x16x32_bf16 v[92:95], v[192:195], v[140:143], v[92:95]
    s_waitcnt lgkmcnt(14)
    ds_read_b64_tr_b16 v[170:171], v204 offset:18688
    v_mfma_f32_16x16x32_bf16 v[96:99], v[196:199], v[128:131], v[96:99]
    v_mfma_f32_16x16x32_bf16 v[100:103], v[196:199], v[132:135], v[100:103]
    v_mfma_f32_16x16x32_bf16 v[104:107], v[196:199], v[136:139], v[104:107]
    v_mfma_f32_16x16x32_bf16 v[108:111], v[196:199], v[140:143], v[108:111]
    v_mfma_f32_16x16x32_bf16 v[0:3], v[144:147], v[112:115], v[0:3]
    s_waitcnt lgkmcnt(14)
    ds_read_b128 v[128:131], v203 offset:0
    v_mfma_f32_16x16x32_bf16 v[4:7], v[144:147], v[116:119], v[4:7]
    s_waitcnt lgkmcnt(14)
    ds_read_b64_tr_b16 v[172:173], v204 offset:26112
    v_mfma_f32_16x16x32_bf16 v[8:11], v[144:147], v[120:123], v[8:11]
    s_waitcnt lgkmcnt(14)
    ds_read_b64_tr_b16 v[174:175], v204 offset:27200
    v_mfma_f32_16x16x32_bf16 v[12:15], v[144:147], v[124:127], v[12:15]
    s_waitcnt lgkmcnt(14)
    ds_read_b128 v[132:135], v203 offset:2048
    s_waitcnt lgkmcnt(14)
    v_mfma_f32_16x16x32_bf16 v[16:19], v[148:151], v[112:115], v[16:19]
    ds_read_b128 v[136:139], v203 offset:4096
    v_mfma_f32_16x16x32_bf16 v[20:23], v[148:151], v[116:119], v[20:23]
    s_waitcnt lgkmcnt(14)
    ds_read_b128 v[140:143], v203 offset:6144
    v_mfma_f32_16x16x32_bf16 v[24:27], v[148:151], v[120:123], v[24:27]
    v_mfma_f32_16x16x32_bf16 v[28:31], v[148:151], v[124:127], v[28:31]
    s_waitcnt lgkmcnt(14)
    ds_read_b64_tr_b16 v[176:177], v204 offset:26144
    v_mfma_f32_16x16x32_bf16 v[32:35], v[152:155], v[112:115], v[32:35]
    s_waitcnt lgkmcnt(14)
    ds_read_b64_tr_b16 v[178:179], v204 offset:27232
    v_mfma_f32_16x16x32_bf16 v[36:39], v[152:155], v[116:119], v[36:39]
    s_waitcnt lgkmcnt(14)
    ds_read_b64_tr_b16 v[180:181], v204 offset:26176
    v_mfma_f32_16x16x32_bf16 v[40:43], v[152:155], v[120:123], v[40:43]
    s_waitcnt lgkmcnt(14)
    ds_read_b64_tr_b16 v[182:183], v204 offset:27264
    v_mfma_f32_16x16x32_bf16 v[44:47], v[152:155], v[124:127], v[44:47]
    s_waitcnt lgkmcnt(14)
    ds_read_b64_tr_b16 v[184:185], v204 offset:26208
    v_mfma_f32_16x16x32_bf16 v[48:51], v[156:159], v[112:115], v[48:51]
    s_waitcnt lgkmcnt(14)
    ds_read_b64_tr_b16 v[186:187], v204 offset:27296
    v_mfma_f32_16x16x32_bf16 v[52:55], v[156:159], v[116:119], v[52:55]
    v_mfma_f32_16x16x32_bf16 v[56:59], v[156:159], v[120:123], v[56:59]
    s_waitcnt lgkmcnt(14)
    ds_read_b64_tr_b16 v[188:189], v204 offset:26240
    v_mfma_f32_16x16x32_bf16 v[60:63], v[156:159], v[124:127], v[60:63]
    s_waitcnt lgkmcnt(14)
    ds_read_b64_tr_b16 v[190:191], v204 offset:27328
    v_mfma_f32_16x16x32_bf16 v[64:67], v[160:163], v[112:115], v[64:67]
    s_waitcnt lgkmcnt(14)
    ds_read_b64_tr_b16 v[192:193], v204 offset:26272
    v_mfma_f32_16x16x32_bf16 v[68:71], v[160:163], v[116:119], v[68:71]
    s_waitcnt lgkmcnt(14)
    ds_read_b64_tr_b16 v[194:195], v204 offset:27360
    v_mfma_f32_16x16x32_bf16 v[72:75], v[160:163], v[120:123], v[72:75]
    s_waitcnt lgkmcnt(14)
    ds_read_b64_tr_b16 v[196:197], v204 offset:26304
    v_mfma_f32_16x16x32_bf16 v[76:79], v[160:163], v[124:127], v[76:79]
    s_waitcnt lgkmcnt(14)
    ds_read_b64_tr_b16 v[198:199], v204 offset:27392
    v_mfma_f32_16x16x32_bf16 v[80:83], v[164:167], v[112:115], v[80:83]
    v_mfma_f32_16x16x32_bf16 v[84:87], v[164:167], v[116:119], v[84:87]
    v_mfma_f32_16x16x32_bf16 v[88:91], v[164:167], v[120:123], v[88:91]
    v_mfma_f32_16x16x32_bf16 v[92:95], v[164:167], v[124:127], v[92:95]
    v_mfma_f32_16x16x32_bf16 v[96:99], v[168:171], v[112:115], v[96:99]
    v_mfma_f32_16x16x32_bf16 v[100:103], v[168:171], v[116:119], v[100:103]
    s_waitcnt vmcnt(4) lgkmcnt(0)
    s_barrier
    s_setprio 1
    v_mfma_f32_16x16x32_bf16 v[104:107], v[168:171], v[120:123], v[104:107]
    v_mfma_f32_16x16x32_bf16 v[108:111], v[168:171], v[124:127], v[108:111]
    v_mfma_f32_16x16x32_bf16 v[0:3], v[172:175], v[128:131], v[0:3]
    ds_read_b128 v[112:115], v200 offset:0
    s_add_u32 m0, s37, 140288
    s_nop 0
    buffer_load_dwordx4 v212, s[12:15], s17 offen offset:0 lds
    v_mfma_f32_16x16x32_bf16 v[4:7], v[172:175], v[132:135], v[4:7]
    ds_read_b64_tr_b16 v[144:145], v204 offset:0
    v_mfma_f32_16x16x32_bf16 v[8:11], v[172:175], v[136:139], v[8:11]
    ds_read_b64_tr_b16 v[146:147], v204 offset:1088
    buffer_load_dwordx4 v213, s[12:15], s17 offen offset:1088 lds
    v_mfma_f32_16x16x32_bf16 v[12:15], v[172:175], v[140:143], v[12:15]
    v_mfma_f32_16x16x32_bf16 v[16:19], v[176:179], v[128:131], v[16:19]
    ds_read_b128 v[116:119], v200 offset:2048
    v_mfma_f32_16x16x32_bf16 v[20:23], v[176:179], v[132:135], v[20:23]
    ds_read_b128 v[120:123], v200 offset:4096
    buffer_load_dwordx4 v214, s[12:15], s17 offen offset:2176 lds
    v_mfma_f32_16x16x32_bf16 v[24:27], v[176:179], v[136:139], v[24:27]
    ds_read_b128 v[124:127], v200 offset:6144
    v_mfma_f32_16x16x32_bf16 v[28:31], v[176:179], v[140:143], v[28:31]
    v_mfma_f32_16x16x32_bf16 v[32:35], v[180:183], v[128:131], v[32:35]
    ds_read_b64_tr_b16 v[148:149], v204 offset:32
    buffer_load_dwordx4 v215, s[12:15], s17 offen offset:3264 lds
    s_add_u32 s17, s17, 458752
    s_cmp_ge_u32 s17, 7340032
    s_cselect_b32 s17, s55, s17
    v_mfma_f32_16x16x32_bf16 v[36:39], v[180:183], v[132:135], v[36:39]
    ds_read_b64_tr_b16 v[150:151], v204 offset:1120
    v_mfma_f32_16x16x32_bf16 v[40:43], v[180:183], v[136:139], v[40:43]
    v_mfma_f32_16x16x32_bf16 v[44:47], v[180:183], v[140:143], v[44:47]
    ds_read_b64_tr_b16 v[152:153], v204 offset:64
    s_add_u32 m0, s36, 65536
    s_nop 0
    buffer_load_dwordx4 v208, s[8:11], s16 offen offset:0 lds
    v_mfma_f32_16x16x32_bf16 v[48:51], v[184:187], v[128:131], v[48:51]
    ds_read_b64_tr_b16 v[154:155], v204 offset:1152
    v_mfma_f32_16x16x32_bf16 v[52:55], v[184:187], v[132:135], v[52:55]
    ds_read_b64_tr_b16 v[156:157], v204 offset:96
    v_mfma_f32_16x16x32_bf16 v[56:59], v[184:187], v[136:139], v[56:59]
    buffer_load_dwordx4 v209, s[8:11], s16 offen offset:1024 lds
    v_mfma_f32_16x16x32_bf16 v[60:63], v[184:187], v[140:143], v[60:63]
    ds_read_b64_tr_b16 v[158:159], v204 offset:1184
    v_mfma_f32_16x16x32_bf16 v[64:67], v[188:191], v[128:131], v[64:67]
    ds_read_b64_tr_b16 v[160:161], v204 offset:128
    v_mfma_f32_16x16x32_bf16 v[68:71], v[188:191], v[132:135], v[68:71]
    buffer_load_dwordx4 v210, s[8:11], s16 offen offset:2048 lds
    v_mfma_f32_16x16x32_bf16 v[72:75], v[188:191], v[136:139], v[72:75]
    ds_read_b64_tr_b16 v[162:163], v204 offset:1216
    v_mfma_f32_16x16x32_bf16 v[76:79], v[188:191], v[140:143], v[76:79]
    ds_read_b64_tr_b16 v[164:165], v204 offset:160
    v_mfma_f32_16x16x32_bf16 v[80:83], v[192:195], v[128:131], v[80:83]
    s_waitcnt lgkmcnt(14)
    ds_read_b64_tr_b16 v[166:167], v204 offset:1248
    buffer_load_dwordx4 v211, s[8:11], s16 offen offset:3072 lds
    s_add_u32 s16, s16, 128
    s_and_b32 s16, s16, 2047
    v_mfma_f32_16x16x32_bf16 v[84:87], v[192:195], v[132:135], v[84:87]
    v_mfma_f32_16x16x32_bf16 v[88:91], v[192:195], v[136:139], v[88:91]
    s_waitcnt lgkmcnt(14)
    ds_read_b64_tr_b16 v[168:169], v204 offset:192
    s_setprio 0
    v_mfma_f32_16x16x32_bf16 v[92:95], v[192:195], v[140:143], v[92:95]
    s_waitcnt lgkmcnt(14)
    ds_read_b64_tr_b16 v[170:171], v204 offset:1280
    v_mfma_f32_16x16x32_bf16 v[96:99], v[196:199], v[128:131], v[96:99]
    v_mfma_f32_16x16x32_bf16 v[100:103], v[196:199], v[132:135], v[100:103]
    v_mfma_f32_16x16x32_bf16 v[104:107], v[196:199], v[136:139], v[104:107]
    v_mfma_f32_16x16x32_bf16 v[108:111], v[196:199], v[140:143], v[108:111]
    v_mfma_f32_16x16x32_bf16 v[0:3], v[144:147], v[112:115], v[0:3]
    s_waitcnt lgkmcnt(14)
    ds_read_b128 v[128:131], v201 offset:0
    v_mfma_f32_16x16x32_bf16 v[4:7], v[144:147], v[116:119], v[4:7]
    s_waitcnt lgkmcnt(14)
    ds_read_b64_tr_b16 v[172:173], v204 offset:8704
    v_mfma_f32_16x16x32_bf16 v[8:11], v[144:147], v[120:123], v[8:11]
    s_waitcnt lgkmcnt(14)
    ds_read_b64_tr_b16 v[174:175], v204 offset:9792
    v_mfma_f32_16x16x32_bf16 v[12:15], v[144:147], v[124:127], v[12:15]
    s_waitcnt lgkmcnt(14)
    ds_read_b128 v[132:135], v201 offset:2048
    s_waitcnt lgkmcnt(14)
    v_mfma_f32_16x16x32_bf16 v[16:19], v[148:151], v[112:115], v[16:19]
    ds_read_b128 v[136:139], v201 offset:4096
    v_mfma_f32_16x16x32_bf16 v[20:23], v[148:151], v[116:119], v[20:23]
    s_waitcnt lgkmcnt(14)
    ds_read_b128 v[140:143], v201 offset:6144
    v_mfma_f32_16x16x32_bf16 v[24:27], v[148:151], v[120:123], v[24:27]
    v_mfma_f32_16x16x32_bf16 v[28:31], v[148:151], v[124:127], v[28:31]
    s_waitcnt lgkmcnt(14)
    ds_read_b64_tr_b16 v[176:177], v204 offset:8736
    v_mfma_f32_16x16x32_bf16 v[32:35], v[152:155], v[112:115], v[32:35]
    s_waitcnt lgkmcnt(14)
    ds_read_b64_tr_b16 v[178:179], v204 offset:9824
    v_mfma_f32_16x16x32_bf16 v[36:39], v[152:155], v[116:119], v[36:39]
    s_waitcnt lgkmcnt(14)
    ds_read_b64_tr_b16 v[180:181], v204 offset:8768
    v_mfma_f32_16x16x32_bf16 v[40:43], v[152:155], v[120:123], v[40:43]
    s_waitcnt lgkmcnt(14)
    ds_read_b64_tr_b16 v[182:183], v204 offset:9856
    v_mfma_f32_16x16x32_bf16 v[44:47], v[152:155], v[124:127], v[44:47]
    s_waitcnt lgkmcnt(14)
    ds_read_b64_tr_b16 v[184:185], v204 offset:8800
    v_mfma_f32_16x16x32_bf16 v[48:51], v[156:159], v[112:115], v[48:51]
    s_waitcnt lgkmcnt(14)
    ds_read_b64_tr_b16 v[186:187], v204 offset:9888
    v_mfma_f32_16x16x32_bf16 v[52:55], v[156:159], v[116:119], v[52:55]
    v_mfma_f32_16x16x32_bf16 v[56:59], v[156:159], v[120:123], v[56:59]
    s_waitcnt lgkmcnt(14)
    ds_read_b64_tr_b16 v[188:189], v204 offset:8832
    v_mfma_f32_16x16x32_bf16 v[60:63], v[156:159], v[124:127], v[60:63]
    s_waitcnt lgkmcnt(14)
    ds_read_b64_tr_b16 v[190:191], v204 offset:9920
    v_mfma_f32_16x16x32_bf16 v[64:67], v[160:163], v[112:115], v[64:67]
    s_waitcnt lgkmcnt(14)
    ds_read_b64_tr_b16 v[192:193], v204 offset:8864
    v_mfma_f32_16x16x32_bf16 v[68:71], v[160:163], v[116:119], v[68:71]
    s_waitcnt lgkmcnt(14)
    ds_read_b64_tr_b16 v[194:195], v204 offset:9952
    v_mfma_f32_16x16x32_bf16 v[72:75], v[160:163], v[120:123], v[72:75]
    s_waitcnt lgkmcnt(14)
    ds_read_b64_tr_b16 v[196:197], v204 offset:8896
    v_mfma_f32_16x16x32_bf16 v[76:79], v[160:163], v[124:127], v[76:79]
    s_waitcnt lgkmcnt(14)
    ds_read_b64_tr_b16 v[198:199], v204 offset:9984
    v_mfma_f32_16x16x32_bf16 v[80:83], v[164:167], v[112:115], v[80:83]
    v_mfma_f32_16x16x32_bf16 v[84:87], v[164:167], v[116:119], v[84:87]
    v_mfma_f32_16x16x32_bf16 v[88:91], v[164:167], v[120:123], v[88:91]
    v_mfma_f32_16x16x32_bf16 v[92:95], v[164:167], v[124:127], v[92:95]
    v_mfma_f32_16x16x32_bf16 v[96:99], v[168:171], v[112:115], v[96:99]
    v_mfma_f32_16x16x32_bf16 v[100:103], v[168:171], v[116:119], v[100:103]
    s_waitcnt vmcnt(4) lgkmcnt(0)
    s_barrier
    s_setprio 1
    v_mfma_f32_16x16x32_bf16 v[104:107], v[168:171], v[120:123], v[104:107]
    v_mfma_f32_16x16x32_bf16 v[108:111], v[168:171], v[124:127], v[108:111]
    v_mfma_f32_16x16x32_bf16 v[0:3], v[172:175], v[128:131], v[0:3]
    ds_read_b128 v[112:115], v200 offset:32768
    s_add_u32 m0, s37, 122880
    s_nop 0
    buffer_load_dwordx4 v212, s[12:15], s17 offen offset:0 lds
    v_mfma_f32_16x16x32_bf16 v[4:7], v[172:175], v[132:135], v[4:7]
    ds_read_b64_tr_b16 v[144:145], v204 offset:17408
    v_mfma_f32_16x16x32_bf16 v[8:11], v[172:175], v[136:139], v[8:11]
    ds_read_b64_tr_b16 v[146:147], v204 offset:18496
    buffer_load_dwordx4 v213, s[12:15], s17 offen offset:1088 lds
    v_mfma_f32_16x16x32_bf16 v[12:15], v[172:175], v[140:143], v[12:15]
    v_mfma_f32_16x16x32_bf16 v[16:19], v[176:179], v[128:131], v[16:19]
    ds_read_b128 v[116:119], v200 offset:34816
    v_mfma_f32_16x16x32_bf16 v[20:23], v[176:179], v[132:135], v[20:23]
    ds_read_b128 v[120:123], v200 offset:36864
    buffer_load_dwordx4 v214, s[12:15], s17 offen offset:2176 lds
    v_mfma_f32_16x16x32_bf16 v[24:27], v[176:179], v[136:139], v[24:27]
    ds_read_b128 v[124:127], v200 offset:38912
    v_mfma_f32_16x16x32_bf16 v[28:31], v[176:179], v[140:143], v[28:31]
    v_mfma_f32_16x16x32_bf16 v[32:35], v[180:183], v[128:131], v[32:35]
    ds_read_b64_tr_b16 v[148:149], v204 offset:17440
    buffer_load_dwordx4 v215, s[12:15], s17 offen offset:3264 lds
    s_add_u32 s17, s17, 458752
    v_mfma_f32_16x16x32_bf16 v[36:39], v[180:183], v[132:135], v[36:39]
    ds_read_b64_tr_b16 v[150:151], v204 offset:18528
    v_mfma_f32_16x16x32_bf16 v[40:43], v[180:183], v[136:139], v[40:43]
    v_mfma_f32_16x16x32_bf16 v[44:47], v[180:183], v[140:143], v[44:47]
    ds_read_b64_tr_b16 v[152:153], v204 offset:17472
    s_add_u32 m0, s36, 0
    s_nop 0
    buffer_load_dwordx4 v208, s[8:11], s16 offen offset:0 lds
    v_mfma_f32_16x16x32_bf16 v[48:51], v[184:187], v[128:131], v[48:51]
    ds_read_b64_tr_b16 v[154:155], v204 offset:18560
    v_mfma_f32_16x16x32_bf16 v[52:55], v[184:187], v[132:135], v[52:55]
    ds_read_b64_tr_b16 v[156:157], v204 offset:17504
    v_mfma_f32_16x16x32_bf16 v[56:59], v[184:187], v[136:139], v[56:59]
    buffer_load_dwordx4 v209, s[8:11], s16 offen offset:1024 lds
    v_mfma_f32_16x16x32_bf16 v[60:63], v[184:187], v[140:143], v[60:63]
    ds_read_b64_tr_b16 v[158:159], v204 offset:18592
    v_mfma_f32_16x16x32_bf16 v[64:67], v[188:191], v[128:131], v[64:67]
    ds_read_b64_tr_b16 v[160:161], v204 offset:17536
    v_mfma_f32_16x16x32_bf16 v[68:71], v[188:191], v[132:135], v[68:71]
    buffer_load_dwordx4 v210, s[8:11], s16 offen offset:2048 lds
    v_mfma_f32_16x16x32_bf16 v[72:75], v[188:191], v[136:139], v[72:75]
    ds_read_b64_tr_b16 v[162:163], v204 offset:18624
    v_mfma_f32_16x16x32_bf16 v[76:79], v[188:191], v[140:143], v[76:79]
    ds_read_b64_tr_b16 v[164:165], v204 offset:17568
    v_mfma_f32_16x16x32_bf16 v[80:83], v[192:195], v[128:131], v[80:83]
    s_waitcnt lgkmcnt(14)
    ds_read_b64_tr_b16 v[166:167], v204 offset:18656
    buffer_load_dwordx4 v211, s[8:11], s16 offen offset:3072 lds
    s_add_u32 s16, s16, 128
    s_and_b32 s16, s16, 2047
    v_mfma_f32_16x16x32_bf16 v[84:87], v[192:195], v[132:135], v[84:87]
    v_mfma_f32_16x16x32_bf16 v[88:91], v[192:195], v[136:139], v[88:91]
    s_waitcnt lgkmcnt(14)
    ds_read_b64_tr_b16 v[168:169], v204 offset:17600
    s_setprio 0
    v_mfma_f32_16x16x32_bf16 v[92:95], v[192:195], v[140:143], v[92:95]
    s_waitcnt lgkmcnt(14)
    ds_read_b64_tr_b16 v[170:171], v204 offset:18688
    v_mfma_f32_16x16x32_bf16 v[96:99], v[196:199], v[128:131], v[96:99]
    v_mfma_f32_16x16x32_bf16 v[100:103], v[196:199], v[132:135], v[100:103]
    v_mfma_f32_16x16x32_bf16 v[104:107], v[196:199], v[136:139], v[104:107]
    v_mfma_f32_16x16x32_bf16 v[108:111], v[196:199], v[140:143], v[108:111]
    v_mfma_f32_16x16x32_bf16 v[0:3], v[144:147], v[112:115], v[0:3]
    s_waitcnt lgkmcnt(14)
    ds_read_b128 v[128:131], v201 offset:32768
    v_mfma_f32_16x16x32_bf16 v[4:7], v[144:147], v[116:119], v[4:7]
    s_waitcnt lgkmcnt(14)
    ds_read_b64_tr_b16 v[172:173], v204 offset:26112
    v_mfma_f32_16x16x32_bf16 v[8:11], v[144:147], v[120:123], v[8:11]
    s_waitcnt lgkmcnt(14)
    ds_read_b64_tr_b16 v[174:175], v204 offset:27200
    v_mfma_f32_16x16x32_bf16 v[12:15], v[144:147], v[124:127], v[12:15]
    s_waitcnt lgkmcnt(14)
    ds_read_b128 v[132:135], v201 offset:34816
    s_waitcnt lgkmcnt(14)
    v_mfma_f32_16x16x32_bf16 v[16:19], v[148:151], v[112:115], v[16:19]
    ds_read_b128 v[136:139], v201 offset:36864
    v_mfma_f32_16x16x32_bf16 v[20:23], v[148:151], v[116:119], v[20:23]
    s_waitcnt lgkmcnt(14)
    ds_read_b128 v[140:143], v201 offset:38912
    v_mfma_f32_16x16x32_bf16 v[24:27], v[148:151], v[120:123], v[24:27]
    v_mfma_f32_16x16x32_bf16 v[28:31], v[148:151], v[124:127], v[28:31]
    s_waitcnt lgkmcnt(14)
    ds_read_b64_tr_b16 v[176:177], v204 offset:26144
    v_mfma_f32_16x16x32_bf16 v[32:35], v[152:155], v[112:115], v[32:35]
    s_waitcnt lgkmcnt(14)
    ds_read_b64_tr_b16 v[178:179], v204 offset:27232
    v_mfma_f32_16x16x32_bf16 v[36:39], v[152:155], v[116:119], v[36:39]
    s_waitcnt lgkmcnt(14)
    ds_read_b64_tr_b16 v[180:181], v204 offset:26176
    v_mfma_f32_16x16x32_bf16 v[40:43], v[152:155], v[120:123], v[40:43]
    s_waitcnt lgkmcnt(14)
    ds_read_b64_tr_b16 v[182:183], v204 offset:27264
    v_mfma_f32_16x16x32_bf16 v[44:47], v[152:155], v[124:127], v[44:47]
    s_waitcnt lgkmcnt(14)
    ds_read_b64_tr_b16 v[184:185], v204 offset:26208
    v_mfma_f32_16x16x32_bf16 v[48:51], v[156:159], v[112:115], v[48:51]
    s_waitcnt lgkmcnt(14)
    ds_read_b64_tr_b16 v[186:187], v204 offset:27296
    v_mfma_f32_16x16x32_bf16 v[52:55], v[156:159], v[116:119], v[52:55]
    v_mfma_f32_16x16x32_bf16 v[56:59], v[156:159], v[120:123], v[56:59]
    s_waitcnt lgkmcnt(14)
    ds_read_b64_tr_b16 v[188:189], v204 offset:26240
    v_mfma_f32_16x16x32_bf16 v[60:63], v[156:159], v[124:127], v[60:63]
    s_waitcnt lgkmcnt(14)
    ds_read_b64_tr_b16 v[190:191], v204 offset:27328
    v_mfma_f32_16x16x32_bf16 v[64:67], v[160:163], v[112:115], v[64:67]
    s_waitcnt lgkmcnt(14)
    ds_read_b64_tr_b16 v[192:193], v204 offset:26272
    v_mfma_f32_16x16x32_bf16 v[68:71], v[160:163], v[116:119], v[68:71]
    s_waitcnt lgkmcnt(14)
    ds_read_b64_tr_b16 v[194:195], v204 offset:27360
    v_mfma_f32_16x16x32_bf16 v[72:75], v[160:163], v[120:123], v[72:75]
    s_waitcnt lgkmcnt(14)
    ds_read_b64_tr_b16 v[196:197], v204 offset:26304
    v_mfma_f32_16x16x32_bf16 v[76:79], v[160:163], v[124:127], v[76:79]
    s_waitcnt lgkmcnt(14)
    ds_read_b64_tr_b16 v[198:199], v204 offset:27392
    v_mfma_f32_16x16x32_bf16 v[80:83], v[164:167], v[112:115], v[80:83]
    v_mfma_f32_16x16x32_bf16 v[84:87], v[164:167], v[116:119], v[84:87]
    v_mfma_f32_16x16x32_bf16 v[88:91], v[164:167], v[120:123], v[88:91]
    v_mfma_f32_16x16x32_bf16 v[92:95], v[164:167], v[124:127], v[92:95]
    v_mfma_f32_16x16x32_bf16 v[96:99], v[168:171], v[112:115], v[96:99]
    v_mfma_f32_16x16x32_bf16 v[100:103], v[168:171], v[116:119], v[100:103]
    s_waitcnt vmcnt(4) lgkmcnt(0)
    s_barrier
    s_setprio 1
    v_mfma_f32_16x16x32_bf16 v[104:107], v[168:171], v[120:123], v[104:107]
    v_mfma_f32_16x16x32_bf16 v[108:111], v[168:171], v[124:127], v[108:111]
    v_mfma_f32_16x16x32_bf16 v[0:3], v[172:175], v[128:131], v[0:3]
    ds_read_b128 v[112:115], v202 offset:0
    s_add_u32 m0, s37, 140288
    s_nop 0
    buffer_load_dwordx4 v212, s[12:15], s17 offen offset:0 lds
    v_mfma_f32_16x16x32_bf16 v[4:7], v[172:175], v[132:135], v[4:7]
    ds_read_b64_tr_b16 v[144:145], v204 offset:0
    v_mfma_f32_16x16x32_bf16 v[8:11], v[172:175], v[136:139], v[8:11]
    ds_read_b64_tr_b16 v[146:147], v204 offset:1088
    buffer_load_dwordx4 v213, s[12:15], s17 offen offset:1088 lds
    v_mfma_f32_16x16x32_bf16 v[12:15], v[172:175], v[140:143], v[12:15]
    v_mfma_f32_16x16x32_bf16 v[16:19], v[176:179], v[128:131], v[16:19]
    ds_read_b128 v[116:119], v202 offset:2048
    v_mfma_f32_16x16x32_bf16 v[20:23], v[176:179], v[132:135], v[20:23]
    ds_read_b128 v[120:123], v202 offset:4096
    buffer_load_dwordx4 v214, s[12:15], s17 offen offset:2176 lds
    v_mfma_f32_16x16x32_bf16 v[24:27], v[176:179], v[136:139], v[24:27]
    ds_read_b128 v[124:127], v202 offset:6144
    v_mfma_f32_16x16x32_bf16 v[28:31], v[176:179], v[140:143], v[28:31]
    v_mfma_f32_16x16x32_bf16 v[32:35], v[180:183], v[128:131], v[32:35]
    ds_read_b64_tr_b16 v[148:149], v204 offset:32
    buffer_load_dwordx4 v215, s[12:15], s17 offen offset:3264 lds
    s_add_u32 s17, s17, 458752
    s_cmp_ge_u32 s17, 7340032
    s_cselect_b32 s17, s55, s17
    v_mfma_f32_16x16x32_bf16 v[36:39], v[180:183], v[132:135], v[36:39]
    ds_read_b64_tr_b16 v[150:151], v204 offset:1120
    v_mfma_f32_16x16x32_bf16 v[40:43], v[180:183], v[136:139], v[40:43]
    v_mfma_f32_16x16x32_bf16 v[44:47], v[180:183], v[140:143], v[44:47]
    ds_read_b64_tr_b16 v[152:153], v204 offset:64
    s_add_u32 m0, s36, 32768
    s_nop 0
    buffer_load_dwordx4 v208, s[8:11], s16 offen offset:0 lds
    v_mfma_f32_16x16x32_bf16 v[48:51], v[184:187], v[128:131], v[48:51]
    ds_read_b64_tr_b16 v[154:155], v204 offset:1152
    v_mfma_f32_16x16x32_bf16 v[52:55], v[184:187], v[132:135], v[52:55]
    ds_read_b64_tr_b16 v[156:157], v204 offset:96
    v_mfma_f32_16x16x32_bf16 v[56:59], v[184:187], v[136:139], v[56:59]
    buffer_load_dwordx4 v209, s[8:11], s16 offen offset:1024 lds
    v_mfma_f32_16x16x32_bf16 v[60:63], v[184:187], v[140:143], v[60:63]
    ds_read_b64_tr_b16 v[158:159], v204 offset:1184
    v_mfma_f32_16x16x32_bf16 v[64:67], v[188:191], v[128:131], v[64:67]
    ds_read_b64_tr_b16 v[160:161], v204 offset:128
    v_mfma_f32_16x16x32_bf16 v[68:71], v[188:191], v[132:135], v[68:71]
    buffer_load_dwordx4 v210, s[8:11], s16 offen offset:2048 lds
    v_mfma_f32_16x16x32_bf16 v[72:75], v[188:191], v[136:139], v[72:75]
    ds_read_b64_tr_b16 v[162:163], v204 offset:1216
    v_mfma_f32_16x16x32_bf16 v[76:79], v[188:191], v[140:143], v[76:79]
    ds_read_b64_tr_b16 v[164:165], v204 offset:160
    v_mfma_f32_16x16x32_bf16 v[80:83], v[192:195], v[128:131], v[80:83]
    s_waitcnt lgkmcnt(14)
    ds_read_b64_tr_b16 v[166:167], v204 offset:1248
    buffer_load_dwordx4 v211, s[8:11], s16 offen offset:3072 lds
    s_add_u32 s16, s16, 128
    s_and_b32 s16, s16, 2047
    v_mfma_f32_16x16x32_bf16 v[84:87], v[192:195], v[132:135], v[84:87]
    v_mfma_f32_16x16x32_bf16 v[88:91], v[192:195], v[136:139], v[88:91]
    s_waitcnt lgkmcnt(14)
    ds_read_b64_tr_b16 v[168:169], v204 offset:192
    s_lshl_b32 s59, s2, 3
    s_add_u32 s59, s59, s24
    v_lshlrev_b32 v253, 6, v254
    s_mov_b32 s96, s62
    s_mov_b32 s97, s63
    s_mov_b32 s98, 7340032
    s_mov_b32 s99, 0x00020000
    s_mul_i32 s23, s59, 3584
    s_mov_b32 exec_hi, 0x00ffffff
    buffer_load_dword v255, v253, s[96:99], s23 offen
    s_mov_b32 s96, s66
    s_mov_b32 s97, s67
    s_mov_b32 s98, 2097152
    s_mov_b32 s99, 0x00020000
    s_lshl_b32 s23, s59, 10
    s_mov_b64 exec, 0xffff
    buffer_load_dword v255, v253, s[96:99], s23 offen
    s_mov_b64 exec, -1
    s_setprio 0
    v_mfma_f32_16x16x32_bf16 v[92:95], v[192:195], v[140:143], v[92:95]
    s_waitcnt lgkmcnt(14)
    ds_read_b64_tr_b16 v[170:171], v204 offset:1280
    v_mfma_f32_16x16x32_bf16 v[96:99], v[196:199], v[128:131], v[96:99]
    v_mfma_f32_16x16x32_bf16 v[100:103], v[196:199], v[132:135], v[100:103]
    v_mfma_f32_16x16x32_bf16 v[104:107], v[196:199], v[136:139], v[104:107]
    v_mfma_f32_16x16x32_bf16 v[108:111], v[196:199], v[140:143], v[108:111]
    v_mfma_f32_16x16x32_bf16 v[0:3], v[144:147], v[112:115], v[0:3]
    s_waitcnt lgkmcnt(14)
    ds_read_b128 v[128:131], v203 offset:0
    v_mfma_f32_16x16x32_bf16 v[4:7], v[144:147], v[116:119], v[4:7]
    s_waitcnt lgkmcnt(14)
    ds_read_b64_tr_b16 v[172:173], v204 offset:8704
    v_mfma_f32_16x16x32_bf16 v[8:11], v[144:147], v[120:123], v[8:11]
    s_waitcnt lgkmcnt(14)
    ds_read_b64_tr_b16 v[174:175], v204 offset:9792
    v_mfma_f32_16x16x32_bf16 v[12:15], v[144:147], v[124:127], v[12:15]
    s_waitcnt lgkmcnt(14)
    ds_read_b128 v[132:135], v203 offset:2048
    s_waitcnt lgkmcnt(14)
    v_mfma_f32_16x16x32_bf16 v[16:19], v[148:151], v[112:115], v[16:19]
    ds_read_b128 v[136:139], v203 offset:4096
    v_mfma_f32_16x16x32_bf16 v[20:23], v[148:151], v[116:119], v[20:23]
    s_waitcnt lgkmcnt(14)
    ds_read_b128 v[140:143], v203 offset:6144
    v_mfma_f32_16x16x32_bf16 v[24:27], v[148:151], v[120:123], v[24:27]
    v_mfma_f32_16x16x32_bf16 v[28:31], v[148:151], v[124:127], v[28:31]
    s_waitcnt lgkmcnt(14)
    ds_read_b64_tr_b16 v[176:177], v204 offset:8736
    v_mfma_f32_16x16x32_bf16 v[32:35], v[152:155], v[112:115], v[32:35]
    s_waitcnt lgkmcnt(14)
    ds_read_b64_tr_b16 v[178:179], v204 offset:9824
    v_mfma_f32_16x16x32_bf16 v[36:39], v[152:155], v[116:119], v[36:39]
    s_waitcnt lgkmcnt(14)
    ds_read_b64_tr_b16 v[180:181], v204 offset:8768
    v_mfma_f32_16x16x32_bf16 v[40:43], v[152:155], v[120:123], v[40:43]
    s_waitcnt lgkmcnt(14)
    ds_read_b64_tr_b16 v[182:183], v204 offset:9856
    v_mfma_f32_16x16x32_bf16 v[44:47], v[152:155], v[124:127], v[44:47]
    s_waitcnt lgkmcnt(14)
    ds_read_b64_tr_b16 v[184:185], v204 offset:8800
    v_mfma_f32_16x16x32_bf16 v[48:51], v[156:159], v[112:115], v[48:51]
    s_waitcnt lgkmcnt(14)
    ds_read_b64_tr_b16 v[186:187], v204 offset:9888
    v_mfma_f32_16x16x32_bf16 v[52:55], v[156:159], v[116:119], v[52:55]
    v_mfma_f32_16x16x32_bf16 v[56:59], v[156:159], v[120:123], v[56:59]
    s_waitcnt lgkmcnt(14)
    ds_read_b64_tr_b16 v[188:189], v204 offset:8832
    v_mfma_f32_16x16x32_bf16 v[60:63], v[156:159], v[124:127], v[60:63]
    s_waitcnt lgkmcnt(14)
    ds_read_b64_tr_b16 v[190:191], v204 offset:9920
    v_mfma_f32_16x16x32_bf16 v[64:67], v[160:163], v[112:115], v[64:67]
    s_waitcnt lgkmcnt(14)
    ds_read_b64_tr_b16 v[192:193], v204 offset:8864
    v_mfma_f32_16x16x32_bf16 v[68:71], v[160:163], v[116:119], v[68:71]
    s_waitcnt lgkmcnt(14)
    ds_read_b64_tr_b16 v[194:195], v204 offset:9952
    v_mfma_f32_16x16x32_bf16 v[72:75], v[160:163], v[120:123], v[72:75]
    s_waitcnt lgkmcnt(14)
    ds_read_b64_tr_b16 v[196:197], v204 offset:8896
    v_mfma_f32_16x16x32_bf16 v[76:79], v[160:163], v[124:127], v[76:79]
    s_waitcnt lgkmcnt(14)
    ds_read_b64_tr_b16 v[198:199], v204 offset:9984
    v_mfma_f32_16x16x32_bf16 v[80:83], v[164:167], v[112:115], v[80:83]
    v_mfma_f32_16x16x32_bf16 v[84:87], v[164:167], v[116:119], v[84:87]
    v_mfma_f32_16x16x32_bf16 v[88:91], v[164:167], v[120:123], v[88:91]
    v_mfma_f32_16x16x32_bf16 v[92:95], v[164:167], v[124:127], v[92:95]
    v_mfma_f32_16x16x32_bf16 v[96:99], v[168:171], v[112:115], v[96:99]
    v_mfma_f32_16x16x32_bf16 v[100:103], v[168:171], v[116:119], v[100:103]
    s_waitcnt vmcnt(6) lgkmcnt(0)
    s_barrier
    s_setprio 1
    v_mfma_f32_16x16x32_bf16 v[104:107], v[168:171], v[120:123], v[104:107]
    v_mfma_f32_16x16x32_bf16 v[108:111], v[168:171], v[124:127], v[108:111]
    v_mfma_f32_16x16x32_bf16 v[0:3], v[172:175], v[128:131], v[0:3]
    ds_read_b128 v[112:115], v200 offset:0
    s_add_u32 m0, s37, 122880
    s_nop 0
    buffer_load_dwordx4 v212, s[12:15], s17 offen offset:0 lds
    v_mfma_f32_16x16x32_bf16 v[4:7], v[172:175], v[132:135], v[4:7]
    ds_read_b64_tr_b16 v[144:145], v204 offset:17408
    v_mfma_f32_16x16x32_bf16 v[8:11], v[172:175], v[136:139], v[8:11]
    ds_read_b64_tr_b16 v[146:147], v204 offset:18496
    buffer_load_dwordx4 v213, s[12:15], s17 offen offset:1088 lds
    v_mfma_f32_16x16x32_bf16 v[12:15], v[172:175], v[140:143], v[12:15]
    v_mfma_f32_16x16x32_bf16 v[16:19], v[176:179], v[128:131], v[16:19]
    ds_read_b128 v[116:119], v200 offset:2048
    v_mfma_f32_16x16x32_bf16 v[20:23], v[176:179], v[132:135], v[20:23]
    ds_read_b128 v[120:123], v200 offset:4096
    buffer_load_dwordx4 v214, s[12:15], s17 offen offset:2176 lds
    v_mfma_f32_16x16x32_bf16 v[24:27], v[176:179], v[136:139], v[24:27]
    ds_read_b128 v[124:127], v200 offset:6144
    v_mfma_f32_16x16x32_bf16 v[28:31], v[176:179], v[140:143], v[28:31]
    v_mfma_f32_16x16x32_bf16 v[32:35], v[180:183], v[128:131], v[32:35]
    ds_read_b64_tr_b16 v[148:149], v204 offset:17440
    buffer_load_dwordx4 v215, s[12:15], s17 offen offset:3264 lds
    s_add_u32 s17, s17, 458752
    v_mfma_f32_16x16x32_bf16 v[36:39], v[180:183], v[132:135], v[36:39]
    ds_read_b64_tr_b16 v[150:151], v204 offset:18528
    v_mfma_f32_16x16x32_bf16 v[40:43], v[180:183], v[136:139], v[40:43]
    v_mfma_f32_16x16x32_bf16 v[44:47], v[180:183], v[140:143], v[44:47]
    ds_read_b64_tr_b16 v[152:153], v204 offset:17472
    s_add_u32 m0, s36, 65536
    s_nop 0
    buffer_load_dwordx4 v208, s[8:11], s16 offen offset:0 lds
    v_mfma_f32_16x16x32_bf16 v[48:51], v[184:187], v[128:131], v[48:51]
    ds_read_b64_tr_b16 v[154:155], v204 offset:18560
    v_mfma_f32_16x16x32_bf16 v[52:55], v[184:187], v[132:135], v[52:55]
    ds_read_b64_tr_b16 v[156:157], v204 offset:17504
    v_mfma_f32_16x16x32_bf16 v[56:59], v[184:187], v[136:139], v[56:59]
    buffer_load_dwordx4 v209, s[8:11], s16 offen offset:1024 lds
    v_mfma_f32_16x16x32_bf16 v[60:63], v[184:187], v[140:143], v[60:63]
    ds_read_b64_tr_b16 v[158:159], v204 offset:18592
    v_mfma_f32_16x16x32_bf16 v[64:67], v[188:191], v[128:131], v[64:67]
    ds_read_b64_tr_b16 v[160:161], v204 offset:17536
    v_mfma_f32_16x16x32_bf16 v[68:71], v[188:191], v[132:135], v[68:71]
    buffer_load_dwordx4 v210, s[8:11], s16 offen offset:2048 lds
    v_mfma_f32_16x16x32_bf16 v[72:75], v[188:191], v[136:139], v[72:75]
    ds_read_b64_tr_b16 v[162:163], v204 offset:18624
    v_mfma_f32_16x16x32_bf16 v[76:79], v[188:191], v[140:143], v[76:79]
    ds_read_b64_tr_b16 v[164:165], v204 offset:17568
    v_mfma_f32_16x16x32_bf16 v[80:83], v[192:195], v[128:131], v[80:83]
    s_waitcnt lgkmcnt(14)
    ds_read_b64_tr_b16 v[166:167], v204 offset:18656
    buffer_load_dwordx4 v211, s[8:11], s16 offen offset:3072 lds
    s_add_u32 s16, s16, 128
    s_and_b32 s16, s16, 2047
    v_mfma_f32_16x16x32_bf16 v[84:87], v[192:195], v[132:135], v[84:87]
    v_mfma_f32_16x16x32_bf16 v[88:91], v[192:195], v[136:139], v[88:91]
    s_waitcnt lgkmcnt(14)
    ds_read_b64_tr_b16 v[168:169], v204 offset:17600
    s_setprio 0
    v_mfma_f32_16x16x32_bf16 v[92:95], v[192:195], v[140:143], v[92:95]
    s_waitcnt lgkmcnt(14)
    ds_read_b64_tr_b16 v[170:171], v204 offset:18688
    v_mfma_f32_16x16x32_bf16 v[96:99], v[196:199], v[128:131], v[96:99]
    v_mfma_f32_16x16x32_bf16 v[100:103], v[196:199], v[132:135], v[100:103]
    v_mfma_f32_16x16x32_bf16 v[104:107], v[196:199], v[136:139], v[104:107]
    v_mfma_f32_16x16x32_bf16 v[108:111], v[196:199], v[140:143], v[108:111]
    v_mfma_f32_16x16x32_bf16 v[0:3], v[144:147], v[112:115], v[0:3]
    s_waitcnt lgkmcnt(14)
    ds_read_b128 v[128:131], v201 offset:0
    v_mfma_f32_16x16x32_bf16 v[4:7], v[144:147], v[116:119], v[4:7]
    s_waitcnt lgkmcnt(14)
    ds_read_b64_tr_b16 v[172:173], v204 offset:26112
    v_mfma_f32_16x16x32_bf16 v[8:11], v[144:147], v[120:123], v[8:11]
    s_waitcnt lgkmcnt(14)
    ds_read_b64_tr_b16 v[174:175], v204 offset:27200
    v_mfma_f32_16x16x32_bf16 v[12:15], v[144:147], v[124:127], v[12:15]
    s_waitcnt lgkmcnt(14)
    ds_read_b128 v[132:135], v201 offset:2048
    s_waitcnt lgkmcnt(14)
    v_mfma_f32_16x16x32_bf16 v[16:19], v[148:151], v[112:115], v[16:19]
    ds_read_b128 v[136:139], v201 offset:4096
    v_mfma_f32_16x16x32_bf16 v[20:23], v[148:151], v[116:119], v[20:23]
    s_waitcnt lgkmcnt(14)
    ds_read_b128 v[140:143], v201 offset:6144
    v_mfma_f32_16x16x32_bf16 v[24:27], v[148:151], v[120:123], v[24:27]
    v_mfma_f32_16x16x32_bf16 v[28:31], v[148:151], v[124:127], v[28:31]
    s_waitcnt lgkmcnt(14)
    ds_read_b64_tr_b16 v[176:177], v204 offset:26144
    v_mfma_f32_16x16x32_bf16 v[32:35], v[152:155], v[112:115], v[32:35]
    s_waitcnt lgkmcnt(14)
    ds_read_b64_tr_b16 v[178:179], v204 offset:27232
    v_mfma_f32_16x16x32_bf16 v[36:39], v[152:155], v[116:119], v[36:39]
    s_waitcnt lgkmcnt(14)
    ds_read_b64_tr_b16 v[180:181], v204 offset:26176
    v_mfma_f32_16x16x32_bf16 v[40:43], v[152:155], v[120:123], v[40:43]
    s_waitcnt lgkmcnt(14)
    ds_read_b64_tr_b16 v[182:183], v204 offset:27264
    v_mfma_f32_16x16x32_bf16 v[44:47], v[152:155], v[124:127], v[44:47]
    s_waitcnt lgkmcnt(14)
    ds_read_b64_tr_b16 v[184:185], v204 offset:26208
    v_mfma_f32_16x16x32_bf16 v[48:51], v[156:159], v[112:115], v[48:51]
    s_waitcnt lgkmcnt(14)
    ds_read_b64_tr_b16 v[186:187], v204 offset:27296
    v_mfma_f32_16x16x32_bf16 v[52:55], v[156:159], v[116:119], v[52:55]
    v_mfma_f32_16x16x32_bf16 v[56:59], v[156:159], v[120:123], v[56:59]
    s_waitcnt lgkmcnt(14)
    ds_read_b64_tr_b16 v[188:189], v204 offset:26240
    v_mfma_f32_16x16x32_bf16 v[60:63], v[156:159], v[124:127], v[60:63]
    s_waitcnt lgkmcnt(14)
    ds_read_b64_tr_b16 v[190:191], v204 offset:27328
    v_mfma_f32_16x16x32_bf16 v[64:67], v[160:163], v[112:115], v[64:67]
    s_waitcnt lgkmcnt(14)
    ds_read_b64_tr_b16 v[192:193], v204 offset:26272
    v_mfma_f32_16x16x32_bf16 v[68:71], v[160:163], v[116:119], v[68:71]
    s_waitcnt lgkmcnt(14)
    ds_read_b64_tr_b16 v[194:195], v204 offset:27360
    v_mfma_f32_16x16x32_bf16 v[72:75], v[160:163], v[120:123], v[72:75]
    s_waitcnt lgkmcnt(14)
    ds_read_b64_tr_b16 v[196:197], v204 offset:26304
    v_mfma_f32_16x16x32_bf16 v[76:79], v[160:163], v[124:127], v[76:79]
    s_waitcnt lgkmcnt(14)
    ds_read_b64_tr_b16 v[198:199], v204 offset:27392
    v_mfma_f32_16x16x32_bf16 v[80:83], v[164:167], v[112:115], v[80:83]
    v_mfma_f32_16x16x32_bf16 v[84:87], v[164:167], v[116:119], v[84:87]
    v_mfma_f32_16x16x32_bf16 v[88:91], v[164:167], v[120:123], v[88:91]
    v_mfma_f32_16x16x32_bf16 v[92:95], v[164:167], v[124:127], v[92:95]
    v_mfma_f32_16x16x32_bf16 v[96:99], v[168:171], v[112:115], v[96:99]
    v_mfma_f32_16x16x32_bf16 v[100:103], v[168:171], v[116:119], v[100:103]
    s_waitcnt vmcnt(4) lgkmcnt(0)
    s_barrier
    s_setprio 1
    v_mfma_f32_16x16x32_bf16 v[104:107], v[168:171], v[120:123], v[104:107]
    v_mfma_f32_16x16x32_bf16 v[108:111], v[168:171], v[124:127], v[108:111]
    v_mfma_f32_16x16x32_bf16 v[0:3], v[172:175], v[128:131], v[0:3]
    ds_read_b128 v[112:115], v200 offset:32768
    s_add_u32 m0, s37, 140288
    s_nop 0
    buffer_load_dwordx4 v212, s[12:15], s17 offen offset:0 lds
    v_mfma_f32_16x16x32_bf16 v[4:7], v[172:175], v[132:135], v[4:7]
    ds_read_b64_tr_b16 v[144:145], v204 offset:0
    v_mfma_f32_16x16x32_bf16 v[8:11], v[172:175], v[136:139], v[8:11]
    ds_read_b64_tr_b16 v[146:147], v204 offset:1088
    buffer_load_dwordx4 v213, s[12:15], s17 offen offset:1088 lds
    v_mfma_f32_16x16x32_bf16 v[12:15], v[172:175], v[140:143], v[12:15]
    v_mfma_f32_16x16x32_bf16 v[16:19], v[176:179], v[128:131], v[16:19]
    ds_read_b128 v[116:119], v200 offset:34816
    v_mfma_f32_16x16x32_bf16 v[20:23], v[176:179], v[132:135], v[20:23]
    ds_read_b128 v[120:123], v200 offset:36864
    buffer_load_dwordx4 v214, s[12:15], s17 offen offset:2176 lds
    v_mfma_f32_16x16x32_bf16 v[24:27], v[176:179], v[136:139], v[24:27]
    ds_read_b128 v[124:127], v200 offset:38912
    v_mfma_f32_16x16x32_bf16 v[28:31], v[176:179], v[140:143], v[28:31]
    v_mfma_f32_16x16x32_bf16 v[32:35], v[180:183], v[128:131], v[32:35]
    ds_read_b64_tr_b16 v[148:149], v204 offset:32
    buffer_load_dwordx4 v215, s[12:15], s17 offen offset:3264 lds
    s_add_u32 s17, s17, 458752
    s_cmp_ge_u32 s17, 7340032
    s_cselect_b32 s17, s55, s17
    v_mfma_f32_16x16x32_bf16 v[36:39], v[180:183], v[132:135], v[36:39]
    ds_read_b64_tr_b16 v[150:151], v204 offset:1120
    v_mfma_f32_16x16x32_bf16 v[40:43], v[180:183], v[136:139], v[40:43]
    v_mfma_f32_16x16x32_bf16 v[44:47], v[180:183], v[140:143], v[44:47]
    ds_read_b64_tr_b16 v[152:153], v204 offset:64
    s_add_u32 m0, s36, 0
    s_nop 0
    buffer_load_dwordx4 v208, s[8:11], s16 offen offset:0 lds
    v_mfma_f32_16x16x32_bf16 v[48:51], v[184:187], v[128:131], v[48:51]
    ds_read_b64_tr_b16 v[154:155], v204 offset:1152
    v_mfma_f32_16x16x32_bf16 v[52:55], v[184:187], v[132:135], v[52:55]
    ds_read_b64_tr_b16 v[156:157], v204 offset:96
    v_mfma_f32_16x16x32_bf16 v[56:59], v[184:187], v[136:139], v[56:59]
    buffer_load_dwordx4 v209, s[8:11], s16 offen offset:1024 lds
    v_mfma_f32_16x16x32_bf16 v[60:63], v[184:187], v[140:143], v[60:63]
    ds_read_b64_tr_b16 v[158:159], v204 offset:1184
    v_mfma_f32_16x16x32_bf16 v[64:67], v[188:191], v[128:131], v[64:67]
    ds_read_b64_tr_b16 v[160:161], v204 offset:128
    v_mfma_f32_16x16x32_bf16 v[68:71], v[188:191], v[132:135], v[68:71]
    buffer_load_dwordx4 v210, s[8:11], s16 offen offset:2048 lds
    v_mfma_f32_16x16x32_bf16 v[72:75], v[188:191], v[136:139], v[72:75]
    ds_read_b64_tr_b16 v[162:163], v204 offset:1216
    v_mfma_f32_16x16x32_bf16 v[76:79], v[188:191], v[140:143], v[76:79]
    ds_read_b64_tr_b16 v[164:165], v204 offset:160
    v_mfma_f32_16x16x32_bf16 v[80:83], v[192:195], v[128:131], v[80:83]
    s_waitcnt lgkmcnt(14)
    ds_read_b64_tr_b16 v[166:167], v204 offset:1248
    buffer_load_dwordx4 v211, s[8:11], s16 offen offset:3072 lds
    s_add_u32 s16, s16, 128
    s_and_b32 s16, s16, 2047
    v_mfma_f32_16x16x32_bf16 v[84:87], v[192:195], v[132:135], v[84:87]
    v_mfma_f32_16x16x32_bf16 v[88:91], v[192:195], v[136:139], v[88:91]
    s_waitcnt lgkmcnt(14)
    ds_read_b64_tr_b16 v[168:169], v204 offset:192
    s_setprio 0
    v_mfma_f32_16x16x32_bf16 v[92:95], v[192:195], v[140:143], v[92:95]
    s_waitcnt lgkmcnt(14)
    ds_read_b64_tr_b16 v[170:171], v204 offset:1280
    v_mfma_f32_16x16x32_bf16 v[96:99], v[196:199], v[128:131], v[96:99]
    v_mfma_f32_16x16x32_bf16 v[100:103], v[196:199], v[132:135], v[100:103]
    v_mfma_f32_16x16x32_bf16 v[104:107], v[196:199], v[136:139], v[104:107]
    v_mfma_f32_16x16x32_bf16 v[108:111], v[196:199], v[140:143], v[108:111]
    v_mfma_f32_16x16x32_bf16 v[0:3], v[144:147], v[112:115], v[0:3]
    s_waitcnt lgkmcnt(14)
    ds_read_b128 v[128:131], v201 offset:32768
    v_mfma_f32_16x16x32_bf16 v[4:7], v[144:147], v[116:119], v[4:7]
    s_waitcnt lgkmcnt(14)
    ds_read_b64_tr_b16 v[172:173], v204 offset:8704
    v_mfma_f32_16x16x32_bf16 v[8:11], v[144:147], v[120:123], v[8:11]
    s_waitcnt lgkmcnt(14)
    ds_read_b64_tr_b16 v[174:175], v204 offset:9792
    v_mfma_f32_16x16x32_bf16 v[12:15], v[144:147], v[124:127], v[12:15]
    s_waitcnt lgkmcnt(14)
    ds_read_b128 v[132:135], v201 offset:34816
    s_waitcnt lgkmcnt(14)
    v_mfma_f32_16x16x32_bf16 v[16:19], v[148:151], v[112:115], v[16:19]
    ds_read_b128 v[136:139], v201 offset:36864
    v_mfma_f32_16x16x32_bf16 v[20:23], v[148:151], v[116:119], v[20:23]
    s_waitcnt lgkmcnt(14)
    ds_read_b128 v[140:143], v201 offset:38912
    v_mfma_f32_16x16x32_bf16 v[24:27], v[148:151], v[120:123], v[24:27]
    v_mfma_f32_16x16x32_bf16 v[28:31], v[148:151], v[124:127], v[28:31]
    s_waitcnt lgkmcnt(14)
    ds_read_b64_tr_b16 v[176:177], v204 offset:8736
    v_mfma_f32_16x16x32_bf16 v[32:35], v[152:155], v[112:115], v[32:35]
    s_waitcnt lgkmcnt(14)
    ds_read_b64_tr_b16 v[178:179], v204 offset:9824
    v_mfma_f32_16x16x32_bf16 v[36:39], v[152:155], v[116:119], v[36:39]
    s_waitcnt lgkmcnt(14)
    ds_read_b64_tr_b16 v[180:181], v204 offset:8768
    v_mfma_f32_16x16x32_bf16 v[40:43], v[152:155], v[120:123], v[40:43]
    s_waitcnt lgkmcnt(14)
    ds_read_b64_tr_b16 v[182:183], v204 offset:9856
    v_mfma_f32_16x16x32_bf16 v[44:47], v[152:155], v[124:127], v[44:47]
    s_waitcnt lgkmcnt(14)
    ds_read_b64_tr_b16 v[184:185], v204 offset:8800
    v_mfma_f32_16x16x32_bf16 v[48:51], v[156:159], v[112:115], v[48:51]
    s_waitcnt lgkmcnt(14)
    ds_read_b64_tr_b16 v[186:187], v204 offset:9888
    v_mfma_f32_16x16x32_bf16 v[52:55], v[156:159], v[116:119], v[52:55]
    v_mfma_f32_16x16x32_bf16 v[56:59], v[156:159], v[120:123], v[56:59]
    s_waitcnt lgkmcnt(14)
    ds_read_b64_tr_b16 v[188:189], v204 offset:8832
    v_mfma_f32_16x16x32_bf16 v[60:63], v[156:159], v[124:127], v[60:63]
    s_waitcnt lgkmcnt(14)
    ds_read_b64_tr_b16 v[190:191], v204 offset:9920
    v_mfma_f32_16x16x32_bf16 v[64:67], v[160:163], v[112:115], v[64:67]
    s_waitcnt lgkmcnt(14)
    ds_read_b64_tr_b16 v[192:193], v204 offset:8864
    v_mfma_f32_16x16x32_bf16 v[68:71], v[160:163], v[116:119], v[68:71]
    s_waitcnt lgkmcnt(14)
    ds_read_b64_tr_b16 v[194:195], v204 offset:9952
    v_mfma_f32_16x16x32_bf16 v[72:75], v[160:163], v[120:123], v[72:75]
    s_waitcnt lgkmcnt(14)
    ds_read_b64_tr_b16 v[196:197], v204 offset:8896
    v_mfma_f32_16x16x32_bf16 v[76:79], v[160:163], v[124:127], v[76:79]
    s_waitcnt lgkmcnt(14)
    ds_read_b64_tr_b16 v[198:199], v204 offset:9984
    v_mfma_f32_16x16x32_bf16 v[80:83], v[164:167], v[112:115], v[80:83]
    v_mfma_f32_16x16x32_bf16 v[84:87], v[164:167], v[116:119], v[84:87]
    v_mfma_f32_16x16x32_bf16 v[88:91], v[164:167], v[120:123], v[88:91]
    v_mfma_f32_16x16x32_bf16 v[92:95], v[164:167], v[124:127], v[92:95]
    v_mfma_f32_16x16x32_bf16 v[96:99], v[168:171], v[112:115], v[96:99]
    v_mfma_f32_16x16x32_bf16 v[100:103], v[168:171], v[116:119], v[100:103]
    s_waitcnt vmcnt(4) lgkmcnt(0)
    s_barrier
    s_setprio 1
    v_mfma_f32_16x16x32_bf16 v[104:107], v[168:171], v[120:123], v[104:107]
    v_mfma_f32_16x16x32_bf16 v[108:111], v[168:171], v[124:127], v[108:111]
    v_mfma_f32_16x16x32_bf16 v[0:3], v[172:175], v[128:131], v[0:3]
    ds_read_b128 v[112:115], v202 offset:0
    s_add_u32 m0, s37, 122880
    s_nop 0
    buffer_load_dwordx4 v212, s[12:15], s17 offen offset:0 lds
    v_mfma_f32_16x16x32_bf16 v[4:7], v[172:175], v[132:135], v[4:7]
    ds_read_b64_tr_b16 v[144:145], v204 offset:17408
    v_mfma_f32_16x16x32_bf16 v[8:11], v[172:175], v[136:139], v[8:11]
    ds_read_b64_tr_b16 v[146:147], v204 offset:18496
    buffer_load_dwordx4 v213, s[12:15], s17 offen offset:1088 lds
    v_mfma_f32_16x16x32_bf16 v[12:15], v[172:175], v[140:143], v[12:15]
    v_mfma_f32_16x16x32_bf16 v[16:19], v[176:179], v[128:131], v[16:19]
    ds_read_b128 v[116:119], v202 offset:2048
    v_mfma_f32_16x16x32_bf16 v[20:23], v[176:179], v[132:135], v[20:23]
    ds_read_b128 v[120:123], v202 offset:4096
    buffer_load_dwordx4 v214, s[12:15], s17 offen offset:2176 lds
    v_mfma_f32_16x16x32_bf16 v[24:27], v[176:179], v[136:139], v[24:27]
    ds_read_b128 v[124:127], v202 offset:6144
    v_mfma_f32_16x16x32_bf16 v[28:31], v[176:179], v[140:143], v[28:31]
    v_mfma_f32_16x16x32_bf16 v[32:35], v[180:183], v[128:131], v[32:35]
    ds_read_b64_tr_b16 v[148:149], v204 offset:17440
    buffer_load_dwordx4 v215, s[12:15], s17 offen offset:3264 lds
    s_add_u32 s17, s17, 458752
    v_mfma_f32_16x16x32_bf16 v[36:39], v[180:183], v[132:135], v[36:39]
    ds_read_b64_tr_b16 v[150:151], v204 offset:18528
    v_mfma_f32_16x16x32_bf16 v[40:43], v[180:183], v[136:139], v[40:43]
    v_mfma_f32_16x16x32_bf16 v[44:47], v[180:183], v[140:143], v[44:47]
    ds_read_b64_tr_b16 v[152:153], v204 offset:17472
    s_add_u32 m0, s36, 32768
    s_nop 0
    buffer_load_dwordx4 v208, s[8:11], s16 offen offset:0 lds
    v_mfma_f32_16x16x32_bf16 v[48:51], v[184:187], v[128:131], v[48:51]
    ds_read_b64_tr_b16 v[154:155], v204 offset:18560
    v_mfma_f32_16x16x32_bf16 v[52:55], v[184:187], v[132:135], v[52:55]
    ds_read_b64_tr_b16 v[156:157], v204 offset:17504
    v_mfma_f32_16x16x32_bf16 v[56:59], v[184:187], v[136:139], v[56:59]
    buffer_load_dwordx4 v209, s[8:11], s16 offen offset:1024 lds
    v_mfma_f32_16x16x32_bf16 v[60:63], v[184:187], v[140:143], v[60:63]
    ds_read_b64_tr_b16 v[158:159], v204 offset:18592
    v_mfma_f32_16x16x32_bf16 v[64:67], v[188:191], v[128:131], v[64:67]
    ds_read_b64_tr_b16 v[160:161], v204 offset:17536
    v_mfma_f32_16x16x32_bf16 v[68:71], v[188:191], v[132:135], v[68:71]
    buffer_load_dwordx4 v210, s[8:11], s16 offen offset:2048 lds
    v_mfma_f32_16x16x32_bf16 v[72:75], v[188:191], v[136:139], v[72:75]
    ds_read_b64_tr_b16 v[162:163], v204 offset:18624
    v_mfma_f32_16x16x32_bf16 v[76:79], v[188:191], v[140:143], v[76:79]
    ds_read_b64_tr_b16 v[164:165], v204 offset:17568
    v_mfma_f32_16x16x32_bf16 v[80:83], v[192:195], v[128:131], v[80:83]
    s_waitcnt lgkmcnt(14)
    ds_read_b64_tr_b16 v[166:167], v204 offset:18656
    buffer_load_dwordx4 v211, s[8:11], s16 offen offset:3072 lds
    s_add_u32 s16, s16, 128
    s_and_b32 s16, s16, 2047
    v_mfma_f32_16x16x32_bf16 v[84:87], v[192:195], v[132:135], v[84:87]
    v_mfma_f32_16x16x32_bf16 v[88:91], v[192:195], v[136:139], v[88:91]
    s_waitcnt lgkmcnt(14)
    ds_read_b64_tr_b16 v[168:169], v204 offset:17600
    s_setprio 0
    v_mfma_f32_16x16x32_bf16 v[92:95], v[192:195], v[140:143], v[92:95]
    s_waitcnt lgkmcnt(14)
    ds_read_b64_tr_b16 v[170:171], v204 offset:18688
    v_mfma_f32_16x16x32_bf16 v[96:99], v[196:199], v[128:131], v[96:99]
    v_mfma_f32_16x16x32_bf16 v[100:103], v[196:199], v[132:135], v[100:103]
    v_mfma_f32_16x16x32_bf16 v[104:107], v[196:199], v[136:139], v[104:107]
    v_mfma_f32_16x16x32_bf16 v[108:111], v[196:199], v[140:143], v[108:111]
    v_mfma_f32_16x16x32_bf16 v[0:3], v[144:147], v[112:115], v[0:3]
    s_waitcnt lgkmcnt(14)
    ds_read_b128 v[128:131], v203 offset:0
    v_mfma_f32_16x16x32_bf16 v[4:7], v[144:147], v[116:119], v[4:7]
    s_waitcnt lgkmcnt(14)
    ds_read_b64_tr_b16 v[172:173], v204 offset:26112
    v_mfma_f32_16x16x32_bf16 v[8:11], v[144:147], v[120:123], v[8:11]
    s_waitcnt lgkmcnt(14)
    ds_read_b64_tr_b16 v[174:175], v204 offset:27200
    v_mfma_f32_16x16x32_bf16 v[12:15], v[144:147], v[124:127], v[12:15]
    s_waitcnt lgkmcnt(14)
    ds_read_b128 v[132:135], v203 offset:2048
    s_waitcnt lgkmcnt(14)
    v_mfma_f32_16x16x32_bf16 v[16:19], v[148:151], v[112:115], v[16:19]
    ds_read_b128 v[136:139], v203 offset:4096
    v_mfma_f32_16x16x32_bf16 v[20:23], v[148:151], v[116:119], v[20:23]
    s_waitcnt lgkmcnt(14)
    ds_read_b128 v[140:143], v203 offset:6144
    v_mfma_f32_16x16x32_bf16 v[24:27], v[148:151], v[120:123], v[24:27]
    v_mfma_f32_16x16x32_bf16 v[28:31], v[148:151], v[124:127], v[28:31]
    s_waitcnt lgkmcnt(14)
    ds_read_b64_tr_b16 v[176:177], v204 offset:26144
    v_mfma_f32_16x16x32_bf16 v[32:35], v[152:155], v[112:115], v[32:35]
    s_waitcnt lgkmcnt(14)
    ds_read_b64_tr_b16 v[178:179], v204 offset:27232
    v_mfma_f32_16x16x32_bf16 v[36:39], v[152:155], v[116:119], v[36:39]
    s_waitcnt lgkmcnt(14)
    ds_read_b64_tr_b16 v[180:181], v204 offset:26176
    v_mfma_f32_16x16x32_bf16 v[40:43], v[152:155], v[120:123], v[40:43]
    s_waitcnt lgkmcnt(14)
    ds_read_b64_tr_b16 v[182:183], v204 offset:27264
    v_mfma_f32_16x16x32_bf16 v[44:47], v[152:155], v[124:127], v[44:47]
    s_waitcnt lgkmcnt(14)
    ds_read_b64_tr_b16 v[184:185], v204 offset:26208
    v_mfma_f32_16x16x32_bf16 v[48:51], v[156:159], v[112:115], v[48:51]
    s_waitcnt lgkmcnt(14)
    ds_read_b64_tr_b16 v[186:187], v204 offset:27296
    v_mfma_f32_16x16x32_bf16 v[52:55], v[156:159], v[116:119], v[52:55]
    v_mfma_f32_16x16x32_bf16 v[56:59], v[156:159], v[120:123], v[56:59]
    s_waitcnt lgkmcnt(14)
    ds_read_b64_tr_b16 v[188:189], v204 offset:26240
    v_mfma_f32_16x16x32_bf16 v[60:63], v[156:159], v[124:127], v[60:63]
    s_waitcnt lgkmcnt(14)
    ds_read_b64_tr_b16 v[190:191], v204 offset:27328
    v_mfma_f32_16x16x32_bf16 v[64:67], v[160:163], v[112:115], v[64:67]
    s_waitcnt lgkmcnt(14)
    ds_read_b64_tr_b16 v[192:193], v204 offset:26272
    v_mfma_f32_16x16x32_bf16 v[68:71], v[160:163], v[116:119], v[68:71]
    s_waitcnt lgkmcnt(14)
    ds_read_b64_tr_b16 v[194:195], v204 offset:27360
    v_mfma_f32_16x16x32_bf16 v[72:75], v[160:163], v[120:123], v[72:75]
    s_waitcnt lgkmcnt(14)
    ds_read_b64_tr_b16 v[196:197], v204 offset:26304
    v_mfma_f32_16x16x32_bf16 v[76:79], v[160:163], v[124:127], v[76:79]
    s_waitcnt lgkmcnt(14)
    ds_read_b64_tr_b16 v[198:199], v204 offset:27392
    v_mfma_f32_16x16x32_bf16 v[80:83], v[164:167], v[112:115], v[80:83]
    v_mfma_f32_16x16x32_bf16 v[84:87], v[164:167], v[116:119], v[84:87]
    v_mfma_f32_16x16x32_bf16 v[88:91], v[164:167], v[120:123], v[88:91]
    v_mfma_f32_16x16x32_bf16 v[92:95], v[164:167], v[124:127], v[92:95]
    v_mfma_f32_16x16x32_bf16 v[96:99], v[168:171], v[112:115], v[96:99]
    v_mfma_f32_16x16x32_bf16 v[100:103], v[168:171], v[116:119], v[100:103]
    s_waitcnt vmcnt(4) lgkmcnt(0)
    s_barrier
    s_setprio 1
    v_mfma_f32_16x16x32_bf16 v[104:107], v[168:171], v[120:123], v[104:107]
    v_mfma_f32_16x16x32_bf16 v[108:111], v[168:171], v[124:127], v[108:111]
    v_mfma_f32_16x16x32_bf16 v[0:3], v[172:175], v[128:131], v[0:3]
    ds_read_b128 v[112:115], v200 offset:0
    s_add_u32 m0, s37, 140288
    s_nop 0
    buffer_load_dwordx4 v212, s[12:15], s17 offen offset:0 lds
    v_mfma_f32_16x16x32_bf16 v[4:7], v[172:175], v[132:135], v[4:7]
    ds_read_b64_tr_b16 v[144:145], v204 offset:0
    v_mfma_f32_16x16x32_bf16 v[8:11], v[172:175], v[136:139], v[8:11]
    ds_read_b64_tr_b16 v[146:147], v204 offset:1088
    buffer_load_dwordx4 v213, s[12:15], s17 offen offset:1088 lds
    v_mfma_f32_16x16x32_bf16 v[12:15], v[172:175], v[140:143], v[12:15]
    v_mfma_f32_16x16x32_bf16 v[16:19], v[176:179], v[128:131], v[16:19]
    ds_read_b128 v[116:119], v200 offset:2048
    v_mfma_f32_16x16x32_bf16 v[20:23], v[176:179], v[132:135], v[20:23]
    ds_read_b128 v[120:123], v200 offset:4096
    buffer_load_dwordx4 v214, s[12:15], s17 offen offset:2176 lds
    v_mfma_f32_16x16x32_bf16 v[24:27], v[176:179], v[136:139], v[24:27]
    ds_read_b128 v[124:127], v200 offset:6144
    v_mfma_f32_16x16x32_bf16 v[28:31], v[176:179], v[140:143], v[28:31]
    v_mfma_f32_16x16x32_bf16 v[32:35], v[180:183], v[128:131], v[32:35]
    ds_read_b64_tr_b16 v[148:149], v204 offset:32
    buffer_load_dwordx4 v215, s[12:15], s17 offen offset:3264 lds
    s_add_u32 s17, s17, 458752
    s_cmp_ge_u32 s17, 7340032
    s_cselect_b32 s17, s55, s17
    v_mfma_f32_16x16x32_bf16 v[36:39], v[180:183], v[132:135], v[36:39]
    ds_read_b64_tr_b16 v[150:151], v204 offset:1120
    v_mfma_f32_16x16x32_bf16 v[40:43], v[180:183], v[136:139], v[40:43]
    v_mfma_f32_16x16x32_bf16 v[44:47], v[180:183], v[140:143], v[44:47]
    ds_read_b64_tr_b16 v[152:153], v204 offset:64
    s_add_u32 m0, s36, 65536
    s_nop 0
    buffer_load_dwordx4 v208, s[8:11], s16 offen offset:0 lds
    v_mfma_f32_16x16x32_bf16 v[48:51], v[184:187], v[128:131], v[48:51]
    ds_read_b64_tr_b16 v[154:155], v204 offset:1152
    v_mfma_f32_16x16x32_bf16 v[52:55], v[184:187], v[132:135], v[52:55]
    ds_read_b64_tr_b16 v[156:157], v204 offset:96
    v_mfma_f32_16x16x32_bf16 v[56:59], v[184:187], v[136:139], v[56:59]
    buffer_load_dwordx4 v209, s[8:11], s16 offen offset:1024 lds
    v_mfma_f32_16x16x32_bf16 v[60:63], v[184:187], v[140:143], v[60:63]
    ds_read_b64_tr_b16 v[158:159], v204 offset:1184
    v_mfma_f32_16x16x32_bf16 v[64:67], v[188:191], v[128:131], v[64:67]
    ds_read_b64_tr_b16 v[160:161], v204 offset:128
    v_mfma_f32_16x16x32_bf16 v[68:71], v[188:191], v[132:135], v[68:71]
    buffer_load_dwordx4 v210, s[8:11], s16 offen offset:2048 lds
    v_mfma_f32_16x16x32_bf16 v[72:75], v[188:191], v[136:139], v[72:75]
    ds_read_b64_tr_b16 v[162:163], v204 offset:1216
    v_mfma_f32_16x16x32_bf16 v[76:79], v[188:191], v[140:143], v[76:79]
    ds_read_b64_tr_b16 v[164:165], v204 offset:160
    v_mfma_f32_16x16x32_bf16 v[80:83], v[192:195], v[128:131], v[80:83]
    s_waitcnt lgkmcnt(14)
    ds_read_b64_tr_b16 v[166:167], v204 offset:1248
    buffer_load_dwordx4 v211, s[8:11], s16 offen offset:3072 lds
    s_add_u32 s16, s16, 128
    s_and_b32 s16, s16, 2047
    v_mfma_f32_16x16x32_bf16 v[84:87], v[192:195], v[132:135], v[84:87]
    v_mfma_f32_16x16x32_bf16 v[88:91], v[192:195], v[136:139], v[88:91]
    s_waitcnt lgkmcnt(14)
    ds_read_b64_tr_b16 v[168:169], v204 offset:192
    s_setprio 0
    v_mfma_f32_16x16x32_bf16 v[92:95], v[192:195], v[140:143], v[92:95]
    s_waitcnt lgkmcnt(14)
    ds_read_b64_tr_b16 v[170:171], v204 offset:1280
    v_mfma_f32_16x16x32_bf16 v[96:99], v[196:199], v[128:131], v[96:99]
    v_mfma_f32_16x16x32_bf16 v[100:103], v[196:199], v[132:135], v[100:103]
    v_mfma_f32_16x16x32_bf16 v[104:107], v[196:199], v[136:139], v[104:107]
    v_mfma_f32_16x16x32_bf16 v[108:111], v[196:199], v[140:143], v[108:111]
    v_mfma_f32_16x16x32_bf16 v[0:3], v[144:147], v[112:115], v[0:3]
    s_waitcnt lgkmcnt(14)
    ds_read_b128 v[128:131], v201 offset:0
    v_mfma_f32_16x16x32_bf16 v[4:7], v[144:147], v[116:119], v[4:7]
    s_waitcnt lgkmcnt(14)
    ds_read_b64_tr_b16 v[172:173], v204 offset:8704
    v_mfma_f32_16x16x32_bf16 v[8:11], v[144:147], v[120:123], v[8:11]
    s_waitcnt lgkmcnt(14)
    ds_read_b64_tr_b16 v[174:175], v204 offset:9792
    v_mfma_f32_16x16x32_bf16 v[12:15], v[144:147], v[124:127], v[12:15]
    s_waitcnt lgkmcnt(14)
    ds_read_b128 v[132:135], v201 offset:2048
    s_waitcnt lgkmcnt(14)
    v_mfma_f32_16x16x32_bf16 v[16:19], v[148:151], v[112:115], v[16:19]
    ds_read_b128 v[136:139], v201 offset:4096
    v_mfma_f32_16x16x32_bf16 v[20:23], v[148:151], v[116:119], v[20:23]
    s_waitcnt lgkmcnt(14)
    ds_read_b128 v[140:143], v201 offset:6144
    v_mfma_f32_16x16x32_bf16 v[24:27], v[148:151], v[120:123], v[24:27]
    v_mfma_f32_16x16x32_bf16 v[28:31], v[148:151], v[124:127], v[28:31]
    s_waitcnt lgkmcnt(14)
    ds_read_b64_tr_b16 v[176:177], v204 offset:8736
    v_mfma_f32_16x16x32_bf16 v[32:35], v[152:155], v[112:115], v[32:35]
    s_waitcnt lgkmcnt(14)
    ds_read_b64_tr_b16 v[178:179], v204 offset:9824
    v_mfma_f32_16x16x32_bf16 v[36:39], v[152:155], v[116:119], v[36:39]
    s_waitcnt lgkmcnt(14)
    ds_read_b64_tr_b16 v[180:181], v204 offset:8768
    v_mfma_f32_16x16x32_bf16 v[40:43], v[152:155], v[120:123], v[40:43]
    s_waitcnt lgkmcnt(14)
    ds_read_b64_tr_b16 v[182:183], v204 offset:9856
    v_mfma_f32_16x16x32_bf16 v[44:47], v[152:155], v[124:127], v[44:47]
    s_waitcnt lgkmcnt(14)
    ds_read_b64_tr_b16 v[184:185], v204 offset:8800
    v_mfma_f32_16x16x32_bf16 v[48:51], v[156:159], v[112:115], v[48:51]
    s_waitcnt lgkmcnt(14)
    ds_read_b64_tr_b16 v[186:187], v204 offset:9888
    v_mfma_f32_16x16x32_bf16 v[52:55], v[156:159], v[116:119], v[52:55]
    v_mfma_f32_16x16x32_bf16 v[56:59], v[156:159], v[120:123], v[56:59]
    s_waitcnt lgkmcnt(14)
    ds_read_b64_tr_b16 v[188:189], v204 offset:8832
    v_mfma_f32_16x16x32_bf16 v[60:63], v[156:159], v[124:127], v[60:63]
    s_waitcnt lgkmcnt(14)
    ds_read_b64_tr_b16 v[190:191], v204 offset:9920
    v_mfma_f32_16x16x32_bf16 v[64:67], v[160:163], v[112:115], v[64:67]
    s_waitcnt lgkmcnt(14)
    ds_read_b64_tr_b16 v[192:193], v204 offset:8864
    v_mfma_f32_16x16x32_bf16 v[68:71], v[160:163], v[116:119], v[68:71]
    s_waitcnt lgkmcnt(14)
    ds_read_b64_tr_b16 v[194:195], v204 offset:9952
    v_mfma_f32_16x16x32_bf16 v[72:75], v[160:163], v[120:123], v[72:75]
    s_waitcnt lgkmcnt(14)
    ds_read_b64_tr_b16 v[196:197], v204 offset:8896
    v_mfma_f32_16x16x32_bf16 v[76:79], v[160:163], v[124:127], v[76:79]
    s_waitcnt lgkmcnt(14)
    ds_read_b64_tr_b16 v[198:199], v204 offset:9984
    v_mfma_f32_16x16x32_bf16 v[80:83], v[164:167], v[112:115], v[80:83]
    v_mfma_f32_16x16x32_bf16 v[84:87], v[164:167], v[116:119], v[84:87]
    v_mfma_f32_16x16x32_bf16 v[88:91], v[164:167], v[120:123], v[88:91]
    v_mfma_f32_16x16x32_bf16 v[92:95], v[164:167], v[124:127], v[92:95]
    v_mfma_f32_16x16x32_bf16 v[96:99], v[168:171], v[112:115], v[96:99]
    v_mfma_f32_16x16x32_bf16 v[100:103], v[168:171], v[116:119], v[100:103]
    s_waitcnt vmcnt(4) lgkmcnt(0)
    s_barrier
    s_setprio 1
    v_mfma_f32_16x16x32_bf16 v[104:107], v[168:171], v[120:123], v[104:107]
    v_mfma_f32_16x16x32_bf16 v[108:111], v[168:171], v[124:127], v[108:111]
    v_mfma_f32_16x16x32_bf16 v[0:3], v[172:175], v[128:131], v[0:3]
    ds_read_b128 v[112:115], v200 offset:32768
    s_add_u32 m0, s37, 122880
    s_nop 0
    buffer_load_dwordx4 v212, s[12:15], s17 offen offset:0 lds
    v_mfma_f32_16x16x32_bf16 v[4:7], v[172:175], v[132:135], v[4:7]
    ds_read_b64_tr_b16 v[144:145], v204 offset:17408
    v_mfma_f32_16x16x32_bf16 v[8:11], v[172:175], v[136:139], v[8:11]
    ds_read_b64_tr_b16 v[146:147], v204 offset:18496
    buffer_load_dwordx4 v213, s[12:15], s17 offen offset:1088 lds
    v_mfma_f32_16x16x32_bf16 v[12:15], v[172:175], v[140:143], v[12:15]
    v_mfma_f32_16x16x32_bf16 v[16:19], v[176:179], v[128:131], v[16:19]
    ds_read_b128 v[116:119], v200 offset:34816
    v_mfma_f32_16x16x32_bf16 v[20:23], v[176:179], v[132:135], v[20:23]
    ds_read_b128 v[120:123], v200 offset:36864
    buffer_load_dwordx4 v214, s[12:15], s17 offen offset:2176 lds
    v_mfma_f32_16x16x32_bf16 v[24:27], v[176:179], v[136:139], v[24:27]
    ds_read_b128 v[124:127], v200 offset:38912
    v_mfma_f32_16x16x32_bf16 v[28:31], v[176:179], v[140:143], v[28:31]
    v_mfma_f32_16x16x32_bf16 v[32:35], v[180:183], v[128:131], v[32:35]
    ds_read_b64_tr_b16 v[148:149], v204 offset:17440
    buffer_load_dwordx4 v215, s[12:15], s17 offen offset:3264 lds
    s_add_u32 s17, s17, 458752
    v_mfma_f32_16x16x32_bf16 v[36:39], v[180:183], v[132:135], v[36:39]
    ds_read_b64_tr_b16 v[150:151], v204 offset:18528
    v_mfma_f32_16x16x32_bf16 v[40:43], v[180:183], v[136:139], v[40:43]
    v_mfma_f32_16x16x32_bf16 v[44:47], v[180:183], v[140:143], v[44:47]
    ds_read_b64_tr_b16 v[152:153], v204 offset:17472
    s_add_u32 m0, s36, 0
    s_nop 0
    buffer_load_dwordx4 v208, s[8:11], s16 offen offset:0 lds
    v_mfma_f32_16x16x32_bf16 v[48:51], v[184:187], v[128:131], v[48:51]
    ds_read_b64_tr_b16 v[154:155], v204 offset:18560
    v_mfma_f32_16x16x32_bf16 v[52:55], v[184:187], v[132:135], v[52:55]
    ds_read_b64_tr_b16 v[156:157], v204 offset:17504
    v_mfma_f32_16x16x32_bf16 v[56:59], v[184:187], v[136:139], v[56:59]
    buffer_load_dwordx4 v209, s[8:11], s16 offen offset:1024 lds
    v_mfma_f32_16x16x32_bf16 v[60:63], v[184:187], v[140:143], v[60:63]
    ds_read_b64_tr_b16 v[158:159], v204 offset:18592
    v_mfma_f32_16x16x32_bf16 v[64:67], v[188:191], v[128:131], v[64:67]
    ds_read_b64_tr_b16 v[160:161], v204 offset:17536
    v_mfma_f32_16x16x32_bf16 v[68:71], v[188:191], v[132:135], v[68:71]
    buffer_load_dwordx4 v210, s[8:11], s16 offen offset:2048 lds
    v_mfma_f32_16x16x32_bf16 v[72:75], v[188:191], v[136:139], v[72:75]
    ds_read_b64_tr_b16 v[162:163], v204 offset:18624
    v_mfma_f32_16x16x32_bf16 v[76:79], v[188:191], v[140:143], v[76:79]
    ds_read_b64_tr_b16 v[164:165], v204 offset:17568
    v_mfma_f32_16x16x32_bf16 v[80:83], v[192:195], v[128:131], v[80:83]
    s_waitcnt lgkmcnt(14)
    ds_read_b64_tr_b16 v[166:167], v204 offset:18656
    buffer_load_dwordx4 v211, s[8:11], s16 offen offset:3072 lds
    s_add_u32 s16, s16, 128
    s_and_b32 s16, s16, 2047
    v_mfma_f32_16x16x32_bf16 v[84:87], v[192:195], v[132:135], v[84:87]
    v_mfma_f32_16x16x32_bf16 v[88:91], v[192:195], v[136:139], v[88:91]
    s_waitcnt lgkmcnt(14)
    ds_read_b64_tr_b16 v[168:169], v204 offset:17600
    buffer_load_dword v253, v252, s[48:51], 0 offen sc1
    s_setprio 0
    v_mfma_f32_16x16x32_bf16 v[92:95], v[192:195], v[140:143], v[92:95]
    s_waitcnt lgkmcnt(14)
    ds_read_b64_tr_b16 v[170:171], v204 offset:18688
    v_mfma_f32_16x16x32_bf16 v[96:99], v[196:199], v[128:131], v[96:99]
    v_mfma_f32_16x16x32_bf16 v[100:103], v[196:199], v[132:135], v[100:103]
    v_mfma_f32_16x16x32_bf16 v[104:107], v[196:199], v[136:139], v[104:107]
    v_mfma_f32_16x16x32_bf16 v[108:111], v[196:199], v[140:143], v[108:111]
    v_mfma_f32_16x16x32_bf16 v[0:3], v[144:147], v[112:115], v[0:3]
    s_waitcnt lgkmcnt(14)
    ds_read_b128 v[128:131], v201 offset:32768
    v_mfma_f32_16x16x32_bf16 v[4:7], v[144:147], v[116:119], v[4:7]
    s_waitcnt lgkmcnt(14)
    ds_read_b64_tr_b16 v[172:173], v204 offset:26112
    v_mfma_f32_16x16x32_bf16 v[8:11], v[144:147], v[120:123], v[8:11]
    s_waitcnt lgkmcnt(14)
    ds_read_b64_tr_b16 v[174:175], v204 offset:27200
    v_mfma_f32_16x16x32_bf16 v[12:15], v[144:147], v[124:127], v[12:15]
    s_waitcnt lgkmcnt(14)
    ds_read_b128 v[132:135], v201 offset:34816
    s_waitcnt lgkmcnt(14)
    v_mfma_f32_16x16x32_bf16 v[16:19], v[148:151], v[112:115], v[16:19]
    ds_read_b128 v[136:139], v201 offset:36864
    v_mfma_f32_16x16x32_bf16 v[20:23], v[148:151], v[116:119], v[20:23]
    s_waitcnt lgkmcnt(14)
    ds_read_b128 v[140:143], v201 offset:38912
    v_mfma_f32_16x16x32_bf16 v[24:27], v[148:151], v[120:123], v[24:27]
    v_mfma_f32_16x16x32_bf16 v[28:31], v[148:151], v[124:127], v[28:31]
    s_waitcnt lgkmcnt(14)
    ds_read_b64_tr_b16 v[176:177], v204 offset:26144
    v_mfma_f32_16x16x32_bf16 v[32:35], v[152:155], v[112:115], v[32:35]
    s_waitcnt lgkmcnt(14)
    ds_read_b64_tr_b16 v[178:179], v204 offset:27232
    v_mfma_f32_16x16x32_bf16 v[36:39], v[152:155], v[116:119], v[36:39]
    s_waitcnt lgkmcnt(14)
    ds_read_b64_tr_b16 v[180:181], v204 offset:26176
    v_mfma_f32_16x16x32_bf16 v[40:43], v[152:155], v[120:123], v[40:43]
    s_waitcnt lgkmcnt(14)
    ds_read_b64_tr_b16 v[182:183], v204 offset:27264
    v_mfma_f32_16x16x32_bf16 v[44:47], v[152:155], v[124:127], v[44:47]
    s_waitcnt lgkmcnt(14)
    ds_read_b64_tr_b16 v[184:185], v204 offset:26208
    v_mfma_f32_16x16x32_bf16 v[48:51], v[156:159], v[112:115], v[48:51]
    s_waitcnt lgkmcnt(14)
    ds_read_b64_tr_b16 v[186:187], v204 offset:27296
    v_mfma_f32_16x16x32_bf16 v[52:55], v[156:159], v[116:119], v[52:55]
    v_mfma_f32_16x16x32_bf16 v[56:59], v[156:159], v[120:123], v[56:59]
    s_waitcnt lgkmcnt(14)
    ds_read_b64_tr_b16 v[188:189], v204 offset:26240
    v_mfma_f32_16x16x32_bf16 v[60:63], v[156:159], v[124:127], v[60:63]
    s_waitcnt lgkmcnt(14)
    ds_read_b64_tr_b16 v[190:191], v204 offset:27328
    v_mfma_f32_16x16x32_bf16 v[64:67], v[160:163], v[112:115], v[64:67]
    s_waitcnt lgkmcnt(14)
    ds_read_b64_tr_b16 v[192:193], v204 offset:26272
    v_mfma_f32_16x16x32_bf16 v[68:71], v[160:163], v[116:119], v[68:71]
    s_waitcnt lgkmcnt(14)
    ds_read_b64_tr_b16 v[194:195], v204 offset:27360
    v_mfma_f32_16x16x32_bf16 v[72:75], v[160:163], v[120:123], v[72:75]
    s_waitcnt lgkmcnt(14)
    ds_read_b64_tr_b16 v[196:197], v204 offset:26304
    v_mfma_f32_16x16x32_bf16 v[76:79], v[160:163], v[124:127], v[76:79]
    s_waitcnt lgkmcnt(14)
    ds_read_b64_tr_b16 v[198:199], v204 offset:27392
    v_mfma_f32_16x16x32_bf16 v[80:83], v[164:167], v[112:115], v[80:83]
    v_mfma_f32_16x16x32_bf16 v[84:87], v[164:167], v[116:119], v[84:87]
    v_mfma_f32_16x16x32_bf16 v[88:91], v[164:167], v[120:123], v[88:91]
    v_mfma_f32_16x16x32_bf16 v[92:95], v[164:167], v[124:127], v[92:95]
    v_mfma_f32_16x16x32_bf16 v[96:99], v[168:171], v[112:115], v[96:99]
    v_mfma_f32_16x16x32_bf16 v[100:103], v[168:171], v[116:119], v[100:103]
    s_waitcnt vmcnt(5) lgkmcnt(0)
    s_barrier
    s_setprio 1
    v_mfma_f32_16x16x32_bf16 v[104:107], v[168:171], v[120:123], v[104:107]
    v_mfma_f32_16x16x32_bf16 v[108:111], v[168:171], v[124:127], v[108:111]
    v_mfma_f32_16x16x32_bf16 v[0:3], v[172:175], v[128:131], v[0:3]
    ds_read_b128 v[112:115], v202 offset:0
    s_add_u32 m0, s37, 140288
    s_nop 0
    buffer_load_dwordx4 v212, s[12:15], s17 offen offset:0 lds
    v_mfma_f32_16x16x32_bf16 v[4:7], v[172:175], v[132:135], v[4:7]
    ds_read_b64_tr_b16 v[144:145], v204 offset:0
    v_mfma_f32_16x16x32_bf16 v[8:11], v[172:175], v[136:139], v[8:11]
    ds_read_b64_tr_b16 v[146:147], v204 offset:1088
    v_mfma_f32_16x16x32_bf16 v[12:15], v[172:175], v[140:143], v[12:15]
    v_mfma_f32_16x16x32_bf16 v[16:19], v[176:179], v[128:131], v[16:19]
    ds_read_b128 v[116:119], v202 offset:2048
    v_mfma_f32_16x16x32_bf16 v[20:23], v[176:179], v[132:135], v[20:23]
    ds_read_b128 v[120:123], v202 offset:4096
    buffer_load_dwordx4 v213, s[12:15], s17 offen offset:1088 lds
    v_mfma_f32_16x16x32_bf16 v[24:27], v[176:179], v[136:139], v[24:27]
    ds_read_b128 v[124:127], v202 offset:6144
    v_mfma_f32_16x16x32_bf16 v[28:31], v[176:179], v[140:143], v[28:31]
    v_mfma_f32_16x16x32_bf16 v[32:35], v[180:183], v[128:131], v[32:35]
    ds_read_b64_tr_b16 v[148:149], v204 offset:32
    v_mfma_f32_16x16x32_bf16 v[36:39], v[180:183], v[132:135], v[36:39]
    ds_read_b64_tr_b16 v[150:151], v204 offset:1120
    v_mfma_f32_16x16x32_bf16 v[40:43], v[180:183], v[136:139], v[40:43]
    v_mfma_f32_16x16x32_bf16 v[44:47], v[180:183], v[140:143], v[44:47]
    ds_read_b64_tr_b16 v[152:153], v204 offset:64
    buffer_load_dwordx4 v214, s[12:15], s17 offen offset:2176 lds
    v_mfma_f32_16x16x32_bf16 v[48:51], v[184:187], v[128:131], v[48:51]
    ds_read_b64_tr_b16 v[154:155], v204 offset:1152
    v_mfma_f32_16x16x32_bf16 v[52:55], v[184:187], v[132:135], v[52:55]
    ds_read_b64_tr_b16 v[156:157], v204 offset:96
    v_mfma_f32_16x16x32_bf16 v[56:59], v[184:187], v[136:139], v[56:59]
    v_mfma_f32_16x16x32_bf16 v[60:63], v[184:187], v[140:143], v[60:63]
    ds_read_b64_tr_b16 v[158:159], v204 offset:1184
    v_mfma_f32_16x16x32_bf16 v[64:67], v[188:191], v[128:131], v[64:67]
    ds_read_b64_tr_b16 v[160:161], v204 offset:128
    v_mfma_f32_16x16x32_bf16 v[68:71], v[188:191], v[132:135], v[68:71]
    buffer_load_dwordx4 v215, s[12:15], s17 offen offset:3264 lds
    s_add_u32 s17, s17, 458752
    s_cmp_ge_u32 s17, 7340032
    s_cselect_b32 s17, s55, s17
    v_mfma_f32_16x16x32_bf16 v[72:75], v[188:191], v[136:139], v[72:75]
    ds_read_b64_tr_b16 v[162:163], v204 offset:1216
    v_mfma_f32_16x16x32_bf16 v[76:79], v[188:191], v[140:143], v[76:79]
    ds_read_b64_tr_b16 v[164:165], v204 offset:160
    v_mfma_f32_16x16x32_bf16 v[80:83], v[192:195], v[128:131], v[80:83]
    s_waitcnt lgkmcnt(14)
    ds_read_b64_tr_b16 v[166:167], v204 offset:1248
    v_mfma_f32_16x16x32_bf16 v[84:87], v[192:195], v[132:135], v[84:87]
    v_mfma_f32_16x16x32_bf16 v[88:91], v[192:195], v[136:139], v[88:91]
    s_waitcnt lgkmcnt(14)
    ds_read_b64_tr_b16 v[168:169], v204 offset:192
    s_setprio 0
    v_mfma_f32_16x16x32_bf16 v[92:95], v[192:195], v[140:143], v[92:95]
    s_waitcnt lgkmcnt(14)
    ds_read_b64_tr_b16 v[170:171], v204 offset:1280
    v_mfma_f32_16x16x32_bf16 v[96:99], v[196:199], v[128:131], v[96:99]
    v_mfma_f32_16x16x32_bf16 v[100:103], v[196:199], v[132:135], v[100:103]
    v_mfma_f32_16x16x32_bf16 v[104:107], v[196:199], v[136:139], v[104:107]
    v_mfma_f32_16x16x32_bf16 v[108:111], v[196:199], v[140:143], v[108:111]
    v_mfma_f32_16x16x32_bf16 v[0:3], v[144:147], v[112:115], v[0:3]
    s_waitcnt lgkmcnt(14)
    ds_read_b128 v[128:131], v203 offset:0
    v_mfma_f32_16x16x32_bf16 v[4:7], v[144:147], v[116:119], v[4:7]
    s_waitcnt lgkmcnt(14)
    ds_read_b64_tr_b16 v[172:173], v204 offset:8704
    v_mfma_f32_16x16x32_bf16 v[8:11], v[144:147], v[120:123], v[8:11]
    s_waitcnt lgkmcnt(14)
    ds_read_b64_tr_b16 v[174:175], v204 offset:9792
    v_mfma_f32_16x16x32_bf16 v[12:15], v[144:147], v[124:127], v[12:15]
    s_waitcnt lgkmcnt(14)
    ds_read_b128 v[132:135], v203 offset:2048
    s_waitcnt lgkmcnt(14)
    v_mfma_f32_16x16x32_bf16 v[16:19], v[148:151], v[112:115], v[16:19]
    ds_read_b128 v[136:139], v203 offset:4096
    v_mfma_f32_16x16x32_bf16 v[20:23], v[148:151], v[116:119], v[20:23]
    s_waitcnt lgkmcnt(14)
    ds_read_b128 v[140:143], v203 offset:6144
    v_mfma_f32_16x16x32_bf16 v[24:27], v[148:151], v[120:123], v[24:27]
    v_mfma_f32_16x16x32_bf16 v[28:31], v[148:151], v[124:127], v[28:31]
    s_waitcnt lgkmcnt(14)
    ds_read_b64_tr_b16 v[176:177], v204 offset:8736
    v_mfma_f32_16x16x32_bf16 v[32:35], v[152:155], v[112:115], v[32:35]
    s_waitcnt lgkmcnt(14)
    ds_read_b64_tr_b16 v[178:179], v204 offset:9824
    v_mfma_f32_16x16x32_bf16 v[36:39], v[152:155], v[116:119], v[36:39]
    s_waitcnt lgkmcnt(14)
    ds_read_b64_tr_b16 v[180:181], v204 offset:8768
    v_mfma_f32_16x16x32_bf16 v[40:43], v[152:155], v[120:123], v[40:43]
    s_waitcnt lgkmcnt(14)
    ds_read_b64_tr_b16 v[182:183], v204 offset:9856
    v_mfma_f32_16x16x32_bf16 v[44:47], v[152:155], v[124:127], v[44:47]
    s_waitcnt lgkmcnt(14)
    ds_read_b64_tr_b16 v[184:185], v204 offset:8800
    v_mfma_f32_16x16x32_bf16 v[48:51], v[156:159], v[112:115], v[48:51]
    s_waitcnt lgkmcnt(14)
    ds_read_b64_tr_b16 v[186:187], v204 offset:9888
    v_mfma_f32_16x16x32_bf16 v[52:55], v[156:159], v[116:119], v[52:55]
    v_mfma_f32_16x16x32_bf16 v[56:59], v[156:159], v[120:123], v[56:59]
    s_waitcnt lgkmcnt(14)
    ds_read_b64_tr_b16 v[188:189], v204 offset:8832
    v_mfma_f32_16x16x32_bf16 v[60:63], v[156:159], v[124:127], v[60:63]
    s_waitcnt lgkmcnt(14)
    ds_read_b64_tr_b16 v[190:191], v204 offset:9920
    v_mfma_f32_16x16x32_bf16 v[64:67], v[160:163], v[112:115], v[64:67]
    s_waitcnt lgkmcnt(14)
    ds_read_b64_tr_b16 v[192:193], v204 offset:8864
    v_mfma_f32_16x16x32_bf16 v[68:71], v[160:163], v[116:119], v[68:71]
    s_waitcnt lgkmcnt(14)
    ds_read_b64_tr_b16 v[194:195], v204 offset:9952
    v_mfma_f32_16x16x32_bf16 v[72:75], v[160:163], v[120:123], v[72:75]
    s_waitcnt lgkmcnt(14)
    ds_read_b64_tr_b16 v[196:197], v204 offset:8896
    v_mfma_f32_16x16x32_bf16 v[76:79], v[160:163], v[124:127], v[76:79]
    s_waitcnt lgkmcnt(14)
    ds_read_b64_tr_b16 v[198:199], v204 offset:9984
    v_mfma_f32_16x16x32_bf16 v[80:83], v[164:167], v[112:115], v[80:83]
    v_mfma_f32_16x16x32_bf16 v[84:87], v[164:167], v[116:119], v[84:87]
    v_mfma_f32_16x16x32_bf16 v[88:91], v[164:167], v[120:123], v[88:91]
    v_mfma_f32_16x16x32_bf16 v[92:95], v[164:167], v[124:127], v[92:95]
    v_mfma_f32_16x16x32_bf16 v[96:99], v[168:171], v[112:115], v[96:99]
    v_mfma_f32_16x16x32_bf16 v[100:103], v[168:171], v[116:119], v[100:103]
    s_waitcnt vmcnt(0) lgkmcnt(0)
    s_barrier
    s_setprio 1
    v_mfma_f32_16x16x32_bf16 v[104:107], v[168:171], v[120:123], v[104:107]
    v_mfma_f32_16x16x32_bf16 v[108:111], v[168:171], v[124:127], v[108:111]
    v_mfma_f32_16x16x32_bf16 v[0:3], v[172:175], v[128:131], v[0:3]
    s_waitcnt vmcnt(4)
    v_cmp_eq_u32 vcc, 32, v253
    s_nop 0
    s_cmp_eq_u64 vcc, -1
    s_cbranch_scc1 polld_29
    s_mov_b32 s70, 1048576
poll_28:
    s_sleep 1
    buffer_load_dword v253, v252, s[48:51], 0 offen sc1
    s_waitcnt vmcnt(0)
    v_cmp_eq_u32 vcc, 32, v253
    s_nop 0
    s_cmp_eq_u64 vcc, -1
    s_cbranch_scc1 polld_29
    s_sub_u32 s70, s70, 1
    s_cmp_lg_u32 s70, 0
    s_cbranch_scc1 poll_28
polld_29:
    s_and_b32 s59, s71, 7
    s_add_u32 s59, s59, 32
    v_and_b32 v252, 7, v254
    v_mov_b32 v253, s59
    v_cmp_gt_u32 vcc, 8, v254
    s_nop 1
    v_cndmask_b32 v252, v253, v252, vcc
    v_lshlrev_b32 v252, 7, v252
    s_andn2_b32 s59, s71, 7
    s_lshl_b32 s59, s59, 7
    s_add_u32 s59, s59, 9437184
    buffer_load_dword v255, v252, s[44:47], s59 offen offset:40 sc1
    v_and_b32 v252, 15, v254
    v_lshlrev_b32 v252, 5, v252
    s_lshl_b32 s59, s52, 2
    s_add_u32 s59, s59, s25
    s_lshl_b32 s59, s59, 11
    s_add_u32 s59, s59, 8388608
    buffer_load_dwordx4 v[236:239], v252, s[44:47], s59 offen offset:0 sc1
    buffer_load_dwordx4 v[240:243], v252, s[44:47], s59 offen offset:512 sc1
    buffer_load_dwordx4 v[244:247], v252, s[44:47], s59 offen offset:1024 sc1
    buffer_load_dwordx4 v[248:251], v252, s[44:47], s59 offen offset:1536 sc1
    v_lshrrev_b32 v253, 4, v254
    v_lshl_add_u32 v253, v253, 3, v252
    s_lshl_b32 s59, s53, 13
    s_add_u32 s59, s59, 8458240
    v_pk_mov_b32 v[210:211], 0, 0
    buffer_load_dwordx2 v[208:209], v253, s[44:47], s59 offen offset:0 sc1
    v_pk_mov_b32 v[214:215], 0, 0
    buffer_load_dwordx2 v[212:213], v253, s[44:47], s59 offen offset:512 sc1
    v_pk_mov_b32 v[218:219], 0, 0
    buffer_load_dwordx2 v[216:217], v253, s[44:47], s59 offen offset:1024 sc1
    v_pk_mov_b32 v[222:223], 0, 0
    buffer_load_dwordx2 v[220:221], v253, s[44:47], s59 offen offset:1536 sc1
    v_pk_mov_b32 v[226:227], 0, 0
    buffer_load_dwordx2 v[224:225], v253, s[44:47], s59 offen offset:2048 sc1
    v_pk_mov_b32 v[230:231], 0, 0
    buffer_load_dwordx2 v[228:229], v253, s[44:47], s59 offen offset:2560 sc1
    v_pk_mov_b32 v[234:235], 0, 0
    buffer_load_dwordx2 v[232:233], v253, s[44:47], s59 offen offset:3072 sc1
    s_mov_b32 s96, s38
    s_mov_b32 s97, s39
    s_mov_b32 s98, 7168
    s_mov_b32 s99, 0x00020000
    v_lshlrev_b32 v252, 1, v254
    s_lshl_b32 s59, s54, 4
    s_add_u32 s59, s59, s55
    s_mov_b64 exec, 0xffff
    buffer_load_ushort v211, v252, s[96:99], s59 offen offset:0
    buffer_load_ushort v215, v252, s[96:99], s59 offen offset:32
    buffer_load_ushort v219, v252, s[96:99], s59 offen offset:64
    buffer_load_ushort v223, v252, s[96:99], s59 offen offset:96
    buffer_load_ushort v227, v252, s[96:99], s59 offen offset:128
    buffer_load_ushort v231, v252, s[96:99], s59 offen offset:160
    s_mul_i32 s59, s54, 96
    s_sub_u32 s59, s55, s59
    buffer_load_ushort v235, v252, s[96:99], s59 offen offset:192
    s_mov_b64 exec, -1
    ds_read_b128 v[112:115], v200 offset:0
    v_mfma_f32_16x16x32_bf16 v[4:7], v[172:175], v[132:135], v[4:7]
    ds_read_b64_tr_b16 v[144:145], v204 offset:17408
    v_mfma_f32_16x16x32_bf16 v[8:11], v[172:175], v[136:139], v[8:11]
    ds_read_b64_tr_b16 v[146:147], v204 offset:18496
    v_mfma_f32_16x16x32_bf16 v[12:15], v[172:175], v[140:143], v[12:15]
    v_mfma_f32_16x16x32_bf16 v[16:19], v[176:179], v[128:131], v[16:19]
    ds_read_b128 v[116:119], v200 offset:2048
    v_mfma_f32_16x16x32_bf16 v[20:23], v[176:179], v[132:135], v[20:23]
    ds_read_b128 v[120:123], v200 offset:4096
    v_mfma_f32_16x16x32_bf16 v[24:27], v[176:179], v[136:139], v[24:27]
    ds_read_b128 v[124:127], v200 offset:6144
    v_mfma_f32_16x16x32_bf16 v[28:31], v[176:179], v[140:143], v[28:31]
    v_mfma_f32_16x16x32_bf16 v[32:35], v[180:183], v[128:131], v[32:35]
    ds_read_b64_tr_b16 v[148:149], v204 offset:17440
    v_mfma_f32_16x16x32_bf16 v[36:39], v[180:183], v[132:135], v[36:39]
    ds_read_b64_tr_b16 v[150:151], v204 offset:18528
    v_mfma_f32_16x16x32_bf16 v[40:43], v[180:183], v[136:139], v[40:43]
    v_mfma_f32_16x16x32_bf16 v[44:47], v[180:183], v[140:143], v[44:47]
    ds_read_b64_tr_b16 v[152:153], v204 offset:17472
    v_mfma_f32_16x16x32_bf16 v[48:51], v[184:187], v[128:131], v[48:51]
    ds_read_b64_tr_b16 v[154:155], v204 offset:18560
    v_mfma_f32_16x16x32_bf16 v[52:55], v[184:187], v[132:135], v[52:55]
    ds_read_b64_tr_b16 v[156:157], v204 offset:17504
    v_mfma_f32_16x16x32_bf16 v[56:59], v[184:187], v[136:139], v[56:59]
    v_mfma_f32_16x16x32_bf16 v[60:63], v[184:187], v[140:143], v[60:63]
    ds_read_b64_tr_b16 v[158:159], v204 offset:18592
    v_mfma_f32_16x16x32_bf16 v[64:67], v[188:191], v[128:131], v[64:67]
    ds_read_b64_tr_b16 v[160:161], v204 offset:17536
    v_mfma_f32_16x16x32_bf16 v[68:71], v[188:191], v[132:135], v[68:71]
    v_mfma_f32_16x16x32_bf16 v[72:75], v[188:191], v[136:139], v[72:75]
    ds_read_b64_tr_b16 v[162:163], v204 offset:18624
    v_mfma_f32_16x16x32_bf16 v[76:79], v[188:191], v[140:143], v[76:79]
    ds_read_b64_tr_b16 v[164:165], v204 offset:17568
    v_mfma_f32_16x16x32_bf16 v[80:83], v[192:195], v[128:131], v[80:83]
    s_waitcnt lgkmcnt(14)
    ds_read_b64_tr_b16 v[166:167], v204 offset:18656
    v_mfma_f32_16x16x32_bf16 v[84:87], v[192:195], v[132:135], v[84:87]
    v_mfma_f32_16x16x32_bf16 v[88:91], v[192:195], v[136:139], v[88:91]
    s_waitcnt lgkmcnt(14)
    ds_read_b64_tr_b16 v[168:169], v204 offset:17600
    s_setprio 0
    v_mfma_f32_16x16x32_bf16 v[92:95], v[192:195], v[140:143], v[92:95]
    s_waitcnt lgkmcnt(14)
    ds_read_b64_tr_b16 v[170:171], v204 offset:18688
    v_mfma_f32_16x16x32_bf16 v[96:99], v[196:199], v[128:131], v[96:99]
    v_mfma_f32_16x16x32_bf16 v[100:103], v[196:199], v[132:135], v[100:103]
    v_mfma_f32_16x16x32_bf16 v[104:107], v[196:199], v[136:139], v[104:107]
    v_mfma_f32_16x16x32_bf16 v[108:111], v[196:199], v[140:143], v[108:111]
    v_mfma_f32_16x16x32_bf16 v[0:3], v[144:147], v[112:115], v[0:3]
    s_waitcnt lgkmcnt(14)
    ds_read_b128 v[128:131], v201 offset:0
    v_mfma_f32_16x16x32_bf16 v[4:7], v[144:147], v[116:119], v[4:7]
    s_waitcnt lgkmcnt(14)
    ds_read_b64_tr_b16 v[172:173], v204 offset:26112
    v_mfma_f32_16x16x32_bf16 v[8:11], v[144:147], v[120:123], v[8:11]
    s_waitcnt lgkmcnt(14)
    ds_read_b64_tr_b16 v[174:175], v204 offset:27200
    v_mfma_f32_16x16x32_bf16 v[12:15], v[144:147], v[124:127], v[12:15]
    s_waitcnt lgkmcnt(14)
    ds_read_b128 v[132:135], v201 offset:2048
    s_waitcnt lgkmcnt(14)
    v_mfma_f32_16x16x32_bf16 v[16:19], v[148:151], v[112:115], v[16:19]
    ds_read_b128 v[136:139], v201 offset:4096
    v_mfma_f32_16x16x32_bf16 v[20:23], v[148:151], v[116:119], v[20:23]
    s_waitcnt lgkmcnt(14)
    ds_read_b128 v[140:143], v201 offset:6144
    v_mfma_f32_16x16x32_bf16 v[24:27], v[148:151], v[120:123], v[24:27]
    v_mfma_f32_16x16x32_bf16 v[28:31], v[148:151], v[124:127], v[28:31]
    s_waitcnt lgkmcnt(14)
    ds_read_b64_tr_b16 v[176:177], v204 offset:26144
    v_mfma_f32_16x16x32_bf16 v[32:35], v[152:155], v[112:115], v[32:35]
    s_waitcnt lgkmcnt(14)
    ds_read_b64_tr_b16 v[178:179], v204 offset:27232
    v_mfma_f32_16x16x32_bf16 v[36:39], v[152:155], v[116:119], v[36:39]
    s_waitcnt lgkmcnt(14)
    ds_read_b64_tr_b16 v[180:181], v204 offset:26176
    v_mfma_f32_16x16x32_bf16 v[40:43], v[152:155], v[120:123], v[40:43]
    s_waitcnt lgkmcnt(14)
    ds_read_b64_tr_b16 v[182:183], v204 offset:27264
    v_mfma_f32_16x16x32_bf16 v[44:47], v[152:155], v[124:127], v[44:47]
    s_waitcnt lgkmcnt(14)
    ds_read_b64_tr_b16 v[184:185], v204 offset:26208
    v_mfma_f32_16x16x32_bf16 v[48:51], v[156:159], v[112:115], v[48:51]
    s_waitcnt lgkmcnt(14)
    ds_read_b64_tr_b16 v[186:187], v204 offset:27296
    v_mfma_f32_16x16x32_bf16 v[52:55], v[156:159], v[116:119], v[52:55]
    v_mfma_f32_16x16x32_bf16 v[56:59], v[156:159], v[120:123], v[56:59]
    s_waitcnt lgkmcnt(14)
    ds_read_b64_tr_b16 v[188:189], v204 offset:26240
    v_mfma_f32_16x16x32_bf16 v[60:63], v[156:159], v[124:127], v[60:63]
    s_waitcnt lgkmcnt(14)
    ds_read_b64_tr_b16 v[190:191], v204 offset:27328
    v_mfma_f32_16x16x32_bf16 v[64:67], v[160:163], v[112:115], v[64:67]
    s_waitcnt lgkmcnt(14)
    ds_read_b64_tr_b16 v[192:193], v204 offset:26272
    v_mfma_f32_16x16x32_bf16 v[68:71], v[160:163], v[116:119], v[68:71]
    s_waitcnt lgkmcnt(14)
    ds_read_b64_tr_b16 v[194:195], v204 offset:27360
    v_mfma_f32_16x16x32_bf16 v[72:75], v[160:163], v[120:123], v[72:75]
    s_waitcnt lgkmcnt(14)
    ds_read_b64_tr_b16 v[196:197], v204 offset:26304
    v_mfma_f32_16x16x32_bf16 v[76:79], v[160:163], v[124:127], v[76:79]
    s_waitcnt lgkmcnt(14)
    ds_read_b64_tr_b16 v[198:199], v204 offset:27392
    v_mfma_f32_16x16x32_bf16 v[80:83], v[164:167], v[112:115], v[80:83]
    v_mfma_f32_16x16x32_bf16 v[84:87], v[164:167], v[116:119], v[84:87]
    v_mfma_f32_16x16x32_bf16 v[88:91], v[164:167], v[120:123], v[88:91]
    v_mfma_f32_16x16x32_bf16 v[92:95], v[164:167], v[124:127], v[92:95]
    v_mfma_f32_16x16x32_bf16 v[96:99], v[168:171], v[112:115], v[96:99]
    v_mfma_f32_16x16x32_bf16 v[100:103], v[168:171], v[116:119], v[100:103]
    s_waitcnt lgkmcnt(0)
    s_barrier
    v_mfma_f32_16x16x32_bf16 v[104:107], v[168:171], v[120:123], v[104:107]
    v_mfma_f32_16x16x32_bf16 v[108:111], v[168:171], v[124:127], v[108:111]
    v_mfma_f32_16x16x32_bf16 v[0:3], v[172:175], v[128:131], v[0:3]
    v_mfma_f32_16x16x32_bf16 v[4:7], v[172:175], v[132:135], v[4:7]
    v_mfma_f32_16x16x32_bf16 v[8:11], v[172:175], v[136:139], v[8:11]
    v_mfma_f32_16x16x32_bf16 v[12:15], v[172:175], v[140:143], v[12:15]
    v_mfma_f32_16x16x32_bf16 v[16:19], v[176:179], v[128:131], v[16:19]
    v_mfma_f32_16x16x32_bf16 v[20:23], v[176:179], v[132:135], v[20:23]
    v_mfma_f32_16x16x32_bf16 v[24:27], v[176:179], v[136:139], v[24:27]
    v_mfma_f32_16x16x32_bf16 v[28:31], v[176:179], v[140:143], v[28:31]
    v_mfma_f32_16x16x32_bf16 v[32:35], v[180:183], v[128:131], v[32:35]
    v_mfma_f32_16x16x32_bf16 v[36:39], v[180:183], v[132:135], v[36:39]
    v_mfma_f32_16x16x32_bf16 v[40:43], v[180:183], v[136:139], v[40:43]
    v_mfma_f32_16x16x32_bf16 v[44:47], v[180:183], v[140:143], v[44:47]
    v_mfma_f32_16x16x32_bf16 v[48:51], v[184:187], v[128:131], v[48:51]
    v_mfma_f32_16x16x32_bf16 v[52:55], v[184:187], v[132:135], v[52:55]
    v_mfma_f32_16x16x32_bf16 v[56:59], v[184:187], v[136:139], v[56:59]
    v_mfma_f32_16x16x32_bf16 v[60:63], v[184:187], v[140:143], v[60:63]
    v_mfma_f32_16x16x32_bf16 v[64:67], v[188:191], v[128:131], v[64:67]
    v_mfma_f32_16x16x32_bf16 v[68:71], v[188:191], v[132:135], v[68:71]
    v_mfma_f32_16x16x32_bf16 v[72:75], v[188:191], v[136:139], v[72:75]
    v_mfma_f32_16x16x32_bf16 v[76:79], v[188:191], v[140:143], v[76:79]
    v_mfma_f32_16x16x32_bf16 v[80:83], v[192:195], v[128:131], v[80:83]
    v_mfma_f32_16x16x32_bf16 v[84:87], v[192:195], v[132:135], v[84:87]
    v_mfma_f32_16x16x32_bf16 v[88:91], v[192:195], v[136:139], v[88:91]
    s_setprio 0
    v_mfma_f32_16x16x32_bf16 v[92:95], v[192:195], v[140:143], v[92:95]
    v_mfma_f32_16x16x32_bf16 v[96:99], v[196:199], v[128:131], v[96:99]
    v_mfma_f32_16x16x32_bf16 v[100:103], v[196:199], v[132:135], v[100:103]
    v_mfma_f32_16x16x32_bf16 v[104:107], v[196:199], v[136:139], v[104:107]
    v_mfma_f32_16x16x32_bf16 v[108:111], v[196:199], v[140:143], v[108:111]
    s_waitcnt vmcnt(0)
    s_setprio 2
    v_cmp_eq_u32 vcc, s28, v255
    s_nop 0
    s_and_b32 s29, vcc_lo, 0xff
    s_bfe_u32 s31, vcc_lo, 0x80008
    s_mov_b32 s31, 0
    s_mov_b32 s58, 0x05040100
    v_perm_b32 v210, v209, v208, s58
    v_lshl_or_b32 v211, v211, 16, v211
    v_perm_b32 v214, v213, v212, s58
    v_lshl_or_b32 v215, v215, 16, v215
    v_perm_b32 v218, v217, v216, s58
    v_lshl_or_b32 v219, v219, 16, v219
    v_perm_b32 v222, v221, v220, s58
    v_lshl_or_b32 v223, v223, 16, v223
    v_perm_b32 v226, v225, v224, s58
    v_lshl_or_b32 v227, v227, 16, v227
    v_perm_b32 v230, v229, v228, s58
    v_lshl_or_b32 v231, v231, 16, v231
    v_perm_b32 v234, v233, v232, s58
    v_lshl_or_b32 v235, v235, 16, v235
    v_mfma_f32_16x16x32_bf16 v[0:3], v[208:211], v[236:239], v[0:3]
    v_mfma_f32_16x16x32_bf16 v[4:7], v[208:211], v[240:243], v[4:7]
    v_mfma_f32_16x16x32_bf16 v[8:11], v[208:211], v[244:247], v[8:11]
    v_mfma_f32_16x16x32_bf16 v[12:15], v[208:211], v[248:251], v[12:15]
    v_mfma_f32_16x16x32_bf16 v[16:19], v[212:215], v[236:239], v[16:19]
    v_mfma_f32_16x16x32_bf16 v[20:23], v[212:215], v[240:243], v[20:23]
    v_mfma_f32_16x16x32_bf16 v[24:27], v[212:215], v[244:247], v[24:27]
    v_mfma_f32_16x16x32_bf16 v[28:31], v[212:215], v[248:251], v[28:31]
    v_mfma_f32_16x16x32_bf16 v[32:35], v[216:219], v[236:239], v[32:35]
    v_mfma_f32_16x16x32_bf16 v[36:39], v[216:219], v[240:243], v[36:39]
    v_mfma_f32_16x16x32_bf16 v[40:43], v[216:219], v[244:247], v[40:43]
    v_mfma_f32_16x16x32_bf16 v[44:47], v[216:219], v[248:251], v[44:47]
    v_mfma_f32_16x16x32_bf16 v[48:51], v[220:223], v[236:239], v[48:51]
    v_mfma_f32_16x16x32_bf16 v[52:55], v[220:223], v[240:243], v[52:55]
    v_mfma_f32_16x16x32_bf16 v[56:59], v[220:223], v[244:247], v[56:59]
    v_mfma_f32_16x16x32_bf16 v[60:63], v[220:223], v[248:251], v[60:63]
    v_mfma_f32_16x16x32_bf16 v[64:67], v[224:227], v[236:239], v[64:67]
    v_mfma_f32_16x16x32_bf16 v[68:71], v[224:227], v[240:243], v[68:71]
    v_mfma_f32_16x16x32_bf16 v[72:75], v[224:227], v[244:247], v[72:75]
    v_mfma_f32_16x16x32_bf16 v[76:79], v[224:227], v[248:251], v[76:79]
    v_mfma_f32_16x16x32_bf16 v[80:83], v[228:231], v[236:239], v[80:83]
    v_mfma_f32_16x16x32_bf16 v[84:87], v[228:231], v[240:243], v[84:87]
    v_mfma_f32_16x16x32_bf16 v[88:91], v[228:231], v[244:247], v[88:91]
    v_mfma_f32_16x16x32_bf16 v[92:95], v[228:231], v[248:251], v[92:95]
    v_mfma_f32_16x16x32_bf16 v[96:99], v[232:235], v[236:239], v[96:99]
    v_mfma_f32_16x16x32_bf16 v[100:103], v[232:235], v[240:243], v[100:103]
    v_mfma_f32_16x16x32_bf16 v[104:107], v[232:235], v[244:247], v[104:107]
    v_mfma_f32_16x16x32_bf16 v[108:111], v[232:235], v[248:251], v[108:111]
    v_and_b32 v112, 15, v254
    s_lshl_b32 s23, s25, 6
    v_add_u32 v112, s23, v112
    v_lshlrev_b32 v112, 6, v112
    v_bfe_u32 v113, v254, 4, 1
    v_lshrrev_b32 v114, 5, v254
    v_lshl_add_u32 v113, v113, 1, v114
    v_lshlrev_b32 v120, 16, v239
    v_and_b32 v121, 0xffff0000, v239
    v_add_f32 v120, v120, v121
    v_rcp_f32 v119, v120
    v_mov_b32 v121, v120
    v_mul_f32 v116, 0xc0135761, v119
    v_mul_f32 v118, v119, v119
    v_mov_b32 v117, v116
    v_mul_f32 v118, v118, v119
    v_mul_f32 v118, 0xbdd2d3e8, v118
    v_mov_b32 v119, v118
    v_lshlrev_b32 v126, 16, v243
    v_and_b32 v127, 0xffff0000, v243
    v_add_f32 v126, v126, v127
    v_rcp_f32 v125, v126
    v_mov_b32 v127, v126
    v_mul_f32 v122, 0xc0135761, v125
    v_mul_f32 v124, v125, v125
    v_mov_b32 v123, v122
    v_mul_f32 v124, v124, v125
    v_mul_f32 v124, 0xbdd2d3e8, v124
    v_mov_b32 v125, v124
    v_lshlrev_b32 v132, 16, v247
    v_and_b32 v133, 0xffff0000, v247
    v_add_f32 v132, v132, v133
    v_rcp_f32 v131, v132
    v_mov_b32 v133, v132
    v_mul_f32 v128, 0xc0135761, v131
    v_mul_f32 v130, v131, v131
    v_mov_b32 v129, v128
    v_mul_f32 v130, v130, v131
    v_mul_f32 v130, 0xbdd2d3e8, v130
    v_mov_b32 v131, v130
    v_lshlrev_b32 v138, 16, v251
    v_and_b32 v139, 0xffff0000, v251
    v_add_f32 v138, v138, v139
    v_rcp_f32 v137, v138
    v_mov_b32 v139, v138
    v_mul_f32 v134, 0xc0135761, v137
    v_mul_f32 v136, v137, v137
    v_mov_b32 v135, v134
    v_mul_f32 v136, v136, v137
    v_mul_f32 v136, 0xbdd2d3e8, v136
    v_mov_b32 v137, v136
    s_lshl_b32 s23, s52, 14
    v_add_u32 v112, s23, v112
    v_bfe_u32 v114, v254, 4, 1
    v_lshl_add_u32 v114, v114, 10, v112
    v_lshrrev_b32 v115, 5, v254
    v_lshl_add_u32 v114, v115, 4, v114
    v_lshl_add_u32 v113, v113, 4, v112
    s_mul_i32 s56, s53, 7
    s_add_u32 s56, s56, 65
    s_lshr_b32 s56, s56, 1
    s_lshl_b32 s56, s56, 17
    s_mul_i32 s57, s54, 262128
    s_sub_u32 s57, 393216, s57
    s_add_u32 s57, s57, s56
    v_pk_mul_f32 v[140:141], v[0:1], v[0:1]
    v_pk_mul_f32 v[142:143], v[2:3], v[2:3]
    v_pk_mul_f32 v[144:145], v[16:17], v[16:17]
    v_pk_mul_f32 v[146:147], v[18:19], v[18:19]
    v_pk_mul_f32 v[148:149], v[4:5], v[4:5]
    v_pk_mul_f32 v[150:151], v[6:7], v[6:7]
    v_pk_mul_f32 v[152:153], v[20:21], v[20:21]
    v_pk_mul_f32 v[154:155], v[22:23], v[22:23]
    v_pk_fma_f32 v[140:141], v[140:141], v[118:119], v[116:117]
    v_pk_fma_f32 v[142:143], v[142:143], v[118:119], v[116:117]
    v_pk_fma_f32 v[144:145], v[144:145], v[118:119], v[116:117]
    v_pk_fma_f32 v[146:147], v[146:147], v[118:119], v[116:117]
    v_pk_fma_f32 v[148:149], v[148:149], v[124:125], v[122:123]
    v_pk_fma_f32 v[150:151], v[150:151], v[124:125], v[122:123]
    v_pk_fma_f32 v[152:153], v[152:153], v[124:125], v[122:123]
    v_pk_fma_f32 v[154:155], v[154:155], v[124:125], v[122:123]
    v_pk_mul_f32 v[140:141], v[140:141], v[0:1]
    v_pk_mul_f32 v[142:143], v[142:143], v[2:3]
    v_pk_mul_f32 v[144:145], v[144:145], v[16:17]
    v_pk_mul_f32 v[146:147], v[146:147], v[18:19]
    v_pk_mul_f32 v[148:149], v[148:149], v[4:5]
    v_pk_mul_f32 v[150:151], v[150:151], v[6:7]
    v_pk_mul_f32 v[152:153], v[152:153], v[20:21]
    v_pk_mul_f32 v[154:155], v[154:155], v[22:23]
    v_exp_f32 v140, v140
    v_exp_f32 v141, v141
    v_exp_f32 v142, v142
    v_exp_f32 v143, v143
    v_exp_f32 v144, v144
    v_exp_f32 v145, v145
    v_exp_f32 v146, v146
    v_exp_f32 v147, v147
    v_exp_f32 v148, v148
    v_exp_f32 v149, v149
    v_exp_f32 v150, v150
    v_exp_f32 v151, v151
    v_exp_f32 v152, v152
    v_exp_f32 v153, v153
    v_exp_f32 v154, v154
    v_exp_f32 v155, v155
    v_pk_fma_f32 v[140:141], v[140:141], v[120:121], v[120:121]
    v_pk_fma_f32 v[142:143], v[142:143], v[120:121], v[120:121]
    v_pk_fma_f32 v[144:145], v[144:145], v[120:121], v[120:121]
    v_pk_fma_f32 v[146:147], v[146:147], v[120:121], v[120:121]
    v_pk_fma_f32 v[148:149], v[148:149], v[126:127], v[126:127]
    v_pk_fma_f32 v[150:151], v[150:151], v[126:127], v[126:127]
    v_pk_fma_f32 v[152:153], v[152:153], v[126:127], v[126:127]
    v_pk_fma_f32 v[154:155], v[154:155], v[126:127], v[126:127]
    v_rcp_f32 v140, v140
    v_rcp_f32 v141, v141
    v_rcp_f32 v142, v142
    v_rcp_f32 v143, v143
    v_rcp_f32 v144, v144
    v_rcp_f32 v145, v145
    v_rcp_f32 v146, v146
    v_rcp_f32 v147, v147
    v_rcp_f32 v148, v148
    v_rcp_f32 v149, v149
    v_rcp_f32 v150, v150
    v_rcp_f32 v151, v151
    v_rcp_f32 v152, v152
    v_rcp_f32 v153, v153
    v_rcp_f32 v154, v154
    v_rcp_f32 v155, v155
    v_pk_mul_f32 v[0:1], v[140:141], v[0:1]
    v_pk_mul_f32 v[2:3], v[142:143], v[2:3]
    v_pk_mul_f32 v[16:17], v[144:145], v[16:17]
    v_pk_mul_f32 v[18:19], v[146:147], v[18:19]
    v_pk_mul_f32 v[4:5], v[148:149], v[4:5]
    v_pk_mul_f32 v[6:7], v[150:151], v[6:7]
    v_pk_mul_f32 v[20:21], v[152:153], v[20:21]
    v_pk_mul_f32 v[22:23], v[154:155], v[22:23]
    v_cvt_pk_bf16_f32 v156, v0, v1
    v_cvt_pk_bf16_f32 v157, v2, v3
    v_cvt_pk_bf16_f32 v158, v16, v17
    v_cvt_pk_bf16_f32 v159, v18, v19
    s_nop 0
    v_permlane16_swap_b32 v156, v158
    v_permlane16_swap_b32 v157, v159
    s_cmp_eq_u32 s29, 0xff
    s_cbranch_scc0 p_30
    buffer_store_dwordx4 v[156:159], v113, s[40:43], s56 offen offset:0
p_31:
    v_cvt_pk_bf16_f32 v160, v4, v5
    v_cvt_pk_bf16_f32 v161, v6, v7
    v_cvt_pk_bf16_f32 v162, v20, v21
    v_cvt_pk_bf16_f32 v163, v22, v23
    s_nop 0
    v_permlane16_swap_b32 v160, v162
    v_permlane16_swap_b32 v161, v163
    s_cmp_eq_u32 s29, 0xff
    s_cbranch_scc0 p_32
    buffer_store_dwordx4 v[160:163], v113, s[40:43], s56 offen offset:1024
p_33:
    v_pk_mul_f32 v[140:141], v[8:9], v[8:9]
    v_pk_mul_f32 v[142:143], v[10:11], v[10:11]
    v_pk_mul_f32 v[144:145], v[24:25], v[24:25]
    v_pk_mul_f32 v[146:147], v[26:27], v[26:27]
    v_pk_mul_f32 v[148:149], v[12:13], v[12:13]
    v_pk_mul_f32 v[150:151], v[14:15], v[14:15]
    v_pk_mul_f32 v[152:153], v[28:29], v[28:29]
    v_pk_mul_f32 v[154:155], v[30:31], v[30:31]
    v_pk_fma_f32 v[140:141], v[140:141], v[130:131], v[128:129]
    v_pk_fma_f32 v[142:143], v[142:143], v[130:131], v[128:129]
    v_pk_fma_f32 v[144:145], v[144:145], v[130:131], v[128:129]
    v_pk_fma_f32 v[146:147], v[146:147], v[130:131], v[128:129]
    v_pk_fma_f32 v[148:149], v[148:149], v[136:137], v[134:135]
    v_pk_fma_f32 v[150:151], v[150:151], v[136:137], v[134:135]
    v_pk_fma_f32 v[152:153], v[152:153], v[136:137], v[134:135]
    v_pk_fma_f32 v[154:155], v[154:155], v[136:137], v[134:135]
    v_pk_mul_f32 v[140:141], v[140:141], v[8:9]
    v_pk_mul_f32 v[142:143], v[142:143], v[10:11]
    v_pk_mul_f32 v[144:145], v[144:145], v[24:25]
    v_pk_mul_f32 v[146:147], v[146:147], v[26:27]
    v_pk_mul_f32 v[148:149], v[148:149], v[12:13]
    v_pk_mul_f32 v[150:151], v[150:151], v[14:15]
    v_pk_mul_f32 v[152:153], v[152:153], v[28:29]
    v_pk_mul_f32 v[154:155], v[154:155], v[30:31]
    v_exp_f32 v140, v140
    v_exp_f32 v141, v141
    v_exp_f32 v142, v142
    v_exp_f32 v143, v143
    v_exp_f32 v144, v144
    v_exp_f32 v145, v145
    v_exp_f32 v146, v146
    v_exp_f32 v147, v147
    v_exp_f32 v148, v148
    v_exp_f32 v149, v149
    v_exp_f32 v150, v150
    v_exp_f32 v151, v151
    v_exp_f32 v152, v152
    v_exp_f32 v153, v153
    v_exp_f32 v154, v154
    v_exp_f32 v155, v155
    v_pk_fma_f32 v[140:141], v[140:141], v[132:133], v[132:133]
    v_pk_fma_f32 v[142:143], v[142:143], v[132:133], v[132:133]
    v_pk_fma_f32 v[144:145], v[144:145], v[132:133], v[132:133]
    v_pk_fma_f32 v[146:147], v[146:147], v[132:133], v[132:133]
    v_pk_fma_f32 v[148:149], v[148:149], v[138:139], v[138:139]
    v_pk_fma_f32 v[150:151], v[150:151], v[138:139], v[138:139]
    v_pk_fma_f32 v[152:153], v[152:153], v[138:139], v[138:139]
    v_pk_fma_f32 v[154:155], v[154:155], v[138:139], v[138:139]
    v_rcp_f32 v140, v140
    v_rcp_f32 v141, v141
    v_rcp_f32 v142, v142
    v_rcp_f32 v143, v143
    v_rcp_f32 v144, v144
    v_rcp_f32 v145, v145
    v_rcp_f32 v146, v146
    v_rcp_f32 v147, v147
    v_rcp_f32 v148, v148
    v_rcp_f32 v149, v149
    v_rcp_f32 v150, v150
    v_rcp_f32 v151, v151
    v_rcp_f32 v152, v152
    v_rcp_f32 v153, v153
    v_rcp_f32 v154, v154
    v_rcp_f32 v155, v155
    v_pk_mul_f32 v[8:9], v[140:141], v[8:9]
    v_pk_mul_f32 v[10:11], v[142:143], v[10:11]
    v_pk_mul_f32 v[24:25], v[144:145], v[24:25]
    v_pk_mul_f32 v[26:27], v[146:147], v[26:27]
    v_pk_mul_f32 v[12:13], v[148:149], v[12:13]
    v_pk_mul_f32 v[14:15], v[150:151], v[14:15]
    v_pk_mul_f32 v[28:29], v[152:153], v[28:29]
    v_pk_mul_f32 v[30:31], v[154:155], v[30:31]
    v_cvt_pk_bf16_f32 v164, v8, v9
    v_cvt_pk_bf16_f32 v165, v10, v11
    v_cvt_pk_bf16_f32 v166, v24, v25
    v_cvt_pk_bf16_f32 v167, v26, v27
    s_nop 0
    v_permlane16_swap_b32 v164, v166
    v_permlane16_swap_b32 v165, v167
    s_cmp_eq_u32 s29, 0xff
    s_cbranch_scc0 p_34
    buffer_store_dwordx4 v[164:167], v113, s[40:43], s56 offen offset:2048
p_35:
    v_cvt_pk_bf16_f32 v168, v12, v13
    v_cvt_pk_bf16_f32 v169, v14, v15
    v_cvt_pk_bf16_f32 v170, v28, v29
    v_cvt_pk_bf16_f32 v171, v30, v31
    s_nop 0
    v_permlane16_swap_b32 v168, v170
    v_permlane16_swap_b32 v169, v171
    s_cmp_eq_u32 s29, 0xff
    s_cbranch_scc0 p_36
    buffer_store_dwordx4 v[168:171], v113, s[40:43], s56 offen offset:3072
p_37:
    s_add_u32 s56, s56, 131072
    v_pk_mul_f32 v[140:141], v[32:33], v[32:33]
    v_pk_mul_f32 v[142:143], v[34:35], v[34:35]
    v_pk_mul_f32 v[144:145], v[48:49], v[48:49]
    v_pk_mul_f32 v[146:147], v[50:51], v[50:51]
    v_pk_mul_f32 v[148:149], v[36:37], v[36:37]
    v_pk_mul_f32 v[150:151], v[38:39], v[38:39]
    v_pk_mul_f32 v[152:153], v[52:53], v[52:53]
    v_pk_mul_f32 v[154:155], v[54:55], v[54:55]
    v_pk_fma_f32 v[140:141], v[140:141], v[118:119], v[116:117]
    v_pk_fma_f32 v[142:143], v[142:143], v[118:119], v[116:117]
    v_pk_fma_f32 v[144:145], v[144:145], v[118:119], v[116:117]
    v_pk_fma_f32 v[146:147], v[146:147], v[118:119], v[116:117]
    v_pk_fma_f32 v[148:149], v[148:149], v[124:125], v[122:123]
    v_pk_fma_f32 v[150:151], v[150:151], v[124:125], v[122:123]
    v_pk_fma_f32 v[152:153], v[152:153], v[124:125], v[122:123]
    v_pk_fma_f32 v[154:155], v[154:155], v[124:125], v[122:123]
    v_pk_mul_f32 v[140:141], v[140:141], v[32:33]
    v_pk_mul_f32 v[142:143], v[142:143], v[34:35]
    v_pk_mul_f32 v[144:145], v[144:145], v[48:49]
    v_pk_mul_f32 v[146:147], v[146:147], v[50:51]
    v_pk_mul_f32 v[148:149], v[148:149], v[36:37]
    v_pk_mul_f32 v[150:151], v[150:151], v[38:39]
    v_pk_mul_f32 v[152:153], v[152:153], v[52:53]
    v_pk_mul_f32 v[154:155], v[154:155], v[54:55]
    v_exp_f32 v140, v140
    v_exp_f32 v141, v141
    v_exp_f32 v142, v142
    v_exp_f32 v143, v143
    v_exp_f32 v144, v144
    v_exp_f32 v145, v145
    v_exp_f32 v146, v146
    v_exp_f32 v147, v147
    v_exp_f32 v148, v148
    v_exp_f32 v149, v149
    v_exp_f32 v150, v150
    v_exp_f32 v151, v151
    v_exp_f32 v152, v152
    v_exp_f32 v153, v153
    v_exp_f32 v154, v154
    v_exp_f32 v155, v155
    v_pk_fma_f32 v[140:141], v[140:141], v[120:121], v[120:121]
    v_pk_fma_f32 v[142:143], v[142:143], v[120:121], v[120:121]
    v_pk_fma_f32 v[144:145], v[144:145], v[120:121], v[120:121]
    v_pk_fma_f32 v[146:147], v[146:147], v[120:121], v[120:121]
    v_pk_fma_f32 v[148:149], v[148:149], v[126:127], v[126:127]
    v_pk_fma_f32 v[150:151], v[150:151], v[126:127], v[126:127]
    v_pk_fma_f32 v[152:153], v[152:153], v[126:127], v[126:127]
    v_pk_fma_f32 v[154:155], v[154:155], v[126:127], v[126:127]
    v_rcp_f32 v140, v140
    v_rcp_f32 v141, v141
    v_rcp_f32 v142, v142
    v_rcp_f32 v143, v143
    v_rcp_f32 v144, v144
    v_rcp_f32 v145, v145
    v_rcp_f32 v146, v146
    v_rcp_f32 v147, v147
    v_rcp_f32 v148, v148
    v_rcp_f32 v149, v149
    v_rcp_f32 v150, v150
    v_rcp_f32 v151, v151
    v_rcp_f32 v152, v152
    v_rcp_f32 v153, v153
    v_rcp_f32 v154, v154
    v_rcp_f32 v155, v155
    v_pk_mul_f32 v[32:33], v[140:141], v[32:33]
    v_pk_mul_f32 v[34:35], v[142:143], v[34:35]
    v_pk_mul_f32 v[48:49], v[144:145], v[48:49]
    v_pk_mul_f32 v[50:51], v[146:147], v[50:51]
    v_pk_mul_f32 v[36:37], v[148:149], v[36:37]
    v_pk_mul_f32 v[38:39], v[150:151], v[38:39]
    v_pk_mul_f32 v[52:53], v[152:153], v[52:53]
    v_pk_mul_f32 v[54:55], v[154:155], v[54:55]
    v_cvt_pk_bf16_f32 v172, v32, v33
    v_cvt_pk_bf16_f32 v173, v34, v35
    v_cvt_pk_bf16_f32 v174, v48, v49
    v_cvt_pk_bf16_f32 v175, v50, v51
    s_nop 0
    v_permlane16_swap_b32 v172, v174
    v_permlane16_swap_b32 v173, v175
    s_cmp_eq_u32 s29, 0xff
    s_cbranch_scc0 p_38
    buffer_store_dwordx4 v[172:175], v113, s[40:43], s56 offen offset:0
p_39:
    v_cvt_pk_bf16_f32 v176, v36, v37
    v_cvt_pk_bf16_f32 v177, v38, v39
    v_cvt_pk_bf16_f32 v178, v52, v53
    v_cvt_pk_bf16_f32 v179, v54, v55
    s_nop 0
    v_permlane16_swap_b32 v176, v178
    v_permlane16_swap_b32 v177, v179
    s_cmp_eq_u32 s29, 0xff
    s_cbranch_scc0 p_40
    buffer_store_dwordx4 v[176:179], v113, s[40:43], s56 offen offset:1024
p_41:
    v_pk_mul_f32 v[140:141], v[40:41], v[40:41]
    v_pk_mul_f32 v[142:143], v[42:43], v[42:43]
    v_pk_mul_f32 v[144:145], v[56:57], v[56:57]
    v_pk_mul_f32 v[146:147], v[58:59], v[58:59]
    v_pk_mul_f32 v[148:149], v[44:45], v[44:45]
    v_pk_mul_f32 v[150:151], v[46:47], v[46:47]
    v_pk_mul_f32 v[152:153], v[60:61], v[60:61]
    v_pk_mul_f32 v[154:155], v[62:63], v[62:63]
    v_pk_fma_f32 v[140:141], v[140:141], v[130:131], v[128:129]
    v_pk_fma_f32 v[142:143], v[142:143], v[130:131], v[128:129]
    v_pk_fma_f32 v[144:145], v[144:145], v[130:131], v[128:129]
    v_pk_fma_f32 v[146:147], v[146:147], v[130:131], v[128:129]
    v_pk_fma_f32 v[148:149], v[148:149], v[136:137], v[134:135]
    v_pk_fma_f32 v[150:151], v[150:151], v[136:137], v[134:135]
    v_pk_fma_f32 v[152:153], v[152:153], v[136:137], v[134:135]
    v_pk_fma_f32 v[154:155], v[154:155], v[136:137], v[134:135]
    v_pk_mul_f32 v[140:141], v[140:141], v[40:41]
    v_pk_mul_f32 v[142:143], v[142:143], v[42:43]
    v_pk_mul_f32 v[144:145], v[144:145], v[56:57]
    v_pk_mul_f32 v[146:147], v[146:147], v[58:59]
    v_pk_mul_f32 v[148:149], v[148:149], v[44:45]
    v_pk_mul_f32 v[150:151], v[150:151], v[46:47]
    v_pk_mul_f32 v[152:153], v[152:153], v[60:61]
    v_pk_mul_f32 v[154:155], v[154:155], v[62:63]
    v_exp_f32 v140, v140
    v_exp_f32 v141, v141
    v_exp_f32 v142, v142
    v_exp_f32 v143, v143
    v_exp_f32 v144, v144
    v_exp_f32 v145, v145
    v_exp_f32 v146, v146
    v_exp_f32 v147, v147
    v_exp_f32 v148, v148
    v_exp_f32 v149, v149
    v_exp_f32 v150, v150
    v_exp_f32 v151, v151
    v_exp_f32 v152, v152
    v_exp_f32 v153, v153
    v_exp_f32 v154, v154
    v_exp_f32 v155, v155
    v_pk_fma_f32 v[140:141], v[140:141], v[132:133], v[132:133]
    v_pk_fma_f32 v[142:143], v[142:143], v[132:133], v[132:133]
    v_pk_fma_f32 v[144:145], v[144:145], v[132:133], v[132:133]
    v_pk_fma_f32 v[146:147], v[146:147], v[132:133], v[132:133]
    v_pk_fma_f32 v[148:149], v[148:149], v[138:139], v[138:139]
    v_pk_fma_f32 v[150:151], v[150:151], v[138:139], v[138:139]
    v_pk_fma_f32 v[152:153], v[152:153], v[138:139], v[138:139]
    v_pk_fma_f32 v[154:155], v[154:155], v[138:139], v[138:139]
    v_rcp_f32 v140, v140
    v_rcp_f32 v141, v141
    v_rcp_f32 v142, v142
    v_rcp_f32 v143, v143
    v_rcp_f32 v144, v144
    v_rcp_f32 v145, v145
    v_rcp_f32 v146, v146
    v_rcp_f32 v147, v147
    v_rcp_f32 v148, v148
    v_rcp_f32 v149, v149
    v_rcp_f32 v150, v150
    v_rcp_f32 v151, v151
    v_rcp_f32 v152, v152
    v_rcp_f32 v153, v153
    v_rcp_f32 v154, v154
    v_rcp_f32 v155, v155
    v_pk_mul_f32 v[40:41], v[140:141], v[40:41]
    v_pk_mul_f32 v[42:43], v[142:143], v[42:43]
    v_pk_mul_f32 v[56:57], v[144:145], v[56:57]
    v_pk_mul_f32 v[58:59], v[146:147], v[58:59]
    v_pk_mul_f32 v[44:45], v[148:149], v[44:45]
    v_pk_mul_f32 v[46:47], v[150:151], v[46:47]
    v_pk_mul_f32 v[60:61], v[152:153], v[60:61]
    v_pk_mul_f32 v[62:63], v[154:155], v[62:63]
    v_cvt_pk_bf16_f32 v180, v40, v41
    v_cvt_pk_bf16_f32 v181, v42, v43
    v_cvt_pk_bf16_f32 v182, v56, v57
    v_cvt_pk_bf16_f32 v183, v58, v59
    s_nop 0
    v_permlane16_swap_b32 v180, v182
    v_permlane16_swap_b32 v181, v183
    s_cmp_eq_u32 s29, 0xff
    s_cbranch_scc0 p_42
    buffer_store_dwordx4 v[180:183], v113, s[40:43], s56 offen offset:2048
p_43:
    v_cvt_pk_bf16_f32 v184, v44, v45
    v_cvt_pk_bf16_f32 v185, v46, v47
    v_cvt_pk_bf16_f32 v186, v60, v61
    v_cvt_pk_bf16_f32 v187, v62, v63
    s_nop 0
    v_permlane16_swap_b32 v184, v186
    v_permlane16_swap_b32 v185, v187
    s_cmp_eq_u32 s29, 0xff
    s_cbranch_scc0 p_44
    buffer_store_dwordx4 v[184:187], v113, s[40:43], s56 offen offset:3072
p_45:
    s_add_u32 s56, s56, 131072
    v_pk_mul_f32 v[140:141], v[64:65], v[64:65]
    v_pk_mul_f32 v[142:143], v[66:67], v[66:67]
    v_pk_mul_f32 v[144:145], v[80:81], v[80:81]
    v_pk_mul_f32 v[146:147], v[82:83], v[82:83]
    v_pk_mul_f32 v[148:149], v[68:69], v[68:69]
    v_pk_mul_f32 v[150:151], v[70:71], v[70:71]
    v_pk_mul_f32 v[152:153], v[84:85], v[84:85]
    v_pk_mul_f32 v[154:155], v[86:87], v[86:87]
    v_pk_fma_f32 v[140:141], v[140:141], v[118:119], v[116:117]
    v_pk_fma_f32 v[142:143], v[142:143], v[118:119], v[116:117]
    v_pk_fma_f32 v[144:145], v[144:145], v[118:119], v[116:117]
    v_pk_fma_f32 v[146:147], v[146:147], v[118:119], v[116:117]
    v_pk_fma_f32 v[148:149], v[148:149], v[124:125], v[122:123]
    v_pk_fma_f32 v[150:151], v[150:151], v[124:125], v[122:123]
    v_pk_fma_f32 v[152:153], v[152:153], v[124:125], v[122:123]
    v_pk_fma_f32 v[154:155], v[154:155], v[124:125], v[122:123]
    v_pk_mul_f32 v[140:141], v[140:141], v[64:65]
    v_pk_mul_f32 v[142:143], v[142:143], v[66:67]
    v_pk_mul_f32 v[144:145], v[144:145], v[80:81]
    v_pk_mul_f32 v[146:147], v[146:147], v[82:83]
    v_pk_mul_f32 v[148:149], v[148:149], v[68:69]
    v_pk_mul_f32 v[150:151], v[150:151], v[70:71]
    v_pk_mul_f32 v[152:153], v[152:153], v[84:85]
    v_pk_mul_f32 v[154:155], v[154:155], v[86:87]
    v_exp_f32 v140, v140
    v_exp_f32 v141, v141
    v_exp_f32 v142, v142
    v_exp_f32 v143, v143
    v_exp_f32 v144, v144
    v_exp_f32 v145, v145
    v_exp_f32 v146, v146
    v_exp_f32 v147, v147
    v_exp_f32 v148, v148
    v_exp_f32 v149, v149
    v_exp_f32 v150, v150
    v_exp_f32 v151, v151
    v_exp_f32 v152, v152
    v_exp_f32 v153, v153
    v_exp_f32 v154, v154
    v_exp_f32 v155, v155
    v_pk_fma_f32 v[140:141], v[140:141], v[120:121], v[120:121]
    v_pk_fma_f32 v[142:143], v[142:143], v[120:121], v[120:121]
    v_pk_fma_f32 v[144:145], v[144:145], v[120:121], v[120:121]
    v_pk_fma_f32 v[146:147], v[146:147], v[120:121], v[120:121]
    v_pk_fma_f32 v[148:149], v[148:149], v[126:127], v[126:127]
    v_pk_fma_f32 v[150:151], v[150:151], v[126:127], v[126:127]
    v_pk_fma_f32 v[152:153], v[152:153], v[126:127], v[126:127]
    v_pk_fma_f32 v[154:155], v[154:155], v[126:127], v[126:127]
    v_rcp_f32 v140, v140
    v_rcp_f32 v141, v141
    v_rcp_f32 v142, v142
    v_rcp_f32 v143, v143
    v_rcp_f32 v144, v144
    v_rcp_f32 v145, v145
    v_rcp_f32 v146, v146
    v_rcp_f32 v147, v147
    v_rcp_f32 v148, v148
    v_rcp_f32 v149, v149
    v_rcp_f32 v150, v150
    v_rcp_f32 v151, v151
    v_rcp_f32 v152, v152
    v_rcp_f32 v153, v153
    v_rcp_f32 v154, v154
    v_rcp_f32 v155, v155
    v_pk_mul_f32 v[64:65], v[140:141], v[64:65]
    v_pk_mul_f32 v[66:67], v[142:143], v[66:67]
    v_pk_mul_f32 v[80:81], v[144:145], v[80:81]
    v_pk_mul_f32 v[82:83], v[146:147], v[82:83]
    v_pk_mul_f32 v[68:69], v[148:149], v[68:69]
    v_pk_mul_f32 v[70:71], v[150:151], v[70:71]
    v_pk_mul_f32 v[84:85], v[152:153], v[84:85]
    v_pk_mul_f32 v[86:87], v[154:155], v[86:87]
    v_cvt_pk_bf16_f32 v156, v64, v65
    v_cvt_pk_bf16_f32 v157, v66, v67
    v_cvt_pk_bf16_f32 v158, v80, v81
    v_cvt_pk_bf16_f32 v159, v82, v83
    s_nop 0
    v_permlane16_swap_b32 v156, v158
    v_permlane16_swap_b32 v157, v159
    s_cmp_eq_u32 s29, 0xff
    s_cbranch_scc0 p_46
    buffer_store_dwordx4 v[156:159], v113, s[40:43], s56 offen offset:0
p_47:
    v_cvt_pk_bf16_f32 v160, v68, v69
    v_cvt_pk_bf16_f32 v161, v70, v71
    v_cvt_pk_bf16_f32 v162, v84, v85
    v_cvt_pk_bf16_f32 v163, v86, v87
    s_nop 0
    v_permlane16_swap_b32 v160, v162
    v_permlane16_swap_b32 v161, v163
    s_cmp_eq_u32 s29, 0xff
    s_cbranch_scc0 p_48
    buffer_store_dwordx4 v[160:163], v113, s[40:43], s56 offen offset:1024
p_49:
    v_pk_mul_f32 v[140:141], v[72:73], v[72:73]
    v_pk_mul_f32 v[142:143], v[74:75], v[74:75]
    v_pk_mul_f32 v[144:145], v[88:89], v[88:89]
    v_pk_mul_f32 v[146:147], v[90:91], v[90:91]
    v_pk_mul_f32 v[148:149], v[76:77], v[76:77]
    v_pk_mul_f32 v[150:151], v[78:79], v[78:79]
    v_pk_mul_f32 v[152:153], v[92:93], v[92:93]
    v_pk_mul_f32 v[154:155], v[94:95], v[94:95]
    v_pk_fma_f32 v[140:141], v[140:141], v[130:131], v[128:129]
    v_pk_fma_f32 v[142:143], v[142:143], v[130:131], v[128:129]
    v_pk_fma_f32 v[144:145], v[144:145], v[130:131], v[128:129]
    v_pk_fma_f32 v[146:147], v[146:147], v[130:131], v[128:129]
    v_pk_fma_f32 v[148:149], v[148:149], v[136:137], v[134:135]
    v_pk_fma_f32 v[150:151], v[150:151], v[136:137], v[134:135]
    v_pk_fma_f32 v[152:153], v[152:153], v[136:137], v[134:135]
    v_pk_fma_f32 v[154:155], v[154:155], v[136:137], v[134:135]
    v_pk_mul_f32 v[140:141], v[140:141], v[72:73]
    v_pk_mul_f32 v[142:143], v[142:143], v[74:75]
    v_pk_mul_f32 v[144:145], v[144:145], v[88:89]
    v_pk_mul_f32 v[146:147], v[146:147], v[90:91]
    v_pk_mul_f32 v[148:149], v[148:149], v[76:77]
    v_pk_mul_f32 v[150:151], v[150:151], v[78:79]
    v_pk_mul_f32 v[152:153], v[152:153], v[92:93]
    v_pk_mul_f32 v[154:155], v[154:155], v[94:95]
    v_exp_f32 v140, v140
    v_exp_f32 v141, v141
    v_exp_f32 v142, v142
    v_exp_f32 v143, v143
    v_exp_f32 v144, v144
    v_exp_f32 v145, v145
    v_exp_f32 v146, v146
    v_exp_f32 v147, v147
    v_exp_f32 v148, v148
    v_exp_f32 v149, v149
    v_exp_f32 v150, v150
    v_exp_f32 v151, v151
    v_exp_f32 v152, v152
    v_exp_f32 v153, v153
    v_exp_f32 v154, v154
    v_exp_f32 v155, v155
    v_pk_fma_f32 v[140:141], v[140:141], v[132:133], v[132:133]
    v_pk_fma_f32 v[142:143], v[142:143], v[132:133], v[132:133]
    v_pk_fma_f32 v[144:145], v[144:145], v[132:133], v[132:133]
    v_pk_fma_f32 v[146:147], v[146:147], v[132:133], v[132:133]
    v_pk_fma_f32 v[148:149], v[148:149], v[138:139], v[138:139]
    v_pk_fma_f32 v[150:151], v[150:151], v[138:139], v[138:139]
    v_pk_fma_f32 v[152:153], v[152:153], v[138:139], v[138:139]
    v_pk_fma_f32 v[154:155], v[154:155], v[138:139], v[138:139]
    v_rcp_f32 v140, v140
    v_rcp_f32 v141, v141
    v_rcp_f32 v142, v142
    v_rcp_f32 v143, v143
    v_rcp_f32 v144, v144
    v_rcp_f32 v145, v145
    v_rcp_f32 v146, v146
    v_rcp_f32 v147, v147
    v_rcp_f32 v148, v148
    v_rcp_f32 v149, v149
    v_rcp_f32 v150, v150
    v_rcp_f32 v151, v151
    v_rcp_f32 v152, v152
    v_rcp_f32 v153, v153
    v_rcp_f32 v154, v154
    v_rcp_f32 v155, v155
    v_pk_mul_f32 v[72:73], v[140:141], v[72:73]
    v_pk_mul_f32 v[74:75], v[142:143], v[74:75]
    v_pk_mul_f32 v[88:89], v[144:145], v[88:89]
    v_pk_mul_f32 v[90:91], v[146:147], v[90:91]
    v_pk_mul_f32 v[76:77], v[148:149], v[76:77]
    v_pk_mul_f32 v[78:79], v[150:151], v[78:79]
    v_pk_mul_f32 v[92:93], v[152:153], v[92:93]
    v_pk_mul_f32 v[94:95], v[154:155], v[94:95]
    v_cvt_pk_bf16_f32 v164, v72, v73
    v_cvt_pk_bf16_f32 v165, v74, v75
    v_cvt_pk_bf16_f32 v166, v88, v89
    v_cvt_pk_bf16_f32 v167, v90, v91
    s_nop 0
    v_permlane16_swap_b32 v164, v166
    v_permlane16_swap_b32 v165, v167
    s_cmp_eq_u32 s29, 0xff
    s_cbranch_scc0 p_50
    buffer_store_dwordx4 v[164:167], v113, s[40:43], s56 offen offset:2048
p_51:
    v_cvt_pk_bf16_f32 v168, v76, v77
    v_cvt_pk_bf16_f32 v169, v78, v79
    v_cvt_pk_bf16_f32 v170, v92, v93
    v_cvt_pk_bf16_f32 v171, v94, v95
    s_nop 0
    v_permlane16_swap_b32 v168, v170
    v_permlane16_swap_b32 v169, v171
    s_cmp_eq_u32 s29, 0xff
    s_cbranch_scc0 p_52
    buffer_store_dwordx4 v[168:171], v113, s[40:43], s56 offen offset:3072
p_53:
    v_pk_mul_f32 v[140:141], v[96:97], v[96:97]
    v_pk_mul_f32 v[142:143], v[98:99], v[98:99]
    v_pk_mul_f32 v[144:145], v[100:101], v[100:101]
    v_pk_mul_f32 v[146:147], v[102:103], v[102:103]
    v_pk_mul_f32 v[148:149], v[104:105], v[104:105]
    v_pk_mul_f32 v[150:151], v[106:107], v[106:107]
    v_pk_mul_f32 v[152:153], v[108:109], v[108:109]
    v_pk_mul_f32 v[154:155], v[110:111], v[110:111]
    v_pk_fma_f32 v[140:141], v[140:141], v[118:119], v[116:117]
    v_pk_fma_f32 v[142:143], v[142:143], v[118:119], v[116:117]
    v_pk_fma_f32 v[144:145], v[144:145], v[124:125], v[122:123]
    v_pk_fma_f32 v[146:147], v[146:147], v[124:125], v[122:123]
    v_pk_fma_f32 v[148:149], v[148:149], v[130:131], v[128:129]
    v_pk_fma_f32 v[150:151], v[150:151], v[130:131], v[128:129]
    v_pk_fma_f32 v[152:153], v[152:153], v[136:137], v[134:135]
    v_pk_fma_f32 v[154:155], v[154:155], v[136:137], v[134:135]
    v_pk_mul_f32 v[140:141], v[140:141], v[96:97]
    v_pk_mul_f32 v[142:143], v[142:143], v[98:99]
    v_pk_mul_f32 v[144:145], v[144:145], v[100:101]
    v_pk_mul_f32 v[146:147], v[146:147], v[102:103]
    v_pk_mul_f32 v[148:149], v[148:149], v[104:105]
    v_pk_mul_f32 v[150:151], v[150:151], v[106:107]
    v_pk_mul_f32 v[152:153], v[152:153], v[108:109]
    v_pk_mul_f32 v[154:155], v[154:155], v[110:111]
    v_exp_f32 v140, v140
    v_exp_f32 v141, v141
    v_exp_f32 v142, v142
    v_exp_f32 v143, v143
    v_exp_f32 v144, v144
    v_exp_f32 v145, v145
    v_exp_f32 v146, v146
    v_exp_f32 v147, v147
    v_exp_f32 v148, v148
    v_exp_f32 v149, v149
    v_exp_f32 v150, v150
    v_exp_f32 v151, v151
    v_exp_f32 v152, v152
    v_exp_f32 v153, v153
    v_exp_f32 v154, v154
    v_exp_f32 v155, v155
    v_pk_fma_f32 v[140:141], v[140:141], v[120:121], v[120:121]
    v_pk_fma_f32 v[142:143], v[142:143], v[120:121], v[120:121]
    v_pk_fma_f32 v[144:145], v[144:145], v[126:127], v[126:127]
    v_pk_fma_f32 v[146:147], v[146:147], v[126:127], v[126:127]
    v_pk_fma_f32 v[148:149], v[148:149], v[132:133], v[132:133]
    v_pk_fma_f32 v[150:151], v[150:151], v[132:133], v[132:133]
    v_pk_fma_f32 v[152:153], v[152:153], v[138:139], v[138:139]
    v_pk_fma_f32 v[154:155], v[154:155], v[138:139], v[138:139]
    v_rcp_f32 v140, v140
    v_rcp_f32 v141, v141
    v_rcp_f32 v142, v142
    v_rcp_f32 v143, v143
    v_rcp_f32 v144, v144
    v_rcp_f32 v145, v145
    v_rcp_f32 v146, v146
    v_rcp_f32 v147, v147
    v_rcp_f32 v148, v148
    v_rcp_f32 v149, v149
    v_rcp_f32 v150, v150
    v_rcp_f32 v151, v151
    v_rcp_f32 v152, v152
    v_rcp_f32 v153, v153
    v_rcp_f32 v154, v154
    v_rcp_f32 v155, v155
    v_pk_mul_f32 v[96:97], v[140:141], v[96:97]
    v_pk_mul_f32 v[98:99], v[142:143], v[98:99]
    v_pk_mul_f32 v[100:101], v[144:145], v[100:101]
    v_pk_mul_f32 v[102:103], v[146:147], v[102:103]
    v_pk_mul_f32 v[104:105], v[148:149], v[104:105]
    v_pk_mul_f32 v[106:107], v[150:151], v[106:107]
    v_pk_mul_f32 v[108:109], v[152:153], v[108:109]
    v_pk_mul_f32 v[110:111], v[154:155], v[110:111]
    v_cvt_pk_bf16_f32 v172, v96, v97
    v_cvt_pk_bf16_f32 v173, v98, v99
    v_cvt_pk_bf16_f32 v174, v100, v101
    v_cvt_pk_bf16_f32 v175, v102, v103
    s_nop 0
    v_permlane16_swap_b32 v172, v174
    v_permlane16_swap_b32 v173, v175
    s_cmp_eq_u32 s29, 0xff
    s_cbranch_scc0 p_54
    buffer_store_dwordx4 v[172:175], v114, s[40:43], s57 offen offset:0
p_55:
    v_cvt_pk_bf16_f32 v176, v104, v105
    v_cvt_pk_bf16_f32 v177, v106, v107
    v_cvt_pk_bf16_f32 v178, v108, v109
    v_cvt_pk_bf16_f32 v179, v110, v111
    s_nop 0
    v_permlane16_swap_b32 v176, v178
    v_permlane16_swap_b32 v177, v179
    s_cmp_eq_u32 s29, 0xff
    s_cbranch_scc0 p_56
    buffer_store_dwordx4 v[176:179], v114, s[40:43], s57 offen offset:2048
p_57:
    s_mov_b64 s[32:33], s[66:67]
    s_mov_b32 s12, s62
    s_mov_b32 s13, s63
    s_mov_b32 s14, 7340032
    s_mov_b32 s15, 0x00020000
    s_bfe_u32 s54, s2, 0x20001
    s_and_b32 s18, s2, 1
    s_lshl_b32 s18, s18, 2
    s_bfe_u32 s3, s2, 0x20003
    s_add_u32 s18, s18, s3
    s_lshr_b32 s19, s2, 5
    s_lshl_b32 s55, s54, 4
    s_lshl_b32 s35, s18, 14
    s_mul_i32 s16, s54, 3670016
    s_add_u32 s16, s16, 4194304
    s_add_u32 s16, s16, s35
    s_lshl_b32 s23, s54, 20
    s_add_u32 s35, s35, s23
    s_lshl_b32 s63, s19, 8
    s_mul_i32 s17, s54, 1835008
    s_add_u32 s17, s17, s63
    s_lshl_b32 s30, s54, 19
    s_add_u32 s30, s30, s63
    s_mov_b32 s8, s6
    s_mov_b32 s9, s7
    s_mov_b32 s10, 18878464
    s_mov_b32 s11, 0x00020000
    s_lshl_b32 s20, s71, 7
    s_add_u32 s21, s20, 9437216
    s_lshl_b32 s23, s24, 2
    s_add_u32 s20, s20, s23
    s_add_u32 s20, s20, 9437184
    s_lshl_b32 s22, s18, 2
    s_add_u32 s22, s22, s54
    s_lshl_b32 s22, s22, 10
    s_add_u32 s22, s22, 9437184
    s_mov_b32 s27, s24
    s_mov_b32 s57, 0xf149f2ca
    v_and_b32 v244, 31, v254
    v_lshrrev_b32 v245, 5, v254
    v_bfe_u32 v246, v254, 2, 2
    v_xor_b32 v246, v246, v245
    v_lshlrev_b32 v246, 4, v246
    v_lshl_add_u32 v240, v244, 6, v246
    s_lshl_b32 s23, s24, 11
    v_add_u32 v240, s23, v240
    v_xor_b32 v241, 32, v240
    v_bfe_u32 v246, v254, 2, 2
    v_lshl_add_u32 v246, v245, 2, v246
    v_lshlrev_b32 v246, 6, v246
    v_bfe_u32 v247, v254, 4, 1
    v_lshl_add_u32 v246, v247, 5, v246
    v_and_b32 v247, 3, v254
    v_lshl_add_u32 v246, v247, 3, v246
    s_add_u32 s23, s23, 49152
    v_add_u32 v242, s23, v246
    s_lshl_b32 s58, s52, 3
    s_add_u32 s58, s58, s24
    s_lshl_b32 s58, s58, 11
    s_lshl_b32 s59, s53, 17
    s_add_u32 s58, s58, s59
    v_lshlrev_b32 v250, 6, v244
    v_lshl_add_u32 v250, v245, 4, v250
    v_lshlrev_b32 v245, 2, v245
    v_sub_u32 v244, v244, v245
    v_add_u32 v244, 1, v244
    v_max_i32 v244, 0, v244
    v_lshrrev_b32 v245, 3, v244
    v_and_b32 v244, 7, v244
    v_min_u32 v244, 4, v244
    v_lshl_add_u32 v244, v245, 2, v244
    v_bfm_b32 v243, v244, 0
    s_cmp_eq_u32 s52, 0
    s_cselect_b32 s3, -1, 0
    s_cselect_b32 s56, 7, 64
    s_sub_u32 s56, s56, s24
    v_or_b32 v244, s3, v243
    v_bfe_i32 v176, v243, 0, 1
    v_bfe_i32 v192, v244, 0, 1
    v_bfi_b32 v176, v176, 0, s57
    v_and_b32 v192, s57, v192
    v_bfe_i32 v177, v243, 1, 1
    v_bfe_i32 v193, v244, 1, 1
    v_bfi_b32 v177, v177, 0, s57
    v_and_b32 v193, s57, v193
    v_bfe_i32 v178, v243, 2, 1
    v_bfe_i32 v194, v244, 2, 1
    v_bfi_b32 v178, v178, 0, s57
    v_and_b32 v194, s57, v194
    v_bfe_i32 v179, v243, 3, 1
    v_bfe_i32 v195, v244, 3, 1
    v_bfi_b32 v179, v179, 0, s57
    v_and_b32 v195, s57, v195
    v_bfe_i32 v180, v243, 4, 1
    v_bfe_i32 v196, v244, 4, 1
    v_bfi_b32 v180, v180, 0, s57
    v_and_b32 v196, s57, v196
    v_bfe_i32 v181, v243, 5, 1
    v_bfe_i32 v197, v244, 5, 1
    v_bfi_b32 v181, v181, 0, s57
    v_and_b32 v197, s57, v197
    v_bfe_i32 v182, v243, 6, 1
    v_bfe_i32 v198, v244, 6, 1
    v_bfi_b32 v182, v182, 0, s57
    v_and_b32 v198, s57, v198
    v_bfe_i32 v183, v243, 7, 1
    v_bfe_i32 v199, v244, 7, 1
    v_bfi_b32 v183, v183, 0, s57
    v_and_b32 v199, s57, v199
    v_bfe_i32 v184, v243, 8, 1
    v_bfe_i32 v200, v244, 8, 1
    v_bfi_b32 v184, v184, 0, s57
    v_and_b32 v200, s57, v200
    v_bfe_i32 v185, v243, 9, 1
    v_bfe_i32 v201, v244, 9, 1
    v_bfi_b32 v185, v185, 0, s57
    v_and_b32 v201, s57, v201
    v_bfe_i32 v186, v243, 10, 1
    v_bfe_i32 v202, v244, 10, 1
    v_bfi_b32 v186, v186, 0, s57
    v_and_b32 v202, s57, v202
    v_bfe_i32 v187, v243, 11, 1
    v_bfe_i32 v203, v244, 11, 1
    v_bfi_b32 v187, v187, 0, s57
    v_and_b32 v203, s57, v203
    v_bfe_i32 v188, v243, 12, 1
    v_bfe_i32 v204, v244, 12, 1
    v_bfi_b32 v188, v188, 0, s57
    v_and_b32 v204, s57, v204
    v_bfe_i32 v189, v243, 13, 1
    v_bfe_i32 v205, v244, 13, 1
    v_bfi_b32 v189, v189, 0, s57
    v_and_b32 v205, s57, v205
    v_bfe_i32 v190, v243, 14, 1
    v_bfe_i32 v206, v244, 14, 1
    v_bfi_b32 v190, v190, 0, s57
    v_and_b32 v206, s57, v206
    v_bfe_i32 v191, v243, 15, 1
    v_bfe_i32 v207, v244, 15, 1
    v_bfi_b32 v191, v191, 0, s57
    v_and_b32 v207, s57, v207
    v_mov_b32 v208, 0x3f803f80
    v_mov_b32 v209, 0x3f803f80
    v_mov_b32 v210, 0x3f803f80
    v_mov_b32 v211, 0x3f803f80
    v_mov_b32 v0, 0
    v_mov_b32 v1, 1
    s_waitcnt vmcnt(0)
    s_mov_b64 exec, 1
    buffer_store_dword v1, v0, s[44:47], s20 offen sc1
    s_mov_b64 exec, -1
f1_attn:
    v_mov_b32 v0, 49152
    s_mov_b32 s70, 16777216
qs_58:
    ds_read_b32 v1, v0
    s_sub_u32 s70, s70, 1
    s_cbranch_scc1 qd_59
    s_waitcnt lgkmcnt(0)
    v_readfirstlane_b32 s3, v1
    s_nop 0
    s_cmp_eq_u32 s3, 4
    s_cbranch_scc1 qd_59
    s_sleep 1
    s_branch qs_58
qd_59:
    s_waitcnt lgkmcnt(0)
    s_setprio 1
    ds_read_b128 v[168:171], v240 offset:0
    ds_read_b128 v[172:175], v241 offset:0
    ds_read_b128 v[64:67], v240 offset:32768
    ds_read_b128 v[68:71], v241 offset:32768
    ds_read_b128 v[56:59], v240 offset:30720
    ds_read_b128 v[60:63], v241 offset:30720
    ds_read_b128 v[48:51], v240 offset:28672
    ds_read_b128 v[52:55], v241 offset:28672
    ds_read_b128 v[40:43], v240 offset:26624
    ds_read_b128 v[44:47], v241 offset:26624
    ds_read_b128 v[32:35], v240 offset:24576
    ds_read_b128 v[36:39], v241 offset:24576
    ds_read_b128 v[24:27], v240 offset:22528
    ds_read_b128 v[28:31], v241 offset:22528
    ds_read_b128 v[16:19], v240 offset:20480
    s_waitcnt lgkmcnt(14)
    ds_read_b128 v[20:23], v241 offset:20480
    s_waitcnt lgkmcnt(14)
    ds_read_b128 v[8:11], v240 offset:18432
    s_waitcnt lgkmcnt(14)
    ds_read_b128 v[12:15], v241 offset:18432
    s_waitcnt lgkmcnt(14)
    ds_read_b128 v[0:3], v240 offset:16384
    s_waitcnt lgkmcnt(14)
    ds_read_b128 v[4:7], v241 offset:16384
    v_pk_mov_b32 v[152:153], 0, 0
    v_pk_mov_b32 v[154:155], 0, 0
    v_pk_mov_b32 v[156:157], 0, 0
    v_pk_mov_b32 v[158:159], 0, 0
    v_pk_mov_b32 v[160:161], 0, 0
    v_pk_mov_b32 v[162:163], 0, 0
    v_pk_mov_b32 v[164:165], 0, 0
    v_pk_mov_b32 v[166:167], 0, 0
    v_mfma_f32_32x32x16_bf16 v[72:87], v[64:67], v[168:171], v[176:191]
    v_mfma_f32_32x32x16_bf16 v[72:87], v[68:71], v[172:175], v[72:87]
    s_cmp_eq_u32 s56, 7
    s_cbranch_scc1 iv_60
ib_61:
    v_mfma_f32_32x32x16_bf16 v[88:103], v[56:59], v[168:171], v[152:167]
    s_waitcnt lgkmcnt(14)
    v_mfma_f32_32x32x16_bf16 v[88:103], v[60:63], v[172:175], v[88:103]
    s_cmp_eq_u32 s56, 6
    s_cbranch_scc1 iv_62
ib_63:
    s_waitcnt lgkmcnt(13)
    v_mfma_f32_32x32x16_bf16 v[104:119], v[48:51], v[168:171], v[152:167]
    s_waitcnt lgkmcnt(12)
    v_mfma_f32_32x32x16_bf16 v[104:119], v[52:55], v[172:175], v[104:119]
    s_nop 0
    v_max_f32 v244, v72, v73
    v_max_f32 v245, v74, v75
    v_max3_f32 v244, v244, v76, v77
    v_max3_f32 v245, v245, v78, v79
    v_max3_f32 v244, v244, v80, v81
    v_max3_f32 v245, v245, v82, v83
    v_max3_f32 v244, v244, v84, v85
    v_max3_f32 v245, v245, v86, v87
    s_cmp_eq_u32 s56, 5
    s_cbranch_scc1 iv_64
ib_65:
    s_waitcnt lgkmcnt(11)
    v_mfma_f32_32x32x16_bf16 v[72:87], v[40:43], v[168:171], v[152:167]
    s_waitcnt lgkmcnt(10)
    v_mfma_f32_32x32x16_bf16 v[72:87], v[44:47], v[172:175], v[72:87]
    v_max3_f32 v244, v244, v88, v89
    v_max3_f32 v245, v245, v90, v91
    v_max3_f32 v244, v244, v92, v93
    v_max3_f32 v245, v245, v94, v95
    v_max3_f32 v244, v244, v96, v97
    v_max3_f32 v245, v245, v98, v99
    v_max3_f32 v244, v244, v100, v101
    v_max3_f32 v245, v245, v102, v103
    s_cmp_eq_u32 s56, 4
    s_cbranch_scc1 iv_66
ib_67:
    s_waitcnt lgkmcnt(9)
    v_mfma_f32_32x32x16_bf16 v[88:103], v[32:35], v[168:171], v[152:167]
    s_waitcnt lgkmcnt(8)
    v_mfma_f32_32x32x16_bf16 v[88:103], v[36:39], v[172:175], v[88:103]
    v_max3_f32 v244, v244, v104, v105
    v_max3_f32 v245, v245, v106, v107
    v_max3_f32 v244, v244, v108, v109
    v_max3_f32 v245, v245, v110, v111
    v_max3_f32 v244, v244, v112, v113
    v_max3_f32 v245, v245, v114, v115
    v_max3_f32 v244, v244, v116, v117
    v_max3_f32 v245, v245, v118, v119
    s_cmp_eq_u32 s56, 3
    s_cbranch_scc1 iv_68
ib_69:
    s_waitcnt lgkmcnt(7)
    v_mfma_f32_32x32x16_bf16 v[104:119], v[24:27], v[168:171], v[152:167]
    s_waitcnt lgkmcnt(6)
    v_mfma_f32_32x32x16_bf16 v[104:119], v[28:31], v[172:175], v[104:119]
    v_max3_f32 v244, v244, v72, v73
    v_max3_f32 v245, v245, v74, v75
    v_max3_f32 v244, v244, v76, v77
    v_max3_f32 v245, v245, v78, v79
    v_max3_f32 v244, v244, v80, v81
    v_max3_f32 v245, v245, v82, v83
    v_max3_f32 v244, v244, v84, v85
    v_max3_f32 v245, v245, v86, v87
    s_cmp_eq_u32 s56, 2
    s_cbranch_scc1 iv_70
ib_71:
    s_waitcnt lgkmcnt(5)
    v_mfma_f32_32x32x16_bf16 v[72:87], v[16:19], v[168:171], v[152:167]
    s_waitcnt lgkmcnt(4)
    v_mfma_f32_32x32x16_bf16 v[72:87], v[20:23], v[172:175], v[72:87]
    v_max3_f32 v244, v244, v88, v89
    v_max3_f32 v245, v245, v90, v91
    v_max3_f32 v244, v244, v92, v93
    v_max3_f32 v245, v245, v94, v95
    v_max3_f32 v244, v244, v96, v97
    v_max3_f32 v245, v245, v98, v99
    v_max3_f32 v244, v244, v100, v101
    v_max3_f32 v245, v245, v102, v103
    s_cmp_eq_u32 s56, 1
    s_cbranch_scc1 iv_72
ib_73:
    s_waitcnt lgkmcnt(3)
    v_mfma_f32_32x32x16_bf16 v[88:103], v[8:11], v[168:171], v[152:167]
    s_waitcnt lgkmcnt(2)
    v_mfma_f32_32x32x16_bf16 v[88:103], v[12:15], v[172:175], v[88:103]
    v_max3_f32 v244, v244, v104, v105
    v_max3_f32 v245, v245, v106, v107
    v_max3_f32 v244, v244, v108, v109
    v_max3_f32 v245, v245, v110, v111
    v_max3_f32 v244, v244, v112, v113
    v_max3_f32 v245, v245, v114, v115
    v_max3_f32 v244, v244, v116, v117
    v_max3_f32 v245, v245, v118, v119
    s_waitcnt lgkmcnt(1)
    v_mfma_f32_32x32x16_bf16 v[104:119], v[0:3], v[168:171], v[192:207]
    s_waitcnt lgkmcnt(0)
    v_mfma_f32_32x32x16_bf16 v[104:119], v[4:7], v[172:175], v[104:119]
    v_max3_f32 v244, v244, v72, v73
    v_max3_f32 v245, v245, v74, v75
    v_max3_f32 v244, v244, v76, v77
    v_max3_f32 v245, v245, v78, v79
    v_max3_f32 v244, v244, v80, v81
    v_max3_f32 v245, v245, v82, v83
    v_max3_f32 v244, v244, v84, v85
    v_max3_f32 v245, v245, v86, v87
    ds_read_b64_tr_b16 v[212:213], v242 offset:16384
    ds_read_b64_tr_b16 v[214:215], v242 offset:16896
    ds_read_b64_tr_b16 v[216:217], v242 offset:17408
    ds_read_b64_tr_b16 v[218:219], v242 offset:17920
    v_max3_f32 v244, v244, v88, v89
    v_max3_f32 v245, v245, v90, v91
    v_max3_f32 v244, v244, v92, v93
    v_max3_f32 v245, v245, v94, v95
    v_max3_f32 v244, v244, v96, v97
    v_max3_f32 v245, v245, v98, v99
    v_max3_f32 v244, v244, v100, v101
    v_max3_f32 v245, v245, v102, v103
    v_max3_f32 v244, v244, v104, v105
    v_max3_f32 v245, v245, v106, v107
    v_max3_f32 v244, v244, v108, v109
    v_max3_f32 v245, v245, v110, v111
    v_max3_f32 v244, v244, v112, v113
    v_max3_f32 v245, v245, v114, v115
    v_max3_f32 v244, v244, v116, v117
    v_max3_f32 v245, v245, v118, v119
    v_max_f32 v244, v244, v245
    v_mov_b32 v245, v244
    s_nop 1
    v_permlane32_swap_b32 v244, v245
    v_max_f32 v244, v244, v245
    v_sub_f32 v72, v176, v244
    v_sub_f32 v73, v177, v244
    v_sub_f32 v74, v178, v244
    v_sub_f32 v75, v179, v244
    v_sub_f32 v76, v180, v244
    v_sub_f32 v77, v181, v244
    v_sub_f32 v78, v182, v244
    v_sub_f32 v79, v183, v244
    v_sub_f32 v80, v184, v244
    v_sub_f32 v81, v185, v244
    v_sub_f32 v82, v186, v244
    v_sub_f32 v83, v187, v244
    v_sub_f32 v84, v188, v244
    v_sub_f32 v85, v189, v244
    v_sub_f32 v86, v190, v244
    v_sub_f32 v87, v191, v244
    s_nop 1
    v_mfma_f32_32x32x16_bf16 v[72:87], v[64:67], v[168:171], v[72:87]
    v_sub_f32 v152, 0, v244
    v_sub_f32 v153, 0, v244
    v_sub_f32 v154, 0, v244
    v_sub_f32 v155, 0, v244
    v_sub_f32 v156, 0, v244
    v_sub_f32 v157, 0, v244
    v_sub_f32 v158, 0, v244
    v_sub_f32 v159, 0, v244
    v_mfma_f32_32x32x16_bf16 v[72:87], v[68:71], v[172:175], v[72:87]
    v_sub_f32 v160, 0, v244
    v_sub_f32 v161, 0, v244
    v_sub_f32 v162, 0, v244
    v_sub_f32 v163, 0, v244
    v_sub_f32 v164, 0, v244
    v_sub_f32 v165, 0, v244
    v_sub_f32 v166, 0, v244
    v_sub_f32 v167, 0, v244
    s_cmp_eq_u32 s56, 7
    s_cbranch_scc1 iv_74
ib_75:
    v_mfma_f32_32x32x16_bf16 v[88:103], v[56:59], v[168:171], v[152:167]
    s_nop 0
    v_exp_f32 v72, v72
    v_exp_f32 v73, v73
    v_exp_f32 v74, v74
    v_exp_f32 v75, v75
    v_mfma_f32_32x32x16_bf16 v[88:103], v[60:63], v[172:175], v[88:103]
    v_exp_f32 v76, v76
    v_exp_f32 v77, v77
    v_exp_f32 v78, v78
    v_exp_f32 v79, v79
    v_exp_f32 v80, v80
    v_exp_f32 v81, v81
    v_cvt_pk_bf16_f32 v72, v72, v73
    v_cvt_pk_bf16_f32 v73, v74, v75
    v_cvt_pk_bf16_f32 v74, v76, v77
    v_cvt_pk_bf16_f32 v75, v78, v79
    v_exp_f32 v82, v82
    v_exp_f32 v83, v83
    v_exp_f32 v84, v84
    v_exp_f32 v85, v85
    s_waitcnt lgkmcnt(2)
    v_mfma_f32_32x32x16_bf16 v[120:135], v[212:215], v[72:75], 0
    v_exp_f32 v86, v86
    v_exp_f32 v87, v87
    v_cvt_pk_bf16_f32 v80, v80, v81
    v_cvt_pk_bf16_f32 v81, v82, v83
    v_cvt_pk_bf16_f32 v82, v84, v85
    v_cvt_pk_bf16_f32 v83, v86, v87
    v_mfma_f32_32x32x16_bf16 v[136:151], v[208:211], v[72:75], 0
    ds_read_b64_tr_b16 v[220:221], v242 offset:14336
    ds_read_b64_tr_b16 v[222:223], v242 offset:14848
    ds_read_b64_tr_b16 v[224:225], v242 offset:15360
    ds_read_b64_tr_b16 v[226:227], v242 offset:15872
    s_cmp_eq_u32 s56, 6
    s_cbranch_scc1 iv_76
ib_77:
    v_mfma_f32_32x32x16_bf16 v[104:119], v[48:51], v[168:171], v[152:167]
    v_exp_f32 v88, v88
    v_exp_f32 v89, v89
    v_exp_f32 v90, v90
    v_exp_f32 v91, v91
    v_mfma_f32_32x32x16_bf16 v[104:119], v[52:55], v[172:175], v[104:119]
    v_exp_f32 v92, v92
    v_exp_f32 v93, v93
    v_exp_f32 v94, v94
    v_exp_f32 v95, v95
    s_waitcnt lgkmcnt(4)
    v_mfma_f32_32x32x16_bf16 v[120:135], v[216:219], v[80:83], v[120:135]
    v_exp_f32 v96, v96
    v_exp_f32 v97, v97
    v_cvt_pk_bf16_f32 v88, v88, v89
    v_cvt_pk_bf16_f32 v89, v90, v91
    v_cvt_pk_bf16_f32 v90, v92, v93
    v_cvt_pk_bf16_f32 v91, v94, v95
    v_mfma_f32_32x32x16_bf16 v[136:151], v[208:211], v[80:83], v[136:151]
    v_exp_f32 v98, v98
    v_exp_f32 v99, v99
    v_exp_f32 v100, v100
    v_exp_f32 v101, v101
    s_waitcnt lgkmcnt(2)
    v_mfma_f32_32x32x16_bf16 v[120:135], v[220:223], v[88:91], v[120:135]
    v_exp_f32 v102, v102
    v_exp_f32 v103, v103
    v_cvt_pk_bf16_f32 v96, v96, v97
    v_cvt_pk_bf16_f32 v97, v98, v99
    v_cvt_pk_bf16_f32 v98, v100, v101
    v_cvt_pk_bf16_f32 v99, v102, v103
    v_mfma_f32_32x32x16_bf16 v[136:151], v[208:211], v[88:91], v[136:151]
    ds_read_b64_tr_b16 v[212:213], v242 offset:12288
    ds_read_b64_tr_b16 v[214:215], v242 offset:12800
    ds_read_b64_tr_b16 v[216:217], v242 offset:13312
    ds_read_b64_tr_b16 v[218:219], v242 offset:13824
    s_cmp_eq_u32 s56, 5
    s_cbranch_scc1 iv_78
ib_79:
    v_mfma_f32_32x32x16_bf16 v[72:87], v[40:43], v[168:171], v[152:167]
    v_exp_f32 v104, v104
    v_exp_f32 v105, v105
    v_exp_f32 v106, v106
    v_exp_f32 v107, v107
    v_mfma_f32_32x32x16_bf16 v[72:87], v[44:47], v[172:175], v[72:87]
    v_exp_f32 v108, v108
    v_exp_f32 v109, v109
    v_exp_f32 v110, v110
    v_exp_f32 v111, v111
    s_waitcnt lgkmcnt(4)
    v_mfma_f32_32x32x16_bf16 v[120:135], v[224:227], v[96:99], v[120:135]
    v_exp_f32 v112, v112
    v_exp_f32 v113, v113
    v_cvt_pk_bf16_f32 v104, v104, v105
    v_cvt_pk_bf16_f32 v105, v106, v107
    v_cvt_pk_bf16_f32 v106, v108, v109
    v_cvt_pk_bf16_f32 v107, v110, v111
    v_mfma_f32_32x32x16_bf16 v[136:151], v[208:211], v[96:99], v[136:151]
    v_exp_f32 v114, v114
    v_exp_f32 v115, v115
    v_exp_f32 v116, v116
    v_exp_f32 v117, v117
    s_waitcnt lgkmcnt(2)
    v_mfma_f32_32x32x16_bf16 v[120:135], v[212:215], v[104:107], v[120:135]
    v_exp_f32 v118, v118
    v_exp_f32 v119, v119
    v_cvt_pk_bf16_f32 v112, v112, v113
    v_cvt_pk_bf16_f32 v113, v114, v115
    v_cvt_pk_bf16_f32 v114, v116, v117
    v_cvt_pk_bf16_f32 v115, v118, v119
    v_mfma_f32_32x32x16_bf16 v[136:151], v[208:211], v[104:107], v[136:151]
    ds_read_b64_tr_b16 v[220:221], v242 offset:10240
    ds_read_b64_tr_b16 v[222:223], v242 offset:10752
    ds_read_b64_tr_b16 v[224:225], v242 offset:11264
    ds_read_b64_tr_b16 v[226:227], v242 offset:11776
    s_cmp_eq_u32 s56, 4
    s_cbranch_scc1 iv_80
ib_81:
    v_mfma_f32_32x32x16_bf16 v[88:103], v[32:35], v[168:171], v[152:167]
    v_exp_f32 v72, v72
    v_exp_f32 v73, v73
    v_exp_f32 v74, v74
    v_exp_f32 v75, v75
    v_mfma_f32_32x32x16_bf16 v[88:103], v[36:39], v[172:175], v[88:103]
    v_exp_f32 v76, v76
    v_exp_f32 v77, v77
    v_exp_f32 v78, v78
    v_exp_f32 v79, v79
    s_waitcnt lgkmcnt(4)
    v_mfma_f32_32x32x16_bf16 v[120:135], v[216:219], v[112:115], v[120:135]
    v_exp_f32 v80, v80
    v_exp_f32 v81, v81
    v_cvt_pk_bf16_f32 v72, v72, v73
    v_cvt_pk_bf16_f32 v73, v74, v75
    v_cvt_pk_bf16_f32 v74, v76, v77
    v_cvt_pk_bf16_f32 v75, v78, v79
    v_mfma_f32_32x32x16_bf16 v[136:151], v[208:211], v[112:115], v[136:151]
    v_exp_f32 v82, v82
    v_exp_f32 v83, v83
    v_exp_f32 v84, v84
    v_exp_f32 v85, v85
    s_waitcnt lgkmcnt(2)
    v_mfma_f32_32x32x16_bf16 v[120:135], v[220:223], v[72:75], v[120:135]
    v_exp_f32 v86, v86
    v_exp_f32 v87, v87
    v_cvt_pk_bf16_f32 v80, v80, v81
    v_cvt_pk_bf16_f32 v81, v82, v83
    v_cvt_pk_bf16_f32 v82, v84, v85
    v_cvt_pk_bf16_f32 v83, v86, v87
    v_mfma_f32_32x32x16_bf16 v[136:151], v[208:211], v[72:75], v[136:151]
    ds_read_b64_tr_b16 v[212:213], v242 offset:8192
    ds_read_b64_tr_b16 v[214:215], v242 offset:8704
    ds_read_b64_tr_b16 v[216:217], v242 offset:9216
    ds_read_b64_tr_b16 v[218:219], v242 offset:9728
    s_cmp_eq_u32 s56, 3
    s_cbranch_scc1 iv_82
ib_83:
    v_mfma_f32_32x32x16_bf16 v[104:119], v[24:27], v[168:171], v[152:167]
    v_exp_f32 v88, v88
    v_exp_f32 v89, v89
    v_exp_f32 v90, v90
    v_exp_f32 v91, v91
    v_mfma_f32_32x32x16_bf16 v[104:119], v[28:31], v[172:175], v[104:119]
    v_exp_f32 v92, v92
    v_exp_f32 v93, v93
    v_exp_f32 v94, v94
    v_exp_f32 v95, v95
    s_waitcnt lgkmcnt(4)
    v_mfma_f32_32x32x16_bf16 v[120:135], v[224:227], v[80:83], v[120:135]
    v_exp_f32 v96, v96
    v_exp_f32 v97, v97
    v_cvt_pk_bf16_f32 v88, v88, v89
    v_cvt_pk_bf16_f32 v89, v90, v91
    v_cvt_pk_bf16_f32 v90, v92, v93
    v_cvt_pk_bf16_f32 v91, v94, v95
    v_mfma_f32_32x32x16_bf16 v[136:151], v[208:211], v[80:83], v[136:151]
    v_exp_f32 v98, v98
    v_exp_f32 v99, v99
    v_exp_f32 v100, v100
    v_exp_f32 v101, v101
    s_waitcnt lgkmcnt(2)
    v_mfma_f32_32x32x16_bf16 v[120:135], v[212:215], v[88:91], v[120:135]
    v_exp_f32 v102, v102
    v_exp_f32 v103, v103
    v_cvt_pk_bf16_f32 v96, v96, v97
    v_cvt_pk_bf16_f32 v97, v98, v99
    v_cvt_pk_bf16_f32 v98, v100, v101
    v_cvt_pk_bf16_f32 v99, v102, v103
    v_mfma_f32_32x32x16_bf16 v[136:151], v[208:211], v[88:91], v[136:151]
    ds_read_b64_tr_b16 v[220:221], v242 offset:6144
    ds_read_b64_tr_b16 v[222:223], v242 offset:6656
    ds_read_b64_tr_b16 v[224:225], v242 offset:7168
    ds_read_b64_tr_b16 v[226:227], v242 offset:7680
    s_cmp_eq_u32 s56, 2
    s_cbranch_scc1 iv_84
ib_85:
    v_mfma_f32_32x32x16_bf16 v[72:87], v[16:19], v[168:171], v[152:167]
    v_exp_f32 v104, v104
    v_exp_f32 v105, v105
    v_exp_f32 v106, v106
    v_exp_f32 v107, v107
    v_mfma_f32_32x32x16_bf16 v[72:87], v[20:23], v[172:175], v[72:87]
    v_exp_f32 v108, v108
    v_exp_f32 v109, v109
    v_exp_f32 v110, v110
    v_exp_f32 v111, v111
    s_waitcnt lgkmcnt(4)
    v_mfma_f32_32x32x16_bf16 v[120:135], v[216:219], v[96:99], v[120:135]
    v_exp_f32 v112, v112
    v_exp_f32 v113, v113
    v_cvt_pk_bf16_f32 v104, v104, v105
    v_cvt_pk_bf16_f32 v105, v106, v107
    v_cvt_pk_bf16_f32 v106, v108, v109
    v_cvt_pk_bf16_f32 v107, v110, v111
    v_mfma_f32_32x32x16_bf16 v[136:151], v[208:211], v[96:99], v[136:151]
    v_exp_f32 v114, v114
    v_exp_f32 v115, v115
    v_exp_f32 v116, v116
    v_exp_f32 v117, v117
    s_waitcnt lgkmcnt(2)
    v_mfma_f32_32x32x16_bf16 v[120:135], v[220:223], v[104:107], v[120:135]
    v_exp_f32 v118, v118
    v_exp_f32 v119, v119
    v_cvt_pk_bf16_f32 v112, v112, v113
    v_cvt_pk_bf16_f32 v113, v114, v115
    v_cvt_pk_bf16_f32 v114, v116, v117
    v_cvt_pk_bf16_f32 v115, v118, v119
    v_mfma_f32_32x32x16_bf16 v[136:151], v[208:211], v[104:107], v[136:151]
    ds_read_b64_tr_b16 v[212:213], v242 offset:4096
    ds_read_b64_tr_b16 v[214:215], v242 offset:4608
    ds_read_b64_tr_b16 v[216:217], v242 offset:5120
    ds_read_b64_tr_b16 v[218:219], v242 offset:5632
    s_cmp_eq_u32 s56, 1
    s_cbranch_scc1 iv_86
ib_87:
    v_mfma_f32_32x32x16_bf16 v[88:103], v[8:11], v[168:171], v[152:167]
    v_exp_f32 v72, v72
    v_exp_f32 v73, v73
    v_exp_f32 v74, v74
    v_exp_f32 v75, v75
    v_mfma_f32_32x32x16_bf16 v[88:103], v[12:15], v[172:175], v[88:103]
    v_exp_f32 v76, v76
    v_exp_f32 v77, v77
    v_exp_f32 v78, v78
    v_exp_f32 v79, v79
    s_waitcnt lgkmcnt(4)
    v_mfma_f32_32x32x16_bf16 v[120:135], v[224:227], v[112:115], v[120:135]
    v_exp_f32 v80, v80
    v_exp_f32 v81, v81
    v_cvt_pk_bf16_f32 v72, v72, v73
    v_cvt_pk_bf16_f32 v73, v74, v75
    v_cvt_pk_bf16_f32 v74, v76, v77
    v_cvt_pk_bf16_f32 v75, v78, v79
    v_mfma_f32_32x32x16_bf16 v[136:151], v[208:211], v[112:115], v[136:151]
    v_exp_f32 v82, v82
    v_exp_f32 v83, v83
    v_exp_f32 v84, v84
    v_exp_f32 v85, v85
    s_waitcnt lgkmcnt(2)
    v_mfma_f32_32x32x16_bf16 v[120:135], v[212:215], v[72:75], v[120:135]
    v_exp_f32 v86, v86
    v_exp_f32 v87, v87
    v_cvt_pk_bf16_f32 v80, v80, v81
    v_cvt_pk_bf16_f32 v81, v82, v83
    v_cvt_pk_bf16_f32 v82, v84, v85
    v_cvt_pk_bf16_f32 v83, v86, v87
    v_mfma_f32_32x32x16_bf16 v[136:151], v[208:211], v[72:75], v[136:151]
    ds_read_b64_tr_b16 v[220:221], v242 offset:2048
    ds_read_b64_tr_b16 v[222:223], v242 offset:2560
    ds_read_b64_tr_b16 v[224:225], v242 offset:3072
    ds_read_b64_tr_b16 v[226:227], v242 offset:3584
    v_sub_f32 v104, v192, v244
    v_sub_f32 v105, v193, v244
    v_sub_f32 v106, v194, v244
    v_sub_f32 v107, v195, v244
    v_sub_f32 v108, v196, v244
    v_sub_f32 v109, v197, v244
    v_sub_f32 v110, v198, v244
    v_sub_f32 v111, v199, v244
    v_sub_f32 v112, v200, v244
    v_sub_f32 v113, v201, v244
    v_sub_f32 v114, v202, v244
    v_sub_f32 v115, v203, v244
    v_sub_f32 v116, v204, v244
    v_sub_f32 v117, v205, v244
    v_sub_f32 v118, v206, v244
    v_sub_f32 v119, v207, v244
    s_nop 1
    v_mfma_f32_32x32x16_bf16 v[104:119], v[0:3], v[168:171], v[104:119]
    v_exp_f32 v88, v88
    v_exp_f32 v89, v89
    v_exp_f32 v90, v90
    v_exp_f32 v91, v91
    v_mfma_f32_32x32x16_bf16 v[104:119], v[4:7], v[172:175], v[104:119]
    v_exp_f32 v92, v92
    v_exp_f32 v93, v93
    v_exp_f32 v94, v94
    v_exp_f32 v95, v95
    s_waitcnt lgkmcnt(4)
    v_mfma_f32_32x32x16_bf16 v[120:135], v[216:219], v[80:83], v[120:135]
    v_exp_f32 v96, v96
    v_exp_f32 v97, v97
    v_cvt_pk_bf16_f32 v88, v88, v89
    v_cvt_pk_bf16_f32 v89, v90, v91
    v_cvt_pk_bf16_f32 v90, v92, v93
    v_cvt_pk_bf16_f32 v91, v94, v95
    v_mfma_f32_32x32x16_bf16 v[136:151], v[208:211], v[80:83], v[136:151]
    v_exp_f32 v98, v98
    v_exp_f32 v99, v99
    v_exp_f32 v100, v100
    v_exp_f32 v101, v101
    s_waitcnt lgkmcnt(2)
    v_mfma_f32_32x32x16_bf16 v[120:135], v[220:223], v[88:91], v[120:135]
    v_exp_f32 v102, v102
    v_exp_f32 v103, v103
    v_cvt_pk_bf16_f32 v96, v96, v97
    v_cvt_pk_bf16_f32 v97, v98, v99
    v_cvt_pk_bf16_f32 v98, v100, v101
    v_cvt_pk_bf16_f32 v99, v102, v103
    v_mfma_f32_32x32x16_bf16 v[136:151], v[208:211], v[88:91], v[136:151]
    ds_read_b64_tr_b16 v[212:213], v242 offset:0
    ds_read_b64_tr_b16 v[214:215], v242 offset:512
    ds_read_b64_tr_b16 v[216:217], v242 offset:1024
    ds_read_b64_tr_b16 v[218:219], v242 offset:1536
    v_exp_f32 v104, v104
    v_exp_f32 v105, v105
    v_exp_f32 v106, v106
    v_exp_f32 v107, v107
    v_exp_f32 v108, v108
    v_exp_f32 v109, v109
    v_exp_f32 v110, v110
    v_exp_f32 v111, v111
    s_waitcnt lgkmcnt(4)
    v_mfma_f32_32x32x16_bf16 v[120:135], v[224:227], v[96:99], v[120:135]
    v_exp_f32 v112, v112
    v_exp_f32 v113, v113
    v_cvt_pk_bf16_f32 v104, v104, v105
    v_cvt_pk_bf16_f32 v105, v106, v107
    v_cvt_pk_bf16_f32 v106, v108, v109
    v_cvt_pk_bf16_f32 v107, v110, v111
    v_mfma_f32_32x32x16_bf16 v[136:151], v[208:211], v[96:99], v[136:151]
    v_exp_f32 v114, v114
    v_exp_f32 v115, v115
    v_exp_f32 v116, v116
    v_exp_f32 v117, v117
    s_waitcnt lgkmcnt(2)
    v_mfma_f32_32x32x16_bf16 v[120:135], v[212:215], v[104:107], v[120:135]
    v_exp_f32 v118, v118
    v_exp_f32 v119, v119
    v_cvt_pk_bf16_f32 v112, v112, v113
    v_cvt_pk_bf16_f32 v113, v114, v115
    v_cvt_pk_bf16_f32 v114, v116, v117
    v_cvt_pk_bf16_f32 v115, v118, v119
    v_mfma_f32_32x32x16_bf16 v[136:151], v[208:211], v[104:107], v[136:151]
    s_nop 0
    v_mfma_f32_32x32x16_bf16 v[136:151], v[208:211], v[112:115], v[136:151]
    s_waitcnt lgkmcnt(0)
    v_mfma_f32_32x32x16_bf16 v[120:135], v[216:219], v[112:115], v[120:135]
    s_nop 9
    v_rcp_f32 v244, v136
    s_nop 0
    v_mul_f32 v72, v120, v244
    v_mul_f32 v73, v121, v244
    v_mul_f32 v74, v122, v244
    v_mul_f32 v75, v123, v244
    v_mul_f32 v76, v124, v244
    v_mul_f32 v77, v125, v244
    v_mul_f32 v78, v126, v244
    v_mul_f32 v79, v127, v244
    v_mul_f32 v80, v128, v244
    v_mul_f32 v81, v129, v244
    v_mul_f32 v82, v130, v244
    v_mul_f32 v83, v131, v244
    v_mul_f32 v84, v132, v244
    v_mul_f32 v85, v133, v244
    v_mul_f32 v86, v134, v244
    v_mul_f32 v87, v135, v244
    v_cvt_pk_bf16_f32 v88, v72, v73
    v_cvt_pk_bf16_f32 v89, v74, v75
    v_cvt_pk_bf16_f32 v90, v76, v77
    v_cvt_pk_bf16_f32 v91, v78, v79
    v_cvt_pk_bf16_f32 v92, v80, v81
    v_cvt_pk_bf16_f32 v93, v82, v83
    v_cvt_pk_bf16_f32 v94, v84, v85
    v_cvt_pk_bf16_f32 v95, v86, v87
    v_permlane32_swap_b32 v88, v90
    v_permlane32_swap_b32 v89, v91
    v_permlane32_swap_b32 v92, v94
    v_permlane32_swap_b32 v93, v95
    s_cmp_eq_u32 s29, 0xff
    s_cbranch_scc0 p_88
    buffer_store_dwordx4 v[88:91], v250, s[40:43], s58 offen
    buffer_store_dwordx4 v[92:95], v250, s[40:43], s58 offen offset:32
p_89:
    s_setprio 0
    s_cmp_eq_u32 s26, 0
    s_cbranch_scc0 hw_90
    v_bfe_u32 v164, v254, 2, 3
    v_and_b32 v165, 3, v254
    v_lshlrev_b32 v165, 2, v165
    v_lshl_add_u32 v164, v164, 7, v165
    buffer_load_dword v165, v164, s[44:47], s22 offen offset:16 sc1
    v_lshrrev_b32 v2, 3, v254
    s_lshl_b32 s23, s24, 5
    v_add_u32 v2, s23, v2
    v_xor_b32 v2, s55, v2
    v_lshrrev_b32 v3, 4, v254
    v_and_b32 v4, 7, v254
    v_xor_b32 v3, v3, v4
    v_lshlrev_b32 v2, 6, v2
    v_and_b32 v4, 3, v3
    v_lshl_add_u32 v2, v4, 4, v2
    v_lshrrev_b32 v3, 2, v3
    v_lshl_add_u32 v2, v3, 17, v2
    v_xor_b32 v3, 0, v2
    v_add_u32 v136, 4096, v3
    v_xor_b32 v3, 131584, v2
    v_add_u32 v137, 3072, v3
    v_xor_b32 v3, 1024, v2
    v_add_u32 v138, 2048, v3
    v_xor_b32 v3, 132608, v2
    v_add_u32 v139, 1024, v3
    s_lshl_b32 s36, s24, 12
    s_waitcnt vmcnt(0)
    v_cmp_eq_u32 vcc, 1, v165
    s_nop 0
    s_cmp_eq_u64 vcc, -1
    s_cbranch_scc1 polld_92
    s_mov_b32 s70, 1048576
poll_91:
    s_sleep 1
    buffer_load_dword v165, v164, s[44:47], s22 offen offset:16 sc1
    s_waitcnt vmcnt(0)
    v_cmp_eq_u32 vcc, 1, v165
    s_nop 0
    s_cmp_eq_u64 vcc, -1
    s_cbranch_scc1 polld_92
    s_sub_u32 s70, s70, 1
    s_cmp_lg_u32 s70, 0
    s_cbranch_scc1 poll_91
polld_92:
    s_add_u32 s23, s16, 8192
    s_add_u32 m0, s36, 81920
    s_nop 0
    buffer_load_dwordx4 v136, s[8:11], s16 offen offset:0 sc1 lds
    buffer_load_dwordx4 v137, s[8:11], s16 offen offset:1024 sc1 lds
    buffer_load_dwordx4 v138, s[8:11], s16 offen offset:2048 sc1 lds
    buffer_load_dwordx4 v139, s[8:11], s16 offen offset:3072 sc1 lds
    s_add_u32 m0, s36, 98304
    s_nop 0
    buffer_load_dwordx4 v136, s[8:11], s23 offen offset:0 sc1 lds
    buffer_load_dwordx4 v137, s[8:11], s23 offen offset:1024 sc1 lds
    buffer_load_dwordx4 v138, s[8:11], s23 offen offset:2048 sc1 lds
    buffer_load_dwordx4 v139, s[8:11], s23 offen offset:3072 sc1 lds
    v_and_b32 v2, 15, v254
    s_lshl_b32 s23, s25, 6
    v_add_u32 v3, s23, v2
    v_lshlrev_b32 v3, 7, v3
    v_lshrrev_b32 v2, 1, v2
    v_lshrrev_b32 v4, 4, v254
    v_xor_b32 v2, v2, v4
    v_lshl_add_u32 v128, v2, 4, v3
    v_xor_b32 v129, 64, v128
    v_add_u32 v130, 81920, v128
    v_add_u32 v131, 81920, v129
    v_bfe_u32 v2, v254, 2, 2
    v_lshl_add_u32 v3, v4, 3, v2
    v_and_b32 v5, 1, v4
    v_lshlrev_b32 v5, 3, v5
    v_lshlrev_b32 v6, 1, v2
    v_xor_b32 v5, v5, v6
    v_lshlrev_b32 v3, 8, v3
    v_and_b32 v6, 1, v254
    v_lshl_add_u32 v3, v6, 3, v3
    v_add_u32 v3, 114688, v3
    v_bfe_u32 v6, v254, 1, 1
    s_lshl_b32 s23, s26, 3
    v_add_u32 v6, s23, v6
    v_add_u32 v7, 0, v6
    v_xor_b32 v7, v7, v5
    v_lshl_add_u32 v132, v7, 4, v3
    v_add_u32 v7, 2, v6
    v_xor_b32 v7, v7, v5
    v_lshl_add_u32 v133, v7, 4, v3
    v_add_u32 v7, 4, v6
    v_xor_b32 v7, v7, v5
    v_lshl_add_u32 v134, v7, 4, v3
    v_add_u32 v7, 6, v6
    v_xor_b32 v7, v7, v5
    v_lshl_add_u32 v135, v7, 4, v3
    s_waitcnt vmcnt(0)
    s_branch g2_join
iv_60:
    s_nop 7
    v_mov_b32 v152, s57
    v_mov_b32 v153, s57
    v_mov_b32 v154, s57
    v_mov_b32 v155, s57
    v_mov_b32 v156, s57
    v_mov_b32 v157, s57
    v_mov_b32 v158, s57
    v_mov_b32 v159, s57
    v_mov_b32 v160, s57
    v_mov_b32 v161, s57
    v_mov_b32 v162, s57
    v_mov_b32 v163, s57
    v_mov_b32 v164, s57
    v_mov_b32 v165, s57
    v_mov_b32 v166, s57
    v_mov_b32 v167, s57
    s_nop 1
    s_branch ib_61
iv_62:
    s_nop 7
    v_mov_b32 v152, s57
    v_mov_b32 v153, s57
    v_mov_b32 v154, s57
    v_mov_b32 v155, s57
    v_mov_b32 v156, s57
    v_mov_b32 v157, s57
    v_mov_b32 v158, s57
    v_mov_b32 v159, s57
    v_mov_b32 v160, s57
    v_mov_b32 v161, s57
    v_mov_b32 v162, s57
    v_mov_b32 v163, s57
    v_mov_b32 v164, s57
    v_mov_b32 v165, s57
    v_mov_b32 v166, s57
    v_mov_b32 v167, s57
    s_nop 1
    s_branch ib_63
iv_64:
    s_nop 7
    v_mov_b32 v152, s57
    v_mov_b32 v153, s57
    v_mov_b32 v154, s57
    v_mov_b32 v155, s57
    v_mov_b32 v156, s57
    v_mov_b32 v157, s57
    v_mov_b32 v158, s57
    v_mov_b32 v159, s57
    v_mov_b32 v160, s57
    v_mov_b32 v161, s57
    v_mov_b32 v162, s57
    v_mov_b32 v163, s57
    v_mov_b32 v164, s57
    v_mov_b32 v165, s57
    v_mov_b32 v166, s57
    v_mov_b32 v167, s57
    s_nop 1
    s_branch ib_65
iv_66:
    s_nop 7
    v_mov_b32 v152, s57
    v_mov_b32 v153, s57
    v_mov_b32 v154, s57
    v_mov_b32 v155, s57
    v_mov_b32 v156, s57
    v_mov_b32 v157, s57
    v_mov_b32 v158, s57
    v_mov_b32 v159, s57
    v_mov_b32 v160, s57
    v_mov_b32 v161, s57
    v_mov_b32 v162, s57
    v_mov_b32 v163, s57
    v_mov_b32 v164, s57
    v_mov_b32 v165, s57
    v_mov_b32 v166, s57
    v_mov_b32 v167, s57
    s_nop 1
    s_branch ib_67
iv_68:
    s_nop 7
    v_mov_b32 v152, s57
    v_mov_b32 v153, s57
    v_mov_b32 v154, s57
    v_mov_b32 v155, s57
    v_mov_b32 v156, s57
    v_mov_b32 v157, s57
    v_mov_b32 v158, s57
    v_mov_b32 v159, s57
    v_mov_b32 v160, s57
    v_mov_b32 v161, s57
    v_mov_b32 v162, s57
    v_mov_b32 v163, s57
    v_mov_b32 v164, s57
    v_mov_b32 v165, s57
    v_mov_b32 v166, s57
    v_mov_b32 v167, s57
    s_nop 1
    s_branch ib_69
iv_70:
    s_nop 7
    v_mov_b32 v152, s57
    v_mov_b32 v153, s57
    v_mov_b32 v154, s57
    v_mov_b32 v155, s57
    v_mov_b32 v156, s57
    v_mov_b32 v157, s57
    v_mov_b32 v158, s57
    v_mov_b32 v159, s57
    v_mov_b32 v160, s57
    v_mov_b32 v161, s57
    v_mov_b32 v162, s57
    v_mov_b32 v163, s57
    v_mov_b32 v164, s57
    v_mov_b32 v165, s57
    v_mov_b32 v166, s57
    v_mov_b32 v167, s57
    s_nop 1
    s_branch ib_71
iv_72:
    s_nop 7
    v_mov_b32 v152, s57
    v_mov_b32 v153, s57
    v_mov_b32 v154, s57
    v_mov_b32 v155, s57
    v_mov_b32 v156, s57
    v_mov_b32 v157, s57
    v_mov_b32 v158, s57
    v_mov_b32 v159, s57
    v_mov_b32 v160, s57
    v_mov_b32 v161, s57
    v_mov_b32 v162, s57
    v_mov_b32 v163, s57
    v_mov_b32 v164, s57
    v_mov_b32 v165, s57
    v_mov_b32 v166, s57
    v_mov_b32 v167, s57
    s_nop 1
    s_branch ib_73
iv_74:
    s_nop 7
    v_mov_b32 v152, s57
    v_mov_b32 v153, s57
    v_mov_b32 v154, s57
    v_mov_b32 v155, s57
    v_mov_b32 v156, s57
    v_mov_b32 v157, s57
    v_mov_b32 v158, s57
    v_mov_b32 v159, s57
    v_mov_b32 v160, s57
    v_mov_b32 v161, s57
    v_mov_b32 v162, s57
    v_mov_b32 v163, s57
    v_mov_b32 v164, s57
    v_mov_b32 v165, s57
    v_mov_b32 v166, s57
    v_mov_b32 v167, s57
    s_nop 1
    s_branch ib_75
iv_76:
    s_nop 7
    v_mov_b32 v152, s57
    v_mov_b32 v153, s57
    v_mov_b32 v154, s57
    v_mov_b32 v155, s57
    v_mov_b32 v156, s57
    v_mov_b32 v157, s57
    v_mov_b32 v158, s57
    v_mov_b32 v159, s57
    v_mov_b32 v160, s57
    v_mov_b32 v161, s57
    v_mov_b32 v162, s57
    v_mov_b32 v163, s57
    v_mov_b32 v164, s57
    v_mov_b32 v165, s57
    v_mov_b32 v166, s57
    v_mov_b32 v167, s57
    s_nop 1
    s_branch ib_77
iv_78:
    s_nop 7
    v_mov_b32 v152, s57
    v_mov_b32 v153, s57
    v_mov_b32 v154, s57
    v_mov_b32 v155, s57
    v_mov_b32 v156, s57
    v_mov_b32 v157, s57
    v_mov_b32 v158, s57
    v_mov_b32 v159, s57
    v_mov_b32 v160, s57
    v_mov_b32 v161, s57
    v_mov_b32 v162, s57
    v_mov_b32 v163, s57
    v_mov_b32 v164, s57
    v_mov_b32 v165, s57
    v_mov_b32 v166, s57
    v_mov_b32 v167, s57
    s_nop 1
    s_branch ib_79
iv_80:
    s_nop 7
    v_mov_b32 v152, s57
    v_mov_b32 v153, s57
    v_mov_b32 v154, s57
    v_mov_b32 v155, s57
    v_mov_b32 v156, s57
    v_mov_b32 v157, s57
    v_mov_b32 v158, s57
    v_mov_b32 v159, s57
    v_mov_b32 v160, s57
    v_mov_b32 v161, s57
    v_mov_b32 v162, s57
    v_mov_b32 v163, s57
    v_mov_b32 v164, s57
    v_mov_b32 v165, s57
    v_mov_b32 v166, s57
    v_mov_b32 v167, s57
    s_nop 1
    s_branch ib_81
iv_82:
    s_nop 7
    v_mov_b32 v152, s57
    v_mov_b32 v153, s57
    v_mov_b32 v154, s57
    v_mov_b32 v155, s57
    v_mov_b32 v156, s57
    v_mov_b32 v157, s57
    v_mov_b32 v158, s57
    v_mov_b32 v159, s57
    v_mov_b32 v160, s57
    v_mov_b32 v161, s57
    v_mov_b32 v162, s57
    v_mov_b32 v163, s57
    v_mov_b32 v164, s57
    v_mov_b32 v165, s57
    v_mov_b32 v166, s57
    v_mov_b32 v167, s57
    s_nop 1
    s_branch ib_83
iv_84:
    s_nop 7
    v_mov_b32 v152, s57
    v_mov_b32 v153, s57
    v_mov_b32 v154, s57
    v_mov_b32 v155, s57
    v_mov_b32 v156, s57
    v_mov_b32 v157, s57
    v_mov_b32 v158, s57
    v_mov_b32 v159, s57
    v_mov_b32 v160, s57
    v_mov_b32 v161, s57
    v_mov_b32 v162, s57
    v_mov_b32 v163, s57
    v_mov_b32 v164, s57
    v_mov_b32 v165, s57
    v_mov_b32 v166, s57
    v_mov_b32 v167, s57
    s_nop 1
    s_branch ib_85
iv_86:
    s_nop 7
    v_mov_b32 v152, s57
    v_mov_b32 v153, s57
    v_mov_b32 v154, s57
    v_mov_b32 v155, s57
    v_mov_b32 v156, s57
    v_mov_b32 v157, s57
    v_mov_b32 v158, s57
    v_mov_b32 v159, s57
    v_mov_b32 v160, s57
    v_mov_b32 v161, s57
    v_mov_b32 v162, s57
    v_mov_b32 v163, s57
    v_mov_b32 v164, s57
    v_mov_b32 v165, s57
    v_mov_b32 v166, s57
    v_mov_b32 v167, s57
    s_nop 1
    s_branch ib_87
hw_90:
    v_and_b32 v2, 15, v254
    s_lshl_b32 s23, s25, 6
    v_add_u32 v3, s23, v2
    v_lshlrev_b32 v3, 7, v3
    v_lshrrev_b32 v2, 1, v2
    v_lshrrev_b32 v4, 4, v254
    v_xor_b32 v2, v2, v4
    v_lshl_add_u32 v128, v2, 4, v3
    v_xor_b32 v129, 64, v128
    v_add_u32 v130, 81920, v128
    v_add_u32 v131, 81920, v129
    v_bfe_u32 v2, v254, 2, 2
    v_lshl_add_u32 v3, v4, 3, v2
    v_and_b32 v5, 1, v4
    v_lshlrev_b32 v5, 3, v5
    v_lshlrev_b32 v6, 1, v2
    v_xor_b32 v5, v5, v6
    v_lshlrev_b32 v3, 8, v3
    v_and_b32 v6, 1, v254
    v_lshl_add_u32 v3, v6, 3, v3
    v_add_u32 v3, 114688, v3
    v_bfe_u32 v6, v254, 1, 1
    s_lshl_b32 s23, s26, 3
    v_add_u32 v6, s23, v6
    v_add_u32 v7, 0, v6
    v_xor_b32 v7, v7, v5
    v_lshl_add_u32 v132, v7, 4, v3
    v_add_u32 v7, 2, v6
    v_xor_b32 v7, v7, v5
    v_lshl_add_u32 v133, v7, 4, v3
    v_add_u32 v7, 4, v6
    v_xor_b32 v7, v7, v5
    v_lshl_add_u32 v134, v7, 4, v3
    v_add_u32 v7, 6, v6
    v_xor_b32 v7, v7, v5
    v_lshl_add_u32 v135, v7, 4, v3
    v_lshrrev_b32 v2, 3, v254
    s_lshl_b32 s23, s24, 5
    v_add_u32 v2, s23, v2
    v_xor_b32 v2, s55, v2
    v_lshrrev_b32 v3, 4, v254
    v_and_b32 v4, 7, v254
    v_xor_b32 v3, v3, v4
    v_lshlrev_b32 v2, 6, v2
    v_and_b32 v4, 3, v3
    v_lshl_add_u32 v2, v4, 4, v2
    v_lshrrev_b32 v3, 2, v3
    v_lshl_add_u32 v2, v3, 17, v2
    v_xor_b32 v3, 0, v2
    v_add_u32 v136, 4096, v3
    v_xor_b32 v3, 131584, v2
    v_add_u32 v137, 3072, v3
    v_xor_b32 v3, 1024, v2
    v_add_u32 v138, 2048, v3
    v_xor_b32 v3, 132608, v2
    v_add_u32 v139, 1024, v3
    s_lshl_b32 s36, s24, 12
g2_join:
    s_barrier
    s_add_u32 s23, s26, 1
    s_lshl_b32 s23, s23, 18
    s_add_u32 s23, s23, s16
    s_lshl_b32 s3, s26, 15
    s_add_u32 s3, s3, s36
    s_mov_b32 m0, s3
    s_nop 0
    buffer_load_dwordx4 v136, s[8:11], s23 offen offset:0 sc1 lds
    buffer_load_dwordx4 v137, s[8:11], s23 offen offset:1024 sc1 lds
    buffer_load_dwordx4 v138, s[8:11], s23 offen offset:2048 sc1 lds
    buffer_load_dwordx4 v139, s[8:11], s23 offen offset:3072 sc1 lds
    s_xor_b32 s3, s3, 16384
    s_lshl_b32 s60, s26, 14
    s_sub_u32 s60, 8192, s60
    s_add_u32 s23, s23, s60
    s_mov_b32 m0, s3
    s_nop 0
    buffer_load_dwordx4 v136, s[8:11], s23 offen offset:0 sc1 lds
    buffer_load_dwordx4 v137, s[8:11], s23 offen offset:1024 sc1 lds
    buffer_load_dwordx4 v138, s[8:11], s23 offen offset:2048 sc1 lds
    buffer_load_dwordx4 v139, s[8:11], s23 offen offset:3072 sc1 lds
    s_add_u32 s16, s16, 786432
    ds_read_b128 v[64:67], v130 offset:0
    ds_read_b64_tr_b16 v[96:97], v132 offset:0
    ds_read_b64_tr_b16 v[98:99], v132 offset:1024
    ds_read_b128 v[68:71], v130 offset:2048
    ds_read_b128 v[72:75], v130 offset:4096
    ds_read_b128 v[76:79], v130 offset:6144
    ds_read_b64_tr_b16 v[100:101], v133 offset:0
    ds_read_b64_tr_b16 v[102:103], v133 offset:1024
    ds_read_b64_tr_b16 v[104:105], v134 offset:0
    ds_read_b64_tr_b16 v[106:107], v134 offset:1024
    ds_read_b64_tr_b16 v[108:109], v135 offset:0
    ds_read_b64_tr_b16 v[110:111], v135 offset:1024
    v_lshrrev_b32 v2, 4, v254
    s_and_b32 s23, s24, 1
    s_lshl_b32 s23, s23, 3
    v_lshlrev_b32 v3, 1, v2
    v_xor_b32 v3, s23, v3
    v_and_b32 v4, 15, v254
    v_xor_b32 v3, v3, v4
    s_lshl_b32 s23, s24, 3
    v_add_u32 v2, s23, v2
    v_lshlrev_b32 v2, 11, v2
    v_lshl_add_u32 v140, v3, 4, v2
    v_add_u32 v141, 7168, v140
    s_mul_i32 s37, s24, 2048
    s_add_u32 s17, s17, 393216
    v_and_b32 v164, 7, v254
    v_lshlrev_b32 v164, 7, v164
    s_waitcnt lgkmcnt(9)
    v_mfma_f32_16x16x32_bf16 v[0:3], v[96:99], v[64:67], 0
    ds_read_b128 v[80:83], v131 offset:0
    s_waitcnt lgkmcnt(9)
    v_mfma_f32_16x16x32_bf16 v[4:7], v[96:99], v[68:71], 0
    ds_read_b64_tr_b16 v[112:113], v132 offset:8192
    s_waitcnt lgkmcnt(9)
    v_mfma_f32_16x16x32_bf16 v[8:11], v[96:99], v[72:75], 0
    ds_read_b64_tr_b16 v[114:115], v132 offset:9216
    s_waitcnt lgkmcnt(9)
    v_mfma_f32_16x16x32_bf16 v[12:15], v[96:99], v[76:79], 0
    ds_read_b128 v[84:87], v131 offset:2048
    s_waitcnt lgkmcnt(8)
    v_mfma_f32_16x16x32_bf16 v[16:19], v[100:103], v[64:67], 0
    ds_read_b128 v[88:91], v131 offset:4096
    v_mfma_f32_16x16x32_bf16 v[20:23], v[100:103], v[68:71], 0
    ds_read_b128 v[92:95], v131 offset:6144
    v_mfma_f32_16x16x32_bf16 v[24:27], v[100:103], v[72:75], 0
    ds_read_b64_tr_b16 v[116:117], v133 offset:8192
    v_mfma_f32_16x16x32_bf16 v[28:31], v[100:103], v[76:79], 0
    ds_read_b64_tr_b16 v[118:119], v133 offset:9216
    s_waitcnt lgkmcnt(10)
    v_mfma_f32_16x16x32_bf16 v[32:35], v[104:107], v[64:67], 0
    ds_read_b64_tr_b16 v[120:121], v134 offset:8192
    v_mfma_f32_16x16x32_bf16 v[36:39], v[104:107], v[68:71], 0
    ds_read_b64_tr_b16 v[122:123], v134 offset:9216
    v_mfma_f32_16x16x32_bf16 v[40:43], v[104:107], v[72:75], 0
    ds_read_b64_tr_b16 v[124:125], v135 offset:8192
    v_mfma_f32_16x16x32_bf16 v[44:47], v[104:107], v[76:79], 0
    ds_read_b64_tr_b16 v[126:127], v135 offset:9216
    s_waitcnt lgkmcnt(12)
    v_mfma_f32_16x16x32_bf16 v[48:51], v[108:111], v[64:67], 0
    v_mfma_f32_16x16x32_bf16 v[52:55], v[108:111], v[68:71], 0
    v_mfma_f32_16x16x32_bf16 v[56:59], v[108:111], v[72:75], 0
    s_waitcnt vmcnt(8) lgkmcnt(0)
    s_cmp_eq_u32 s26, 0
    s_cbranch_scc0 w0_93
    s_waitcnt vmcnt(0)
w0_93:
    s_barrier
    s_setprio 1
    v_mfma_f32_16x16x32_bf16 v[60:63], v[108:111], v[76:79], 0
    v_mfma_f32_16x16x32_bf16 v[0:3], v[112:115], v[80:83], v[0:3]
    s_cmp_eq_u32 s24, 0
    s_cbranch_scc0 sk_94
    v_mov_b32 v165, 1
    s_mov_b64 exec, 1
    buffer_store_dword v165, v164, s[44:47], s21 offen sc1
    s_mov_b64 exec, -1
sk_94:
    ds_read_b128 v[64:67], v128 offset:0
    s_add_u32 m0, s37, 114688
    s_nop 0
    buffer_load_dwordx4 v140, s[12:15], s17 offen offset:0 lds
    v_mfma_f32_16x16x32_bf16 v[4:7], v[112:115], v[84:87], v[4:7]
    ds_read_b64_tr_b16 v[96:97], v132 offset:16384
    v_mfma_f32_16x16x32_bf16 v[8:11], v[112:115], v[88:91], v[8:11]
    ds_read_b64_tr_b16 v[98:99], v132 offset:17408
    buffer_load_dwordx4 v141, s[12:15], s17 offen offset:1024 lds
    s_add_u32 s17, s17, 131072
    v_mfma_f32_16x16x32_bf16 v[12:15], v[112:115], v[92:95], v[12:15]
    ds_read_b128 v[68:71], v128 offset:2048
    v_mfma_f32_16x16x32_bf16 v[16:19], v[116:119], v[80:83], v[16:19]
    s_add_u32 m0, s36, 81920
    s_nop 0
    buffer_load_dwordx4 v136, s[8:11], s16 offen offset:0 sc1 lds
    v_mfma_f32_16x16x32_bf16 v[20:23], v[116:119], v[84:87], v[20:23]
    ds_read_b128 v[72:75], v128 offset:4096
    v_mfma_f32_16x16x32_bf16 v[24:27], v[116:119], v[88:91], v[24:27]
    ds_read_b128 v[76:79], v128 offset:6144
    v_mfma_f32_16x16x32_bf16 v[28:31], v[116:119], v[92:95], v[28:31]
    ds_read_b64_tr_b16 v[100:101], v133 offset:16384
    buffer_load_dwordx4 v137, s[8:11], s16 offen offset:1024 sc1 lds
    v_mfma_f32_16x16x32_bf16 v[32:35], v[120:123], v[80:83], v[32:35]
    ds_read_b64_tr_b16 v[102:103], v133 offset:17408
    v_mfma_f32_16x16x32_bf16 v[36:39], v[120:123], v[84:87], v[36:39]
    buffer_load_dwordx4 v138, s[8:11], s16 offen offset:2048 sc1 lds
    v_mfma_f32_16x16x32_bf16 v[40:43], v[120:123], v[88:91], v[40:43]
    ds_read_b64_tr_b16 v[104:105], v134 offset:16384
    v_mfma_f32_16x16x32_bf16 v[44:47], v[120:123], v[92:95], v[44:47]
    ds_read_b64_tr_b16 v[106:107], v134 offset:17408
    buffer_load_dwordx4 v139, s[8:11], s16 offen offset:3072 sc1 lds
    s_add_u32 s16, s16, 262144
    v_mfma_f32_16x16x32_bf16 v[48:51], v[124:127], v[80:83], v[48:51]
    ds_read_b64_tr_b16 v[108:109], v135 offset:16384
    v_mfma_f32_16x16x32_bf16 v[52:55], v[124:127], v[84:87], v[52:55]
    ds_read_b64_tr_b16 v[110:111], v135 offset:17408
    s_setprio 0
    v_mfma_f32_16x16x32_bf16 v[56:59], v[124:127], v[88:91], v[56:59]
    v_mfma_f32_16x16x32_bf16 v[60:63], v[124:127], v[92:95], v[60:63]
    s_waitcnt lgkmcnt(9)
    v_mfma_f32_16x16x32_bf16 v[0:3], v[96:99], v[64:67], v[0:3]
    ds_read_b128 v[80:83], v129 offset:0
    s_waitcnt lgkmcnt(9)
    v_mfma_f32_16x16x32_bf16 v[4:7], v[96:99], v[68:71], v[4:7]
    ds_read_b64_tr_b16 v[112:113], v132 offset:24576
    s_waitcnt lgkmcnt(9)
    v_mfma_f32_16x16x32_bf16 v[8:11], v[96:99], v[72:75], v[8:11]
    ds_read_b64_tr_b16 v[114:115], v132 offset:25600
    s_waitcnt lgkmcnt(9)
    v_mfma_f32_16x16x32_bf16 v[12:15], v[96:99], v[76:79], v[12:15]
    ds_read_b128 v[84:87], v129 offset:2048
    s_waitcnt lgkmcnt(8)
    v_mfma_f32_16x16x32_bf16 v[16:19], v[100:103], v[64:67], v[16:19]
    ds_read_b128 v[88:91], v129 offset:4096
    v_mfma_f32_16x16x32_bf16 v[20:23], v[100:103], v[68:71], v[20:23]
    ds_read_b128 v[92:95], v129 offset:6144
    v_mfma_f32_16x16x32_bf16 v[24:27], v[100:103], v[72:75], v[24:27]
    ds_read_b64_tr_b16 v[116:117], v133 offset:24576
    v_mfma_f32_16x16x32_bf16 v[28:31], v[100:103], v[76:79], v[28:31]
    ds_read_b64_tr_b16 v[118:119], v133 offset:25600
    s_waitcnt lgkmcnt(10)
    v_mfma_f32_16x16x32_bf16 v[32:35], v[104:107], v[64:67], v[32:35]
    ds_read_b64_tr_b16 v[120:121], v134 offset:24576
    v_mfma_f32_16x16x32_bf16 v[36:39], v[104:107], v[68:71], v[36:39]
    ds_read_b64_tr_b16 v[122:123], v134 offset:25600
    v_mfma_f32_16x16x32_bf16 v[40:43], v[104:107], v[72:75], v[40:43]
    ds_read_b64_tr_b16 v[124:125], v135 offset:24576
    v_mfma_f32_16x16x32_bf16 v[44:47], v[104:107], v[76:79], v[44:47]
    ds_read_b64_tr_b16 v[126:127], v135 offset:25600
    s_waitcnt lgkmcnt(12)
    v_mfma_f32_16x16x32_bf16 v[48:51], v[108:111], v[64:67], v[48:51]
    v_mfma_f32_16x16x32_bf16 v[52:55], v[108:111], v[68:71], v[52:55]
    v_mfma_f32_16x16x32_bf16 v[56:59], v[108:111], v[72:75], v[56:59]
    s_waitcnt vmcnt(6) lgkmcnt(0)
    s_barrier
    s_setprio 1
    v_mfma_f32_16x16x32_bf16 v[60:63], v[108:111], v[76:79], v[60:63]
    v_mfma_f32_16x16x32_bf16 v[0:3], v[112:115], v[80:83], v[0:3]
    ds_read_b128 v[64:67], v128 offset:32768
    s_add_u32 m0, s37, 131072
    s_nop 0
    buffer_load_dwordx4 v140, s[12:15], s17 offen offset:0 lds
    v_mfma_f32_16x16x32_bf16 v[4:7], v[112:115], v[84:87], v[4:7]
    ds_read_b64_tr_b16 v[96:97], v132 offset:32768
    v_mfma_f32_16x16x32_bf16 v[8:11], v[112:115], v[88:91], v[8:11]
    ds_read_b64_tr_b16 v[98:99], v132 offset:33792
    buffer_load_dwordx4 v141, s[12:15], s17 offen offset:1024 lds
    s_add_u32 s17, s17, 131072
    v_mfma_f32_16x16x32_bf16 v[12:15], v[112:115], v[92:95], v[12:15]
    ds_read_b128 v[68:71], v128 offset:34816
    v_mfma_f32_16x16x32_bf16 v[16:19], v[116:119], v[80:83], v[16:19]
    s_add_u32 m0, s36, 0
    s_nop 0
    buffer_load_dwordx4 v136, s[8:11], s16 offen offset:0 sc1 lds
    v_mfma_f32_16x16x32_bf16 v[20:23], v[116:119], v[84:87], v[20:23]
    ds_read_b128 v[72:75], v128 offset:36864
    v_mfma_f32_16x16x32_bf16 v[24:27], v[116:119], v[88:91], v[24:27]
    ds_read_b128 v[76:79], v128 offset:38912
    v_mfma_f32_16x16x32_bf16 v[28:31], v[116:119], v[92:95], v[28:31]
    ds_read_b64_tr_b16 v[100:101], v133 offset:32768
    buffer_load_dwordx4 v137, s[8:11], s16 offen offset:1024 sc1 lds
    v_mfma_f32_16x16x32_bf16 v[32:35], v[120:123], v[80:83], v[32:35]
    ds_read_b64_tr_b16 v[102:103], v133 offset:33792
    v_mfma_f32_16x16x32_bf16 v[36:39], v[120:123], v[84:87], v[36:39]
    buffer_load_dwordx4 v138, s[8:11], s16 offen offset:2048 sc1 lds
    v_mfma_f32_16x16x32_bf16 v[40:43], v[120:123], v[88:91], v[40:43]
    ds_read_b64_tr_b16 v[104:105], v134 offset:32768
    v_mfma_f32_16x16x32_bf16 v[44:47], v[120:123], v[92:95], v[44:47]
    ds_read_b64_tr_b16 v[106:107], v134 offset:33792
    buffer_load_dwordx4 v139, s[8:11], s16 offen offset:3072 sc1 lds
    s_add_u32 s16, s16, 262144
    v_mfma_f32_16x16x32_bf16 v[48:51], v[124:127], v[80:83], v[48:51]
    ds_read_b64_tr_b16 v[108:109], v135 offset:32768
    v_mfma_f32_16x16x32_bf16 v[52:55], v[124:127], v[84:87], v[52:55]
    ds_read_b64_tr_b16 v[110:111], v135 offset:33792
    s_setprio 0
    v_mfma_f32_16x16x32_bf16 v[56:59], v[124:127], v[88:91], v[56:59]
    v_mfma_f32_16x16x32_bf16 v[60:63], v[124:127], v[92:95], v[60:63]
    s_waitcnt lgkmcnt(9)
    v_mfma_f32_16x16x32_bf16 v[0:3], v[96:99], v[64:67], v[0:3]
    ds_read_b128 v[80:83], v129 offset:32768
    s_waitcnt lgkmcnt(9)
    v_mfma_f32_16x16x32_bf16 v[4:7], v[96:99], v[68:71], v[4:7]
    ds_read_b64_tr_b16 v[112:113], v132 offset:40960
    s_waitcnt lgkmcnt(9)
    v_mfma_f32_16x16x32_bf16 v[8:11], v[96:99], v[72:75], v[8:11]
    ds_read_b64_tr_b16 v[114:115], v132 offset:41984
    s_waitcnt lgkmcnt(9)
    v_mfma_f32_16x16x32_bf16 v[12:15], v[96:99], v[76:79], v[12:15]
    ds_read_b128 v[84:87], v129 offset:34816
    s_waitcnt lgkmcnt(8)
    v_mfma_f32_16x16x32_bf16 v[16:19], v[100:103], v[64:67], v[16:19]
    ds_read_b128 v[88:91], v129 offset:36864
    v_mfma_f32_16x16x32_bf16 v[20:23], v[100:103], v[68:71], v[20:23]
    ds_read_b128 v[92:95], v129 offset:38912
    v_mfma_f32_16x16x32_bf16 v[24:27], v[100:103], v[72:75], v[24:27]
    ds_read_b64_tr_b16 v[116:117], v133 offset:40960
    v_mfma_f32_16x16x32_bf16 v[28:31], v[100:103], v[76:79], v[28:31]
    ds_read_b64_tr_b16 v[118:119], v133 offset:41984
    s_waitcnt lgkmcnt(10)
    v_mfma_f32_16x16x32_bf16 v[32:35], v[104:107], v[64:67], v[32:35]
    ds_read_b64_tr_b16 v[120:121], v134 offset:40960
    v_mfma_f32_16x16x32_bf16 v[36:39], v[104:107], v[68:71], v[36:39]
    ds_read_b64_tr_b16 v[122:123], v134 offset:41984
    v_mfma_f32_16x16x32_bf16 v[40:43], v[104:107], v[72:75], v[40:43]
    ds_read_b64_tr_b16 v[124:125], v135 offset:40960
    v_mfma_f32_16x16x32_bf16 v[44:47], v[104:107], v[76:79], v[44:47]
    ds_read_b64_tr_b16 v[126:127], v135 offset:41984
    s_waitcnt lgkmcnt(12)
    v_mfma_f32_16x16x32_bf16 v[48:51], v[108:111], v[64:67], v[48:51]
    v_mfma_f32_16x16x32_bf16 v[52:55], v[108:111], v[68:71], v[52:55]
    v_mfma_f32_16x16x32_bf16 v[56:59], v[108:111], v[72:75], v[56:59]
    s_waitcnt vmcnt(6) lgkmcnt(0)
    s_barrier
    s_setprio 1
    v_mfma_f32_16x16x32_bf16 v[60:63], v[108:111], v[76:79], v[60:63]
    v_mfma_f32_16x16x32_bf16 v[0:3], v[112:115], v[80:83], v[0:3]
    ds_read_b128 v[64:67], v130 offset:0
    s_add_u32 m0, s37, 147456
    s_nop 0
    buffer_load_dwordx4 v140, s[12:15], s17 offen offset:0 lds
    v_mfma_f32_16x16x32_bf16 v[4:7], v[112:115], v[84:87], v[4:7]
    ds_read_b64_tr_b16 v[96:97], v132 offset:0
    v_mfma_f32_16x16x32_bf16 v[8:11], v[112:115], v[88:91], v[8:11]
    ds_read_b64_tr_b16 v[98:99], v132 offset:1024
    buffer_load_dwordx4 v141, s[12:15], s17 offen offset:1024 lds
    s_add_u32 s17, s17, 131072
    v_mfma_f32_16x16x32_bf16 v[12:15], v[112:115], v[92:95], v[12:15]
    ds_read_b128 v[68:71], v130 offset:2048
    v_mfma_f32_16x16x32_bf16 v[16:19], v[116:119], v[80:83], v[16:19]
    s_add_u32 m0, s36, 32768
    s_nop 0
    buffer_load_dwordx4 v136, s[8:11], s16 offen offset:0 sc1 lds
    v_mfma_f32_16x16x32_bf16 v[20:23], v[116:119], v[84:87], v[20:23]
    ds_read_b128 v[72:75], v130 offset:4096
    v_mfma_f32_16x16x32_bf16 v[24:27], v[116:119], v[88:91], v[24:27]
    ds_read_b128 v[76:79], v130 offset:6144
    v_mfma_f32_16x16x32_bf16 v[28:31], v[116:119], v[92:95], v[28:31]
    ds_read_b64_tr_b16 v[100:101], v133 offset:0
    buffer_load_dwordx4 v137, s[8:11], s16 offen offset:1024 sc1 lds
    v_mfma_f32_16x16x32_bf16 v[32:35], v[120:123], v[80:83], v[32:35]
    ds_read_b64_tr_b16 v[102:103], v133 offset:1024
    v_mfma_f32_16x16x32_bf16 v[36:39], v[120:123], v[84:87], v[36:39]
    buffer_load_dwordx4 v138, s[8:11], s16 offen offset:2048 sc1 lds
    v_mfma_f32_16x16x32_bf16 v[40:43], v[120:123], v[88:91], v[40:43]
    ds_read_b64_tr_b16 v[104:105], v134 offset:0
    v_mfma_f32_16x16x32_bf16 v[44:47], v[120:123], v[92:95], v[44:47]
    ds_read_b64_tr_b16 v[106:107], v134 offset:1024
    buffer_load_dwordx4 v139, s[8:11], s16 offen offset:3072 sc1 lds
    s_add_u32 s16, s16, 262144
    v_mfma_f32_16x16x32_bf16 v[48:51], v[124:127], v[80:83], v[48:51]
    ds_read_b64_tr_b16 v[108:109], v135 offset:0
    v_mfma_f32_16x16x32_bf16 v[52:55], v[124:127], v[84:87], v[52:55]
    ds_read_b64_tr_b16 v[110:111], v135 offset:1024
    s_setprio 0
    v_mfma_f32_16x16x32_bf16 v[56:59], v[124:127], v[88:91], v[56:59]
    v_mfma_f32_16x16x32_bf16 v[60:63], v[124:127], v[92:95], v[60:63]
    s_waitcnt lgkmcnt(9)
    v_mfma_f32_16x16x32_bf16 v[0:3], v[96:99], v[64:67], v[0:3]
    ds_read_b128 v[80:83], v131 offset:0
    s_waitcnt lgkmcnt(9)
    v_mfma_f32_16x16x32_bf16 v[4:7], v[96:99], v[68:71], v[4:7]
    ds_read_b64_tr_b16 v[112:113], v132 offset:8192
    s_waitcnt lgkmcnt(9)
    v_mfma_f32_16x16x32_bf16 v[8:11], v[96:99], v[72:75], v[8:11]
    ds_read_b64_tr_b16 v[114:115], v132 offset:9216
    s_waitcnt lgkmcnt(9)
    v_mfma_f32_16x16x32_bf16 v[12:15], v[96:99], v[76:79], v[12:15]
    ds_read_b128 v[84:87], v131 offset:2048
    s_waitcnt lgkmcnt(8)
    v_mfma_f32_16x16x32_bf16 v[16:19], v[100:103], v[64:67], v[16:19]
    ds_read_b128 v[88:91], v131 offset:4096
    v_mfma_f32_16x16x32_bf16 v[20:23], v[100:103], v[68:71], v[20:23]
    ds_read_b128 v[92:95], v131 offset:6144
    v_mfma_f32_16x16x32_bf16 v[24:27], v[100:103], v[72:75], v[24:27]
    ds_read_b64_tr_b16 v[116:117], v133 offset:8192
    v_mfma_f32_16x16x32_bf16 v[28:31], v[100:103], v[76:79], v[28:31]
    ds_read_b64_tr_b16 v[118:119], v133 offset:9216
    s_waitcnt lgkmcnt(10)
    v_mfma_f32_16x16x32_bf16 v[32:35], v[104:107], v[64:67], v[32:35]
    ds_read_b64_tr_b16 v[120:121], v134 offset:8192
    v_mfma_f32_16x16x32_bf16 v[36:39], v[104:107], v[68:71], v[36:39]
    ds_read_b64_tr_b16 v[122:123], v134 offset:9216
    v_mfma_f32_16x16x32_bf16 v[40:43], v[104:107], v[72:75], v[40:43]
    ds_read_b64_tr_b16 v[124:125], v135 offset:8192
    v_mfma_f32_16x16x32_bf16 v[44:47], v[104:107], v[76:79], v[44:47]
    ds_read_b64_tr_b16 v[126:127], v135 offset:9216
    s_waitcnt lgkmcnt(12)
    v_mfma_f32_16x16x32_bf16 v[48:51], v[108:111], v[64:67], v[48:51]
    v_mfma_f32_16x16x32_bf16 v[52:55], v[108:111], v[68:71], v[52:55]
    v_mfma_f32_16x16x32_bf16 v[56:59], v[108:111], v[72:75], v[56:59]
    s_waitcnt vmcnt(6) lgkmcnt(0)
    s_barrier
    s_setprio 1
    v_mfma_f32_16x16x32_bf16 v[60:63], v[108:111], v[76:79], v[60:63]
    v_mfma_f32_16x16x32_bf16 v[0:3], v[112:115], v[80:83], v[0:3]
    ds_read_b128 v[64:67], v128 offset:0
    s_add_u32 m0, s37, 114688
    s_nop 0
    buffer_load_dwordx4 v140, s[12:15], s17 offen offset:0 lds
    v_mfma_f32_16x16x32_bf16 v[4:7], v[112:115], v[84:87], v[4:7]
    ds_read_b64_tr_b16 v[96:97], v132 offset:16384
    v_mfma_f32_16x16x32_bf16 v[8:11], v[112:115], v[88:91], v[8:11]
    ds_read_b64_tr_b16 v[98:99], v132 offset:17408
    buffer_load_dwordx4 v141, s[12:15], s17 offen offset:1024 lds
    s_add_u32 s17, s17, 131072
    v_mfma_f32_16x16x32_bf16 v[12:15], v[112:115], v[92:95], v[12:15]
    ds_read_b128 v[68:71], v128 offset:2048
    v_mfma_f32_16x16x32_bf16 v[16:19], v[116:119], v[80:83], v[16:19]
    s_add_u32 m0, s36, 81920
    s_nop 0
    buffer_load_dwordx4 v136, s[8:11], s16 offen offset:0 sc1 lds
    v_mfma_f32_16x16x32_bf16 v[20:23], v[116:119], v[84:87], v[20:23]
    ds_read_b128 v[72:75], v128 offset:4096
    v_mfma_f32_16x16x32_bf16 v[24:27], v[116:119], v[88:91], v[24:27]
    ds_read_b128 v[76:79], v128 offset:6144
    v_mfma_f32_16x16x32_bf16 v[28:31], v[116:119], v[92:95], v[28:31]
    ds_read_b64_tr_b16 v[100:101], v133 offset:16384
    buffer_load_dwordx4 v137, s[8:11], s16 offen offset:1024 sc1 lds
    v_mfma_f32_16x16x32_bf16 v[32:35], v[120:123], v[80:83], v[32:35]
    ds_read_b64_tr_b16 v[102:103], v133 offset:17408
    v_mfma_f32_16x16x32_bf16 v[36:39], v[120:123], v[84:87], v[36:39]
    buffer_load_dwordx4 v138, s[8:11], s16 offen offset:2048 sc1 lds
    v_mfma_f32_16x16x32_bf16 v[40:43], v[120:123], v[88:91], v[40:43]
    ds_read_b64_tr_b16 v[104:105], v134 offset:16384
    v_mfma_f32_16x16x32_bf16 v[44:47], v[120:123], v[92:95], v[44:47]
    ds_read_b64_tr_b16 v[106:107], v134 offset:17408
    buffer_load_dwordx4 v139, s[8:11], s16 offen offset:3072 sc1 lds
    s_add_u32 s16, s16, 262144
    v_mfma_f32_16x16x32_bf16 v[48:51], v[124:127], v[80:83], v[48:51]
    ds_read_b64_tr_b16 v[108:109], v135 offset:16384
    v_mfma_f32_16x16x32_bf16 v[52:55], v[124:127], v[84:87], v[52:55]
    ds_read_b64_tr_b16 v[110:111], v135 offset:17408
    s_lshl_b32 s23, s18, 8
    s_lshl_b32 s60, s25, 6
    s_add_u32 s23, s23, s60
    s_add_u32 s23, s23, s55
    v_and_b32 v142, 15, v254
    v_add_u32 v142, s23, v142
    v_lshlrev_b32 v142, 11, v142
    s_lshl_b32 s60, s26, 7
    s_add_u32 s60, s60, s63
    v_bfe_u32 v143, v254, 4, 1
    v_lshrrev_b32 v160, 5, v254
    v_lshl_add_u32 v143, v143, 1, v160
    v_lshl_add_u32 v143, v143, 4, s60
    v_add_u32 v142, v143, v142
    s_setprio 0
    v_mfma_f32_16x16x32_bf16 v[56:59], v[124:127], v[88:91], v[56:59]
    v_mfma_f32_16x16x32_bf16 v[60:63], v[124:127], v[92:95], v[60:63]
    s_waitcnt lgkmcnt(9)
    v_mfma_f32_16x16x32_bf16 v[0:3], v[96:99], v[64:67], v[0:3]
    ds_read_b128 v[80:83], v129 offset:0
    s_waitcnt lgkmcnt(9)
    v_mfma_f32_16x16x32_bf16 v[4:7], v[96:99], v[68:71], v[4:7]
    ds_read_b64_tr_b16 v[112:113], v132 offset:24576
    s_waitcnt lgkmcnt(9)
    v_mfma_f32_16x16x32_bf16 v[8:11], v[96:99], v[72:75], v[8:11]
    ds_read_b64_tr_b16 v[114:115], v132 offset:25600
    s_waitcnt lgkmcnt(9)
    v_mfma_f32_16x16x32_bf16 v[12:15], v[96:99], v[76:79], v[12:15]
    ds_read_b128 v[84:87], v129 offset:2048
    s_waitcnt lgkmcnt(8)
    v_mfma_f32_16x16x32_bf16 v[16:19], v[100:103], v[64:67], v[16:19]
    ds_read_b128 v[88:91], v129 offset:4096
    v_mfma_f32_16x16x32_bf16 v[20:23], v[100:103], v[68:71], v[20:23]
    ds_read_b128 v[92:95], v129 offset:6144
    v_mfma_f32_16x16x32_bf16 v[24:27], v[100:103], v[72:75], v[24:27]
    ds_read_b64_tr_b16 v[116:117], v133 offset:24576
    v_mfma_f32_16x16x32_bf16 v[28:31], v[100:103], v[76:79], v[28:31]
    ds_read_b64_tr_b16 v[118:119], v133 offset:25600
    s_waitcnt lgkmcnt(10)
    v_mfma_f32_16x16x32_bf16 v[32:35], v[104:107], v[64:67], v[32:35]
    ds_read_b64_tr_b16 v[120:121], v134 offset:24576
    v_mfma_f32_16x16x32_bf16 v[36:39], v[104:107], v[68:71], v[36:39]
    ds_read_b64_tr_b16 v[122:123], v134 offset:25600
    v_mfma_f32_16x16x32_bf16 v[40:43], v[104:107], v[72:75], v[40:43]
    ds_read_b64_tr_b16 v[124:125], v135 offset:24576
    v_mfma_f32_16x16x32_bf16 v[44:47], v[104:107], v[76:79], v[44:47]
    ds_read_b64_tr_b16 v[126:127], v135 offset:25600
    s_waitcnt lgkmcnt(12)
    v_mfma_f32_16x16x32_bf16 v[48:51], v[108:111], v[64:67], v[48:51]
    v_mfma_f32_16x16x32_bf16 v[52:55], v[108:111], v[68:71], v[52:55]
    v_mfma_f32_16x16x32_bf16 v[56:59], v[108:111], v[72:75], v[56:59]
    s_waitcnt vmcnt(6) lgkmcnt(0)
    s_barrier
    s_setprio 1
    v_mfma_f32_16x16x32_bf16 v[60:63], v[108:111], v[76:79], v[60:63]
    v_mfma_f32_16x16x32_bf16 v[0:3], v[112:115], v[80:83], v[0:3]
    ds_read_b128 v[64:67], v128 offset:32768
    s_add_u32 m0, s37, 131072
    s_nop 0
    buffer_load_dwordx4 v140, s[12:15], s17 offen offset:0 lds
    v_mfma_f32_16x16x32_bf16 v[4:7], v[112:115], v[84:87], v[4:7]
    ds_read_b64_tr_b16 v[96:97], v132 offset:32768
    v_mfma_f32_16x16x32_bf16 v[8:11], v[112:115], v[88:91], v[8:11]
    ds_read_b64_tr_b16 v[98:99], v132 offset:33792
    buffer_load_dwordx4 v141, s[12:15], s17 offen offset:1024 lds
    s_add_u32 s17, s17, 131072
    v_mfma_f32_16x16x32_bf16 v[12:15], v[112:115], v[92:95], v[12:15]
    ds_read_b128 v[68:71], v128 offset:34816
    v_mfma_f32_16x16x32_bf16 v[16:19], v[116:119], v[80:83], v[16:19]
    s_add_u32 m0, s36, 0
    s_nop 0
    buffer_load_dwordx4 v136, s[8:11], s16 offen offset:0 sc1 lds
    v_mfma_f32_16x16x32_bf16 v[20:23], v[116:119], v[84:87], v[20:23]
    ds_read_b128 v[72:75], v128 offset:36864
    v_mfma_f32_16x16x32_bf16 v[24:27], v[116:119], v[88:91], v[24:27]
    ds_read_b128 v[76:79], v128 offset:38912
    v_mfma_f32_16x16x32_bf16 v[28:31], v[116:119], v[92:95], v[28:31]
    ds_read_b64_tr_b16 v[100:101], v133 offset:32768
    buffer_load_dwordx4 v137, s[8:11], s16 offen offset:1024 sc1 lds
    v_mfma_f32_16x16x32_bf16 v[32:35], v[120:123], v[80:83], v[32:35]
    ds_read_b64_tr_b16 v[102:103], v133 offset:33792
    v_mfma_f32_16x16x32_bf16 v[36:39], v[120:123], v[84:87], v[36:39]
    buffer_load_dwordx4 v138, s[8:11], s16 offen offset:2048 sc1 lds
    v_mfma_f32_16x16x32_bf16 v[40:43], v[120:123], v[88:91], v[40:43]
    ds_read_b64_tr_b16 v[104:105], v134 offset:32768
    v_mfma_f32_16x16x32_bf16 v[44:47], v[120:123], v[92:95], v[44:47]
    ds_read_b64_tr_b16 v[106:107], v134 offset:33792
    buffer_load_dwordx4 v139, s[8:11], s16 offen offset:3072 sc1 lds
    s_add_u32 s16, s16, 262144
    v_mfma_f32_16x16x32_bf16 v[48:51], v[124:127], v[80:83], v[48:51]
    ds_read_b64_tr_b16 v[108:109], v135 offset:32768
    v_mfma_f32_16x16x32_bf16 v[52:55], v[124:127], v[84:87], v[52:55]
    ds_read_b64_tr_b16 v[110:111], v135 offset:33792
    s_setprio 0
    v_mfma_f32_16x16x32_bf16 v[56:59], v[124:127], v[88:91], v[56:59]
    v_mfma_f32_16x16x32_bf16 v[60:63], v[124:127], v[92:95], v[60:63]
    s_waitcnt lgkmcnt(9)
    v_mfma_f32_16x16x32_bf16 v[0:3], v[96:99], v[64:67], v[0:3]
    ds_read_b128 v[80:83], v129 offset:32768
    s_waitcnt lgkmcnt(9)
    v_mfma_f32_16x16x32_bf16 v[4:7], v[96:99], v[68:71], v[4:7]
    ds_read_b64_tr_b16 v[112:113], v132 offset:40960
    s_waitcnt lgkmcnt(9)
    v_mfma_f32_16x16x32_bf16 v[8:11], v[96:99], v[72:75], v[8:11]
    ds_read_b64_tr_b16 v[114:115], v132 offset:41984
    s_waitcnt lgkmcnt(9)
    v_mfma_f32_16x16x32_bf16 v[12:15], v[96:99], v[76:79], v[12:15]
    ds_read_b128 v[84:87], v129 offset:34816
    s_waitcnt lgkmcnt(8)
    v_mfma_f32_16x16x32_bf16 v[16:19], v[100:103], v[64:67], v[16:19]
    ds_read_b128 v[88:91], v129 offset:36864
    v_mfma_f32_16x16x32_bf16 v[20:23], v[100:103], v[68:71], v[20:23]
    ds_read_b128 v[92:95], v129 offset:38912
    v_mfma_f32_16x16x32_bf16 v[24:27], v[100:103], v[72:75], v[24:27]
    ds_read_b64_tr_b16 v[116:117], v133 offset:40960
    v_mfma_f32_16x16x32_bf16 v[28:31], v[100:103], v[76:79], v[28:31]
    ds_read_b64_tr_b16 v[118:119], v133 offset:41984
    s_waitcnt lgkmcnt(10)
    v_mfma_f32_16x16x32_bf16 v[32:35], v[104:107], v[64:67], v[32:35]
    ds_read_b64_tr_b16 v[120:121], v134 offset:40960
    v_mfma_f32_16x16x32_bf16 v[36:39], v[104:107], v[68:71], v[36:39]
    ds_read_b64_tr_b16 v[122:123], v134 offset:41984
    v_mfma_f32_16x16x32_bf16 v[40:43], v[104:107], v[72:75], v[40:43]
    ds_read_b64_tr_b16 v[124:125], v135 offset:40960
    v_mfma_f32_16x16x32_bf16 v[44:47], v[104:107], v[76:79], v[44:47]
    ds_read_b64_tr_b16 v[126:127], v135 offset:41984
    s_waitcnt lgkmcnt(12)
    v_mfma_f32_16x16x32_bf16 v[48:51], v[108:111], v[64:67], v[48:51]
    v_mfma_f32_16x16x32_bf16 v[52:55], v[108:111], v[68:71], v[52:55]
    v_mfma_f32_16x16x32_bf16 v[56:59], v[108:111], v[72:75], v[56:59]
    s_waitcnt vmcnt(6) lgkmcnt(0)
    s_barrier
    s_setprio 1
    v_mfma_f32_16x16x32_bf16 v[60:63], v[108:111], v[76:79], v[60:63]
    v_mfma_f32_16x16x32_bf16 v[0:3], v[112:115], v[80:83], v[0:3]
    ds_read_b128 v[64:67], v130 offset:0
    s_add_u32 m0, s37, 147456
    s_nop 0
    buffer_load_dwordx4 v140, s[12:15], s17 offen offset:0 lds
    v_mfma_f32_16x16x32_bf16 v[4:7], v[112:115], v[84:87], v[4:7]
    ds_read_b64_tr_b16 v[96:97], v132 offset:0
    v_mfma_f32_16x16x32_bf16 v[8:11], v[112:115], v[88:91], v[8:11]
    ds_read_b64_tr_b16 v[98:99], v132 offset:1024
    buffer_load_dwordx4 v141, s[12:15], s17 offen offset:1024 lds
    s_add_u32 s17, s17, 131072
    v_mfma_f32_16x16x32_bf16 v[12:15], v[112:115], v[92:95], v[12:15]
    ds_read_b128 v[68:71], v130 offset:2048
    v_mfma_f32_16x16x32_bf16 v[16:19], v[116:119], v[80:83], v[16:19]
    s_add_u32 m0, s36, 32768
    s_nop 0
    buffer_load_dwordx4 v136, s[8:11], s16 offen offset:0 sc1 lds
    v_mfma_f32_16x16x32_bf16 v[20:23], v[116:119], v[84:87], v[20:23]
    ds_read_b128 v[72:75], v130 offset:4096
    v_mfma_f32_16x16x32_bf16 v[24:27], v[116:119], v[88:91], v[24:27]
    ds_read_b128 v[76:79], v130 offset:6144
    v_mfma_f32_16x16x32_bf16 v[28:31], v[116:119], v[92:95], v[28:31]
    ds_read_b64_tr_b16 v[100:101], v133 offset:0
    buffer_load_dwordx4 v137, s[8:11], s16 offen offset:1024 sc1 lds
    v_mfma_f32_16x16x32_bf16 v[32:35], v[120:123], v[80:83], v[32:35]
    ds_read_b64_tr_b16 v[102:103], v133 offset:1024
    v_mfma_f32_16x16x32_bf16 v[36:39], v[120:123], v[84:87], v[36:39]
    buffer_load_dwordx4 v138, s[8:11], s16 offen offset:2048 sc1 lds
    v_mfma_f32_16x16x32_bf16 v[40:43], v[120:123], v[88:91], v[40:43]
    ds_read_b64_tr_b16 v[104:105], v134 offset:0
    v_mfma_f32_16x16x32_bf16 v[44:47], v[120:123], v[92:95], v[44:47]
    ds_read_b64_tr_b16 v[106:107], v134 offset:1024
    buffer_load_dwordx4 v139, s[8:11], s16 offen offset:3072 sc1 lds
    s_add_u32 s16, s16, 262144
    v_mfma_f32_16x16x32_bf16 v[48:51], v[124:127], v[80:83], v[48:51]
    ds_read_b64_tr_b16 v[108:109], v135 offset:0
    v_mfma_f32_16x16x32_bf16 v[52:55], v[124:127], v[84:87], v[52:55]
    ds_read_b64_tr_b16 v[110:111], v135 offset:1024
    s_setprio 0
    v_mfma_f32_16x16x32_bf16 v[56:59], v[124:127], v[88:91], v[56:59]
    v_mfma_f32_16x16x32_bf16 v[60:63], v[124:127], v[92:95], v[60:63]
    s_waitcnt lgkmcnt(9)
    v_mfma_f32_16x16x32_bf16 v[0:3], v[96:99], v[64:67], v[0:3]
    ds_read_b128 v[80:83], v131 offset:0
    s_waitcnt lgkmcnt(9)
    v_mfma_f32_16x16x32_bf16 v[4:7], v[96:99], v[68:71], v[4:7]
    ds_read_b64_tr_b16 v[112:113], v132 offset:8192
    s_waitcnt lgkmcnt(9)
    v_mfma_f32_16x16x32_bf16 v[8:11], v[96:99], v[72:75], v[8:11]
    ds_read_b64_tr_b16 v[114:115], v132 offset:9216
    s_waitcnt lgkmcnt(9)
    v_mfma_f32_16x16x32_bf16 v[12:15], v[96:99], v[76:79], v[12:15]
    ds_read_b128 v[84:87], v131 offset:2048
    s_waitcnt lgkmcnt(8)
    v_mfma_f32_16x16x32_bf16 v[16:19], v[100:103], v[64:67], v[16:19]
    ds_read_b128 v[88:91], v131 offset:4096
    v_mfma_f32_16x16x32_bf16 v[20:23], v[100:103], v[68:71], v[20:23]
    ds_read_b128 v[92:95], v131 offset:6144
    v_mfma_f32_16x16x32_bf16 v[24:27], v[100:103], v[72:75], v[24:27]
    ds_read_b64_tr_b16 v[116:117], v133 offset:8192
    v_mfma_f32_16x16x32_bf16 v[28:31], v[100:103], v[76:79], v[28:31]
    ds_read_b64_tr_b16 v[118:119], v133 offset:9216
    s_waitcnt lgkmcnt(10)
    v_mfma_f32_16x16x32_bf16 v[32:35], v[104:107], v[64:67], v[32:35]
    ds_read_b64_tr_b16 v[120:121], v134 offset:8192
    v_mfma_f32_16x16x32_bf16 v[36:39], v[104:107], v[68:71], v[36:39]
    ds_read_b64_tr_b16 v[122:123], v134 offset:9216
    v_mfma_f32_16x16x32_bf16 v[40:43], v[104:107], v[72:75], v[40:43]
    ds_read_b64_tr_b16 v[124:125], v135 offset:8192
    v_mfma_f32_16x16x32_bf16 v[44:47], v[104:107], v[76:79], v[44:47]
    ds_read_b64_tr_b16 v[126:127], v135 offset:9216
    s_waitcnt lgkmcnt(12)
    v_mfma_f32_16x16x32_bf16 v[48:51], v[108:111], v[64:67], v[48:51]
    v_mfma_f32_16x16x32_bf16 v[52:55], v[108:111], v[68:71], v[52:55]
    v_mfma_f32_16x16x32_bf16 v[56:59], v[108:111], v[72:75], v[56:59]
    s_waitcnt vmcnt(6) lgkmcnt(0)
    s_barrier
    s_setprio 1
    v_mfma_f32_16x16x32_bf16 v[60:63], v[108:111], v[76:79], v[60:63]
    v_mfma_f32_16x16x32_bf16 v[0:3], v[112:115], v[80:83], v[0:3]
    ds_read_b128 v[64:67], v128 offset:0
    s_add_u32 m0, s37, 114688
    s_nop 0
    buffer_load_dwordx4 v140, s[12:15], s17 offen offset:0 lds
    v_mfma_f32_16x16x32_bf16 v[4:7], v[112:115], v[84:87], v[4:7]
    ds_read_b64_tr_b16 v[96:97], v132 offset:16384
    v_mfma_f32_16x16x32_bf16 v[8:11], v[112:115], v[88:91], v[8:11]
    ds_read_b64_tr_b16 v[98:99], v132 offset:17408
    buffer_load_dwordx4 v141, s[12:15], s17 offen offset:1024 lds
    s_add_u32 s17, s17, 131072
    v_mfma_f32_16x16x32_bf16 v[12:15], v[112:115], v[92:95], v[12:15]
    ds_read_b128 v[68:71], v128 offset:2048
    v_mfma_f32_16x16x32_bf16 v[16:19], v[116:119], v[80:83], v[16:19]
    s_add_u32 m0, s36, 81920
    s_nop 0
    buffer_load_dwordx4 v136, s[8:11], s16 offen offset:0 sc1 lds
    v_mfma_f32_16x16x32_bf16 v[20:23], v[116:119], v[84:87], v[20:23]
    ds_read_b128 v[72:75], v128 offset:4096
    v_mfma_f32_16x16x32_bf16 v[24:27], v[116:119], v[88:91], v[24:27]
    ds_read_b128 v[76:79], v128 offset:6144
    v_mfma_f32_16x16x32_bf16 v[28:31], v[116:119], v[92:95], v[28:31]
    ds_read_b64_tr_b16 v[100:101], v133 offset:16384
    buffer_load_dwordx4 v137, s[8:11], s16 offen offset:1024 sc1 lds
    v_mfma_f32_16x16x32_bf16 v[32:35], v[120:123], v[80:83], v[32:35]
    ds_read_b64_tr_b16 v[102:103], v133 offset:17408
    v_mfma_f32_16x16x32_bf16 v[36:39], v[120:123], v[84:87], v[36:39]
    buffer_load_dwordx4 v138, s[8:11], s16 offen offset:2048 sc1 lds
    v_mfma_f32_16x16x32_bf16 v[40:43], v[120:123], v[88:91], v[40:43]
    ds_read_b64_tr_b16 v[104:105], v134 offset:16384
    v_mfma_f32_16x16x32_bf16 v[44:47], v[120:123], v[92:95], v[44:47]
    ds_read_b64_tr_b16 v[106:107], v134 offset:17408
    buffer_load_dwordx4 v139, s[8:11], s16 offen offset:3072 sc1 lds
    s_add_u32 s16, s16, 262144
    v_mfma_f32_16x16x32_bf16 v[48:51], v[124:127], v[80:83], v[48:51]
    ds_read_b64_tr_b16 v[108:109], v135 offset:16384
    v_mfma_f32_16x16x32_bf16 v[52:55], v[124:127], v[84:87], v[52:55]
    ds_read_b64_tr_b16 v[110:111], v135 offset:17408
    s_setprio 0
    v_mfma_f32_16x16x32_bf16 v[56:59], v[124:127], v[88:91], v[56:59]
    v_mfma_f32_16x16x32_bf16 v[60:63], v[124:127], v[92:95], v[60:63]
    s_waitcnt lgkmcnt(9)
    v_mfma_f32_16x16x32_bf16 v[0:3], v[96:99], v[64:67], v[0:3]
    ds_read_b128 v[80:83], v129 offset:0
    s_waitcnt lgkmcnt(9)
    v_mfma_f32_16x16x32_bf16 v[4:7], v[96:99], v[68:71], v[4:7]
    ds_read_b64_tr_b16 v[112:113], v132 offset:24576
    s_waitcnt lgkmcnt(9)
    v_mfma_f32_16x16x32_bf16 v[8:11], v[96:99], v[72:75], v[8:11]
    ds_read_b64_tr_b16 v[114:115], v132 offset:25600
    s_waitcnt lgkmcnt(9)
    v_mfma_f32_16x16x32_bf16 v[12:15], v[96:99], v[76:79], v[12:15]
    ds_read_b128 v[84:87], v129 offset:2048
    s_waitcnt lgkmcnt(8)
    v_mfma_f32_16x16x32_bf16 v[16:19], v[100:103], v[64:67], v[16:19]
    ds_read_b128 v[88:91], v129 offset:4096
    v_mfma_f32_16x16x32_bf16 v[20:23], v[100:103], v[68:71], v[20:23]
    ds_read_b128 v[92:95], v129 offset:6144
    v_mfma_f32_16x16x32_bf16 v[24:27], v[100:103], v[72:75], v[24:27]
    ds_read_b64_tr_b16 v[116:117], v133 offset:24576
    v_mfma_f32_16x16x32_bf16 v[28:31], v[100:103], v[76:79], v[28:31]
    ds_read_b64_tr_b16 v[118:119], v133 offset:25600
    s_waitcnt lgkmcnt(10)
    v_mfma_f32_16x16x32_bf16 v[32:35], v[104:107], v[64:67], v[32:35]
    ds_read_b64_tr_b16 v[120:121], v134 offset:24576
    v_mfma_f32_16x16x32_bf16 v[36:39], v[104:107], v[68:71], v[36:39]
    ds_read_b64_tr_b16 v[122:123], v134 offset:25600
    v_mfma_f32_16x16x32_bf16 v[40:43], v[104:107], v[72:75], v[40:43]
    ds_read_b64_tr_b16 v[124:125], v135 offset:24576
    v_mfma_f32_16x16x32_bf16 v[44:47], v[104:107], v[76:79], v[44:47]
    ds_read_b64_tr_b16 v[126:127], v135 offset:25600
    s_waitcnt lgkmcnt(12)
    v_mfma_f32_16x16x32_bf16 v[48:51], v[108:111], v[64:67], v[48:51]
    v_mfma_f32_16x16x32_bf16 v[52:55], v[108:111], v[68:71], v[52:55]
    v_mfma_f32_16x16x32_bf16 v[56:59], v[108:111], v[72:75], v[56:59]
    s_waitcnt vmcnt(6) lgkmcnt(0)
    s_barrier
    s_setprio 1
    v_mfma_f32_16x16x32_bf16 v[60:63], v[108:111], v[76:79], v[60:63]
    v_mfma_f32_16x16x32_bf16 v[0:3], v[112:115], v[80:83], v[0:3]
    ds_read_b128 v[64:67], v128 offset:32768
    s_add_u32 m0, s37, 131072
    s_nop 0
    buffer_load_dwordx4 v140, s[12:15], s17 offen offset:0 lds
    v_mfma_f32_16x16x32_bf16 v[4:7], v[112:115], v[84:87], v[4:7]
    ds_read_b64_tr_b16 v[96:97], v132 offset:32768
    v_mfma_f32_16x16x32_bf16 v[8:11], v[112:115], v[88:91], v[8:11]
    ds_read_b64_tr_b16 v[98:99], v132 offset:33792
    buffer_load_dwordx4 v141, s[12:15], s17 offen offset:1024 lds
    s_add_u32 s17, s17, 131072
    v_mfma_f32_16x16x32_bf16 v[12:15], v[112:115], v[92:95], v[12:15]
    ds_read_b128 v[68:71], v128 offset:34816
    v_mfma_f32_16x16x32_bf16 v[16:19], v[116:119], v[80:83], v[16:19]
    s_add_u32 m0, s36, 0
    s_nop 0
    buffer_load_dwordx4 v136, s[8:11], s16 offen offset:0 sc1 lds
    v_mfma_f32_16x16x32_bf16 v[20:23], v[116:119], v[84:87], v[20:23]
    ds_read_b128 v[72:75], v128 offset:36864
    v_mfma_f32_16x16x32_bf16 v[24:27], v[116:119], v[88:91], v[24:27]
    ds_read_b128 v[76:79], v128 offset:38912
    v_mfma_f32_16x16x32_bf16 v[28:31], v[116:119], v[92:95], v[28:31]
    ds_read_b64_tr_b16 v[100:101], v133 offset:32768
    buffer_load_dwordx4 v137, s[8:11], s16 offen offset:1024 sc1 lds
    v_mfma_f32_16x16x32_bf16 v[32:35], v[120:123], v[80:83], v[32:35]
    ds_read_b64_tr_b16 v[102:103], v133 offset:33792
    v_mfma_f32_16x16x32_bf16 v[36:39], v[120:123], v[84:87], v[36:39]
    buffer_load_dwordx4 v138, s[8:11], s16 offen offset:2048 sc1 lds
    v_mfma_f32_16x16x32_bf16 v[40:43], v[120:123], v[88:91], v[40:43]
    ds_read_b64_tr_b16 v[104:105], v134 offset:32768
    v_mfma_f32_16x16x32_bf16 v[44:47], v[120:123], v[92:95], v[44:47]
    ds_read_b64_tr_b16 v[106:107], v134 offset:33792
    buffer_load_dwordx4 v139, s[8:11], s16 offen offset:3072 sc1 lds
    s_add_u32 s16, s16, 262144
    v_mfma_f32_16x16x32_bf16 v[48:51], v[124:127], v[80:83], v[48:51]
    ds_read_b64_tr_b16 v[108:109], v135 offset:32768
    v_mfma_f32_16x16x32_bf16 v[52:55], v[124:127], v[84:87], v[52:55]
    ds_read_b64_tr_b16 v[110:111], v135 offset:33792
    s_setprio 0
    v_mfma_f32_16x16x32_bf16 v[56:59], v[124:127], v[88:91], v[56:59]
    v_mfma_f32_16x16x32_bf16 v[60:63], v[124:127], v[92:95], v[60:63]
    s_waitcnt lgkmcnt(9)
    v_mfma_f32_16x16x32_bf16 v[0:3], v[96:99], v[64:67], v[0:3]
    ds_read_b128 v[80:83], v129 offset:32768
    s_waitcnt lgkmcnt(9)
    v_mfma_f32_16x16x32_bf16 v[4:7], v[96:99], v[68:71], v[4:7]
    ds_read_b64_tr_b16 v[112:113], v132 offset:40960
    s_waitcnt lgkmcnt(9)
    v_mfma_f32_16x16x32_bf16 v[8:11], v[96:99], v[72:75], v[8:11]
    ds_read_b64_tr_b16 v[114:115], v132 offset:41984
    s_waitcnt lgkmcnt(9)
    v_mfma_f32_16x16x32_bf16 v[12:15], v[96:99], v[76:79], v[12:15]
    ds_read_b128 v[84:87], v129 offset:34816
    s_waitcnt lgkmcnt(8)
    v_mfma_f32_16x16x32_bf16 v[16:19], v[100:103], v[64:67], v[16:19]
    ds_read_b128 v[88:91], v129 offset:36864
    v_mfma_f32_16x16x32_bf16 v[20:23], v[100:103], v[68:71], v[20:23]
    ds_read_b128 v[92:95], v129 offset:38912
    v_mfma_f32_16x16x32_bf16 v[24:27], v[100:103], v[72:75], v[24:27]
    ds_read_b64_tr_b16 v[116:117], v133 offset:40960
    v_mfma_f32_16x16x32_bf16 v[28:31], v[100:103], v[76:79], v[28:31]
    ds_read_b64_tr_b16 v[118:119], v133 offset:41984
    s_waitcnt lgkmcnt(10)
    v_mfma_f32_16x16x32_bf16 v[32:35], v[104:107], v[64:67], v[32:35]
    ds_read_b64_tr_b16 v[120:121], v134 offset:40960
    v_mfma_f32_16x16x32_bf16 v[36:39], v[104:107], v[68:71], v[36:39]
    ds_read_b64_tr_b16 v[122:123], v134 offset:41984
    v_mfma_f32_16x16x32_bf16 v[40:43], v[104:107], v[72:75], v[40:43]
    ds_read_b64_tr_b16 v[124:125], v135 offset:40960
    v_mfma_f32_16x16x32_bf16 v[44:47], v[104:107], v[76:79], v[44:47]
    ds_read_b64_tr_b16 v[126:127], v135 offset:41984
    s_waitcnt lgkmcnt(12)
    v_mfma_f32_16x16x32_bf16 v[48:51], v[108:111], v[64:67], v[48:51]
    v_mfma_f32_16x16x32_bf16 v[52:55], v[108:111], v[68:71], v[52:55]
    v_mfma_f32_16x16x32_bf16 v[56:59], v[108:111], v[72:75], v[56:59]
    s_waitcnt vmcnt(6) lgkmcnt(0)
    s_barrier
    s_setprio 1
    v_mfma_f32_16x16x32_bf16 v[60:63], v[108:111], v[76:79], v[60:63]
    v_mfma_f32_16x16x32_bf16 v[0:3], v[112:115], v[80:83], v[0:3]
    ds_read_b128 v[64:67], v130 offset:0
    s_add_u32 m0, s37, 147456
    s_nop 0
    buffer_load_dwordx4 v140, s[12:15], s17 offen offset:0 lds
    v_mfma_f32_16x16x32_bf16 v[4:7], v[112:115], v[84:87], v[4:7]
    ds_read_b64_tr_b16 v[96:97], v132 offset:0
    v_mfma_f32_16x16x32_bf16 v[8:11], v[112:115], v[88:91], v[8:11]
    ds_read_b64_tr_b16 v[98:99], v132 offset:1024
    buffer_load_dwordx4 v141, s[12:15], s17 offen offset:1024 lds
    s_add_u32 s17, s17, 131072
    v_mfma_f32_16x16x32_bf16 v[12:15], v[112:115], v[92:95], v[12:15]
    ds_read_b128 v[68:71], v130 offset:2048
    v_mfma_f32_16x16x32_bf16 v[16:19], v[116:119], v[80:83], v[16:19]
    s_add_u32 m0, s36, 32768
    s_nop 0
    buffer_load_dwordx4 v136, s[8:11], s16 offen offset:0 sc1 lds
    v_mfma_f32_16x16x32_bf16 v[20:23], v[116:119], v[84:87], v[20:23]
    ds_read_b128 v[72:75], v130 offset:4096
    v_mfma_f32_16x16x32_bf16 v[24:27], v[116:119], v[88:91], v[24:27]
    ds_read_b128 v[76:79], v130 offset:6144
    v_mfma_f32_16x16x32_bf16 v[28:31], v[116:119], v[92:95], v[28:31]
    ds_read_b64_tr_b16 v[100:101], v133 offset:0
    buffer_load_dwordx4 v137, s[8:11], s16 offen offset:1024 sc1 lds
    v_mfma_f32_16x16x32_bf16 v[32:35], v[120:123], v[80:83], v[32:35]
    ds_read_b64_tr_b16 v[102:103], v133 offset:1024
    v_mfma_f32_16x16x32_bf16 v[36:39], v[120:123], v[84:87], v[36:39]
    buffer_load_dwordx4 v138, s[8:11], s16 offen offset:2048 sc1 lds
    v_mfma_f32_16x16x32_bf16 v[40:43], v[120:123], v[88:91], v[40:43]
    ds_read_b64_tr_b16 v[104:105], v134 offset:0
    v_mfma_f32_16x16x32_bf16 v[44:47], v[120:123], v[92:95], v[44:47]
    ds_read_b64_tr_b16 v[106:107], v134 offset:1024
    buffer_load_dwordx4 v139, s[8:11], s16 offen offset:3072 sc1 lds
    s_add_u32 s16, s16, 262144
    v_mfma_f32_16x16x32_bf16 v[48:51], v[124:127], v[80:83], v[48:51]
    ds_read_b64_tr_b16 v[108:109], v135 offset:0
    v_mfma_f32_16x16x32_bf16 v[52:55], v[124:127], v[84:87], v[52:55]
    ds_read_b64_tr_b16 v[110:111], v135 offset:1024
    s_setprio 0
    v_mfma_f32_16x16x32_bf16 v[56:59], v[124:127], v[88:91], v[56:59]
    v_mfma_f32_16x16x32_bf16 v[60:63], v[124:127], v[92:95], v[60:63]
    s_waitcnt lgkmcnt(9)
    v_mfma_f32_16x16x32_bf16 v[0:3], v[96:99], v[64:67], v[0:3]
    ds_read_b128 v[80:83], v131 offset:0
    s_waitcnt lgkmcnt(9)
    v_mfma_f32_16x16x32_bf16 v[4:7], v[96:99], v[68:71], v[4:7]
    ds_read_b64_tr_b16 v[112:113], v132 offset:8192
    s_waitcnt lgkmcnt(9)
    v_mfma_f32_16x16x32_bf16 v[8:11], v[96:99], v[72:75], v[8:11]
    ds_read_b64_tr_b16 v[114:115], v132 offset:9216
    s_waitcnt lgkmcnt(9)
    v_mfma_f32_16x16x32_bf16 v[12:15], v[96:99], v[76:79], v[12:15]
    ds_read_b128 v[84:87], v131 offset:2048
    s_waitcnt lgkmcnt(8)
    v_mfma_f32_16x16x32_bf16 v[16:19], v[100:103], v[64:67], v[16:19]
    ds_read_b128 v[88:91], v131 offset:4096
    v_mfma_f32_16x16x32_bf16 v[20:23], v[100:103], v[68:71], v[20:23]
    ds_read_b128 v[92:95], v131 offset:6144
    v_mfma_f32_16x16x32_bf16 v[24:27], v[100:103], v[72:75], v[24:27]
    ds_read_b64_tr_b16 v[116:117], v133 offset:8192
    v_mfma_f32_16x16x32_bf16 v[28:31], v[100:103], v[76:79], v[28:31]
    ds_read_b64_tr_b16 v[118:119], v133 offset:9216
    s_waitcnt lgkmcnt(10)
    v_mfma_f32_16x16x32_bf16 v[32:35], v[104:107], v[64:67], v[32:35]
    ds_read_b64_tr_b16 v[120:121], v134 offset:8192
    v_mfma_f32_16x16x32_bf16 v[36:39], v[104:107], v[68:71], v[36:39]
    ds_read_b64_tr_b16 v[122:123], v134 offset:9216
    v_mfma_f32_16x16x32_bf16 v[40:43], v[104:107], v[72:75], v[40:43]
    ds_read_b64_tr_b16 v[124:125], v135 offset:8192
    v_mfma_f32_16x16x32_bf16 v[44:47], v[104:107], v[76:79], v[44:47]
    ds_read_b64_tr_b16 v[126:127], v135 offset:9216
    s_waitcnt lgkmcnt(12)
    v_mfma_f32_16x16x32_bf16 v[48:51], v[108:111], v[64:67], v[48:51]
    v_mfma_f32_16x16x32_bf16 v[52:55], v[108:111], v[68:71], v[52:55]
    v_mfma_f32_16x16x32_bf16 v[56:59], v[108:111], v[72:75], v[56:59]
    s_waitcnt vmcnt(6) lgkmcnt(0)
    s_barrier
    s_setprio 1
    v_mfma_f32_16x16x32_bf16 v[60:63], v[108:111], v[76:79], v[60:63]
    v_mfma_f32_16x16x32_bf16 v[0:3], v[112:115], v[80:83], v[0:3]
    ds_read_b128 v[64:67], v128 offset:0
    s_add_u32 m0, s37, 114688
    s_nop 0
    buffer_load_dwordx4 v140, s[12:15], s17 offen offset:0 lds
    v_mfma_f32_16x16x32_bf16 v[4:7], v[112:115], v[84:87], v[4:7]
    ds_read_b64_tr_b16 v[96:97], v132 offset:16384
    v_mfma_f32_16x16x32_bf16 v[8:11], v[112:115], v[88:91], v[8:11]
    ds_read_b64_tr_b16 v[98:99], v132 offset:17408
    buffer_load_dwordx4 v141, s[12:15], s17 offen offset:1024 lds
    s_add_u32 s17, s17, 131072
    v_mfma_f32_16x16x32_bf16 v[12:15], v[112:115], v[92:95], v[12:15]
    ds_read_b128 v[68:71], v128 offset:2048
    v_mfma_f32_16x16x32_bf16 v[16:19], v[116:119], v[80:83], v[16:19]
    s_add_u32 m0, s36, 81920
    s_nop 0
    buffer_load_dwordx4 v136, s[8:11], s16 offen offset:0 sc1 lds
    v_mfma_f32_16x16x32_bf16 v[20:23], v[116:119], v[84:87], v[20:23]
    ds_read_b128 v[72:75], v128 offset:4096
    v_mfma_f32_16x16x32_bf16 v[24:27], v[116:119], v[88:91], v[24:27]
    ds_read_b128 v[76:79], v128 offset:6144
    v_mfma_f32_16x16x32_bf16 v[28:31], v[116:119], v[92:95], v[28:31]
    ds_read_b64_tr_b16 v[100:101], v133 offset:16384
    buffer_load_dwordx4 v137, s[8:11], s16 offen offset:1024 sc1 lds
    v_mfma_f32_16x16x32_bf16 v[32:35], v[120:123], v[80:83], v[32:35]
    ds_read_b64_tr_b16 v[102:103], v133 offset:17408
    v_mfma_f32_16x16x32_bf16 v[36:39], v[120:123], v[84:87], v[36:39]
    buffer_load_dwordx4 v138, s[8:11], s16 offen offset:2048 sc1 lds
    v_mfma_f32_16x16x32_bf16 v[40:43], v[120:123], v[88:91], v[40:43]
    ds_read_b64_tr_b16 v[104:105], v134 offset:16384
    v_mfma_f32_16x16x32_bf16 v[44:47], v[120:123], v[92:95], v[44:47]
    ds_read_b64_tr_b16 v[106:107], v134 offset:17408
    buffer_load_dwordx4 v139, s[8:11], s16 offen offset:3072 sc1 lds
    s_add_u32 s16, s16, 262144
    v_mfma_f32_16x16x32_bf16 v[48:51], v[124:127], v[80:83], v[48:51]
    ds_read_b64_tr_b16 v[108:109], v135 offset:16384
    v_mfma_f32_16x16x32_bf16 v[52:55], v[124:127], v[84:87], v[52:55]
    ds_read_b64_tr_b16 v[110:111], v135 offset:17408
    buffer_load_dword v165, v164, s[44:47], s22 offen offset:32 sc1
    s_setprio 0
    v_mfma_f32_16x16x32_bf16 v[56:59], v[124:127], v[88:91], v[56:59]
    v_mfma_f32_16x16x32_bf16 v[60:63], v[124:127], v[92:95], v[60:63]
    s_waitcnt lgkmcnt(9)
    v_mfma_f32_16x16x32_bf16 v[0:3], v[96:99], v[64:67], v[0:3]
    ds_read_b128 v[80:83], v129 offset:0
    s_waitcnt lgkmcnt(9)
    v_mfma_f32_16x16x32_bf16 v[4:7], v[96:99], v[68:71], v[4:7]
    ds_read_b64_tr_b16 v[112:113], v132 offset:24576
    s_waitcnt lgkmcnt(9)
    v_mfma_f32_16x16x32_bf16 v[8:11], v[96:99], v[72:75], v[8:11]
    ds_read_b64_tr_b16 v[114:115], v132 offset:25600
    s_waitcnt lgkmcnt(9)
    v_mfma_f32_16x16x32_bf16 v[12:15], v[96:99], v[76:79], v[12:15]
    ds_read_b128 v[84:87], v129 offset:2048
    s_waitcnt lgkmcnt(8)
    v_mfma_f32_16x16x32_bf16 v[16:19], v[100:103], v[64:67], v[16:19]
    ds_read_b128 v[88:91], v129 offset:4096
    v_mfma_f32_16x16x32_bf16 v[20:23], v[100:103], v[68:71], v[20:23]
    ds_read_b128 v[92:95], v129 offset:6144
    v_mfma_f32_16x16x32_bf16 v[24:27], v[100:103], v[72:75], v[24:27]
    ds_read_b64_tr_b16 v[116:117], v133 offset:24576
    v_mfma_f32_16x16x32_bf16 v[28:31], v[100:103], v[76:79], v[28:31]
    ds_read_b64_tr_b16 v[118:119], v133 offset:25600
    s_waitcnt lgkmcnt(10)
    v_mfma_f32_16x16x32_bf16 v[32:35], v[104:107], v[64:67], v[32:35]
    ds_read_b64_tr_b16 v[120:121], v134 offset:24576
    v_mfma_f32_16x16x32_bf16 v[36:39], v[104:107], v[68:71], v[36:39]
    ds_read_b64_tr_b16 v[122:123], v134 offset:25600
    v_mfma_f32_16x16x32_bf16 v[40:43], v[104:107], v[72:75], v[40:43]
    ds_read_b64_tr_b16 v[124:125], v135 offset:24576
    v_mfma_f32_16x16x32_bf16 v[44:47], v[104:107], v[76:79], v[44:47]
    ds_read_b64_tr_b16 v[126:127], v135 offset:25600
    s_waitcnt lgkmcnt(12)
    v_mfma_f32_16x16x32_bf16 v[48:51], v[108:111], v[64:67], v[48:51]
    v_mfma_f32_16x16x32_bf16 v[52:55], v[108:111], v[68:71], v[52:55]
    v_mfma_f32_16x16x32_bf16 v[56:59], v[108:111], v[72:75], v[56:59]
    s_waitcnt vmcnt(7) lgkmcnt(0)
    s_barrier
    s_setprio 1
    v_mfma_f32_16x16x32_bf16 v[60:63], v[108:111], v[76:79], v[60:63]
    v_mfma_f32_16x16x32_bf16 v[0:3], v[112:115], v[80:83], v[0:3]
    ds_read_b128 v[64:67], v128 offset:32768
    s_add_u32 m0, s37, 131072
    s_nop 0
    buffer_load_dwordx4 v140, s[12:15], s17 offen offset:0 lds
    v_mfma_f32_16x16x32_bf16 v[4:7], v[112:115], v[84:87], v[4:7]
    ds_read_b64_tr_b16 v[96:97], v132 offset:32768
    v_mfma_f32_16x16x32_bf16 v[8:11], v[112:115], v[88:91], v[8:11]
    ds_read_b64_tr_b16 v[98:99], v132 offset:33792
    buffer_load_dwordx4 v141, s[12:15], s17 offen offset:1024 lds
    s_mov_b32 s12, s32
    s_mov_b32 s13, s33
    s_mov_b32 s14, 2097152
    s_mov_b32 s17, s30
    v_mfma_f32_16x16x32_bf16 v[12:15], v[112:115], v[92:95], v[12:15]
    ds_read_b128 v[68:71], v128 offset:34816
    v_mfma_f32_16x16x32_bf16 v[16:19], v[116:119], v[80:83], v[16:19]
    s_add_u32 m0, s36, 0
    s_nop 0
    buffer_load_dwordx4 v136, s[8:11], s16 offen offset:0 sc1 lds
    v_mfma_f32_16x16x32_bf16 v[20:23], v[116:119], v[84:87], v[20:23]
    ds_read_b128 v[72:75], v128 offset:36864
    v_mfma_f32_16x16x32_bf16 v[24:27], v[116:119], v[88:91], v[24:27]
    ds_read_b128 v[76:79], v128 offset:38912
    v_mfma_f32_16x16x32_bf16 v[28:31], v[116:119], v[92:95], v[28:31]
    ds_read_b64_tr_b16 v[100:101], v133 offset:32768
    buffer_load_dwordx4 v137, s[8:11], s16 offen offset:1024 sc1 lds
    v_mfma_f32_16x16x32_bf16 v[32:35], v[120:123], v[80:83], v[32:35]
    ds_read_b64_tr_b16 v[102:103], v133 offset:33792
    v_mfma_f32_16x16x32_bf16 v[36:39], v[120:123], v[84:87], v[36:39]
    buffer_load_dwordx4 v138, s[8:11], s16 offen offset:2048 sc1 lds
    v_mfma_f32_16x16x32_bf16 v[40:43], v[120:123], v[88:91], v[40:43]
    ds_read_b64_tr_b16 v[104:105], v134 offset:32768
    v_mfma_f32_16x16x32_bf16 v[44:47], v[120:123], v[92:95], v[44:47]
    ds_read_b64_tr_b16 v[106:107], v134 offset:33792
    buffer_load_dwordx4 v139, s[8:11], s16 offen offset:3072 sc1 lds
    s_mov_b32 s16, s35
    v_mfma_f32_16x16x32_bf16 v[48:51], v[124:127], v[80:83], v[48:51]
    ds_read_b64_tr_b16 v[108:109], v135 offset:32768
    v_mfma_f32_16x16x32_bf16 v[52:55], v[124:127], v[84:87], v[52:55]
    ds_read_b64_tr_b16 v[110:111], v135 offset:33792
    s_setprio 0
    v_mfma_f32_16x16x32_bf16 v[56:59], v[124:127], v[88:91], v[56:59]
    v_mfma_f32_16x16x32_bf16 v[60:63], v[124:127], v[92:95], v[60:63]
    s_waitcnt lgkmcnt(9)
    v_mfma_f32_16x16x32_bf16 v[0:3], v[96:99], v[64:67], v[0:3]
    ds_read_b128 v[80:83], v129 offset:32768
    s_waitcnt lgkmcnt(9)
    v_mfma_f32_16x16x32_bf16 v[4:7], v[96:99], v[68:71], v[4:7]
    ds_read_b64_tr_b16 v[112:113], v132 offset:40960
    s_waitcnt lgkmcnt(9)
    v_mfma_f32_16x16x32_bf16 v[8:11], v[96:99], v[72:75], v[8:11]
    ds_read_b64_tr_b16 v[114:115], v132 offset:41984
    s_waitcnt lgkmcnt(9)
    v_mfma_f32_16x16x32_bf16 v[12:15], v[96:99], v[76:79], v[12:15]
    ds_read_b128 v[84:87], v129 offset:34816
    s_waitcnt lgkmcnt(8)
    v_mfma_f32_16x16x32_bf16 v[16:19], v[100:103], v[64:67], v[16:19]
    ds_read_b128 v[88:91], v129 offset:36864
    v_mfma_f32_16x16x32_bf16 v[20:23], v[100:103], v[68:71], v[20:23]
    ds_read_b128 v[92:95], v129 offset:38912
    v_mfma_f32_16x16x32_bf16 v[24:27], v[100:103], v[72:75], v[24:27]
    ds_read_b64_tr_b16 v[116:117], v133 offset:40960
    v_mfma_f32_16x16x32_bf16 v[28:31], v[100:103], v[76:79], v[28:31]
    ds_read_b64_tr_b16 v[118:119], v133 offset:41984
    s_waitcnt lgkmcnt(10)
    v_mfma_f32_16x16x32_bf16 v[32:35], v[104:107], v[64:67], v[32:35]
    ds_read_b64_tr_b16 v[120:121], v134 offset:40960
    v_mfma_f32_16x16x32_bf16 v[36:39], v[104:107], v[68:71], v[36:39]
    ds_read_b64_tr_b16 v[122:123], v134 offset:41984
    v_mfma_f32_16x16x32_bf16 v[40:43], v[104:107], v[72:75], v[40:43]
    ds_read_b64_tr_b16 v[124:125], v135 offset:40960
    v_mfma_f32_16x16x32_bf16 v[44:47], v[104:107], v[76:79], v[44:47]
    ds_read_b64_tr_b16 v[126:127], v135 offset:41984
    s_waitcnt lgkmcnt(12)
    v_mfma_f32_16x16x32_bf16 v[48:51], v[108:111], v[64:67], v[48:51]
    v_mfma_f32_16x16x32_bf16 v[52:55], v[108:111], v[68:71], v[52:55]
    v_mfma_f32_16x16x32_bf16 v[56:59], v[108:111], v[72:75], v[56:59]
    s_waitcnt vmcnt(7) lgkmcnt(0)
    s_barrier
    s_setprio 1
    v_mfma_f32_16x16x32_bf16 v[60:63], v[108:111], v[76:79], v[60:63]
    v_mfma_f32_16x16x32_bf16 v[0:3], v[112:115], v[80:83], v[0:3]
    s_waitcnt vmcnt(6)
    v_cmp_eq_u32 vcc, 1, v165
    s_nop 0
    s_cmp_eq_u64 vcc, -1
    s_cbranch_scc1 polld_96
    s_mov_b32 s70, 1048576
poll_95:
    s_sleep 1
    buffer_load_dword v165, v164, s[44:47], s22 offen offset:32 sc1
    s_waitcnt vmcnt(0)
    v_cmp_eq_u32 vcc, 1, v165
    s_nop 0
    s_cmp_eq_u64 vcc, -1
    s_cbranch_scc1 polld_96
    s_sub_u32 s70, s70, 1
    s_cmp_lg_u32 s70, 0
    s_cbranch_scc1 poll_95
polld_96:
    ds_read_b128 v[64:67], v130 offset:0
    s_add_u32 m0, s37, 147456
    s_nop 0
    buffer_load_dwordx4 v140, s[12:15], s17 offen offset:0 lds
    v_mfma_f32_16x16x32_bf16 v[4:7], v[112:115], v[84:87], v[4:7]
    ds_read_b64_tr_b16 v[96:97], v132 offset:0
    v_mfma_f32_16x16x32_bf16 v[8:11], v[112:115], v[88:91], v[8:11]
    ds_read_b64_tr_b16 v[98:99], v132 offset:1024
    buffer_load_dwordx4 v141, s[12:15], s17 offen offset:1024 lds
    s_add_u32 s17, s17, 131072
    v_mfma_f32_16x16x32_bf16 v[12:15], v[112:115], v[92:95], v[12:15]
    ds_read_b128 v[68:71], v130 offset:2048
    v_mfma_f32_16x16x32_bf16 v[16:19], v[116:119], v[80:83], v[16:19]
    s_add_u32 m0, s36, 32768
    s_nop 0
    buffer_load_dwordx4 v136, s[8:11], s16 offen offset:0 sc1 lds
    v_mfma_f32_16x16x32_bf16 v[20:23], v[116:119], v[84:87], v[20:23]
    ds_read_b128 v[72:75], v130 offset:4096
    v_mfma_f32_16x16x32_bf16 v[24:27], v[116:119], v[88:91], v[24:27]
    ds_read_b128 v[76:79], v130 offset:6144
    v_mfma_f32_16x16x32_bf16 v[28:31], v[116:119], v[92:95], v[28:31]
    ds_read_b64_tr_b16 v[100:101], v133 offset:0
    buffer_load_dwordx4 v137, s[8:11], s16 offen offset:1024 sc1 lds
    v_mfma_f32_16x16x32_bf16 v[32:35], v[120:123], v[80:83], v[32:35]
    ds_read_b64_tr_b16 v[102:103], v133 offset:1024
    v_mfma_f32_16x16x32_bf16 v[36:39], v[120:123], v[84:87], v[36:39]
    buffer_load_dwordx4 v138, s[8:11], s16 offen offset:2048 sc1 lds
    v_mfma_f32_16x16x32_bf16 v[40:43], v[120:123], v[88:91], v[40:43]
    ds_read_b64_tr_b16 v[104:105], v134 offset:0
    v_mfma_f32_16x16x32_bf16 v[44:47], v[120:123], v[92:95], v[44:47]
    ds_read_b64_tr_b16 v[106:107], v134 offset:1024
    buffer_load_dwordx4 v139, s[8:11], s16 offen offset:3072 sc1 lds
    s_add_u32 s16, s16, 262144
    v_mfma_f32_16x16x32_bf16 v[48:51], v[124:127], v[80:83], v[48:51]
    ds_read_b64_tr_b16 v[108:109], v135 offset:0
    v_mfma_f32_16x16x32_bf16 v[52:55], v[124:127], v[84:87], v[52:55]
    ds_read_b64_tr_b16 v[110:111], v135 offset:1024
    s_setprio 0
    v_mfma_f32_16x16x32_bf16 v[56:59], v[124:127], v[88:91], v[56:59]
    v_mfma_f32_16x16x32_bf16 v[60:63], v[124:127], v[92:95], v[60:63]
    s_waitcnt lgkmcnt(9)
    v_mfma_f32_16x16x32_bf16 v[0:3], v[96:99], v[64:67], v[0:3]
    ds_read_b128 v[80:83], v131 offset:0
    s_waitcnt lgkmcnt(9)
    v_mfma_f32_16x16x32_bf16 v[4:7], v[96:99], v[68:71], v[4:7]
    ds_read_b64_tr_b16 v[112:113], v132 offset:8192
    s_waitcnt lgkmcnt(9)
    v_mfma_f32_16x16x32_bf16 v[8:11], v[96:99], v[72:75], v[8:11]
    ds_read_b64_tr_b16 v[114:115], v132 offset:9216
    s_waitcnt lgkmcnt(9)
    v_mfma_f32_16x16x32_bf16 v[12:15], v[96:99], v[76:79], v[12:15]
    ds_read_b128 v[84:87], v131 offset:2048
    s_waitcnt lgkmcnt(8)
    v_mfma_f32_16x16x32_bf16 v[16:19], v[100:103], v[64:67], v[16:19]
    ds_read_b128 v[88:91], v131 offset:4096
    v_mfma_f32_16x16x32_bf16 v[20:23], v[100:103], v[68:71], v[20:23]
    ds_read_b128 v[92:95], v131 offset:6144
    v_mfma_f32_16x16x32_bf16 v[24:27], v[100:103], v[72:75], v[24:27]
    ds_read_b64_tr_b16 v[116:117], v133 offset:8192
    v_mfma_f32_16x16x32_bf16 v[28:31], v[100:103], v[76:79], v[28:31]
    ds_read_b64_tr_b16 v[118:119], v133 offset:9216
    s_waitcnt lgkmcnt(10)
    v_mfma_f32_16x16x32_bf16 v[32:35], v[104:107], v[64:67], v[32:35]
    ds_read_b64_tr_b16 v[120:121], v134 offset:8192
    v_mfma_f32_16x16x32_bf16 v[36:39], v[104:107], v[68:71], v[36:39]
    ds_read_b64_tr_b16 v[122:123], v134 offset:9216
    v_mfma_f32_16x16x32_bf16 v[40:43], v[104:107], v[72:75], v[40:43]
    ds_read_b64_tr_b16 v[124:125], v135 offset:8192
    v_mfma_f32_16x16x32_bf16 v[44:47], v[104:107], v[76:79], v[44:47]
    ds_read_b64_tr_b16 v[126:127], v135 offset:9216
    s_waitcnt lgkmcnt(12)
    v_mfma_f32_16x16x32_bf16 v[48:51], v[108:111], v[64:67], v[48:51]
    v_mfma_f32_16x16x32_bf16 v[52:55], v[108:111], v[68:71], v[52:55]
    v_mfma_f32_16x16x32_bf16 v[56:59], v[108:111], v[72:75], v[56:59]
    s_waitcnt vmcnt(6) lgkmcnt(0)
    s_barrier
    s_setprio 1
    v_mfma_f32_16x16x32_bf16 v[60:63], v[108:111], v[76:79], v[60:63]
    v_mfma_f32_16x16x32_bf16 v[0:3], v[112:115], v[80:83], v[0:3]
    ds_read_b128 v[64:67], v128 offset:0
    s_add_u32 m0, s37, 114688
    s_nop 0
    buffer_load_dwordx4 v140, s[12:15], s17 offen offset:0 lds
    v_mfma_f32_16x16x32_bf16 v[4:7], v[112:115], v[84:87], v[4:7]
    ds_read_b64_tr_b16 v[96:97], v132 offset:16384
    v_mfma_f32_16x16x32_bf16 v[8:11], v[112:115], v[88:91], v[8:11]
    ds_read_b64_tr_b16 v[98:99], v132 offset:17408
    buffer_load_dwordx4 v141, s[12:15], s17 offen offset:1024 lds
    s_add_u32 s17, s17, 131072
    v_mfma_f32_16x16x32_bf16 v[12:15], v[112:115], v[92:95], v[12:15]
    ds_read_b128 v[68:71], v128 offset:2048
    v_mfma_f32_16x16x32_bf16 v[16:19], v[116:119], v[80:83], v[16:19]
    s_add_u32 m0, s36, 81920
    s_nop 0
    buffer_load_dwordx4 v136, s[8:11], s16 offen offset:0 sc1 lds
    v_mfma_f32_16x16x32_bf16 v[20:23], v[116:119], v[84:87], v[20:23]
    ds_read_b128 v[72:75], v128 offset:4096
    v_mfma_f32_16x16x32_bf16 v[24:27], v[116:119], v[88:91], v[24:27]
    ds_read_b128 v[76:79], v128 offset:6144
    v_mfma_f32_16x16x32_bf16 v[28:31], v[116:119], v[92:95], v[28:31]
    ds_read_b64_tr_b16 v[100:101], v133 offset:16384
    buffer_load_dwordx4 v137, s[8:11], s16 offen offset:1024 sc1 lds
    v_mfma_f32_16x16x32_bf16 v[32:35], v[120:123], v[80:83], v[32:35]
    ds_read_b64_tr_b16 v[102:103], v133 offset:17408
    v_mfma_f32_16x16x32_bf16 v[36:39], v[120:123], v[84:87], v[36:39]
    buffer_load_dwordx4 v138, s[8:11], s16 offen offset:2048 sc1 lds
    v_mfma_f32_16x16x32_bf16 v[40:43], v[120:123], v[88:91], v[40:43]
    ds_read_b64_tr_b16 v[104:105], v134 offset:16384
    v_mfma_f32_16x16x32_bf16 v[44:47], v[120:123], v[92:95], v[44:47]
    ds_read_b64_tr_b16 v[106:107], v134 offset:17408
    buffer_load_dwordx4 v139, s[8:11], s16 offen offset:3072 sc1 lds
    s_add_u32 s16, s16, 262144
    v_mfma_f32_16x16x32_bf16 v[48:51], v[124:127], v[80:83], v[48:51]
    ds_read_b64_tr_b16 v[108:109], v135 offset:16384
    v_mfma_f32_16x16x32_bf16 v[52:55], v[124:127], v[84:87], v[52:55]
    ds_read_b64_tr_b16 v[110:111], v135 offset:17408
    s_setprio 0
    v_mfma_f32_16x16x32_bf16 v[56:59], v[124:127], v[88:91], v[56:59]
    v_mfma_f32_16x16x32_bf16 v[60:63], v[124:127], v[92:95], v[60:63]
    s_waitcnt lgkmcnt(9)
    v_mfma_f32_16x16x32_bf16 v[0:3], v[96:99], v[64:67], v[0:3]
    ds_read_b128 v[80:83], v129 offset:0
    s_waitcnt lgkmcnt(9)
    v_mfma_f32_16x16x32_bf16 v[4:7], v[96:99], v[68:71], v[4:7]
    ds_read_b64_tr_b16 v[112:113], v132 offset:24576
    s_waitcnt lgkmcnt(9)
    v_mfma_f32_16x16x32_bf16 v[8:11], v[96:99], v[72:75], v[8:11]
    ds_read_b64_tr_b16 v[114:115], v132 offset:25600
    s_waitcnt lgkmcnt(9)
    v_mfma_f32_16x16x32_bf16 v[12:15], v[96:99], v[76:79], v[12:15]
    ds_read_b128 v[84:87], v129 offset:2048
    s_waitcnt lgkmcnt(8)
    v_mfma_f32_16x16x32_bf16 v[16:19], v[100:103], v[64:67], v[16:19]
    ds_read_b128 v[88:91], v129 offset:4096
    v_mfma_f32_16x16x32_bf16 v[20:23], v[100:103], v[68:71], v[20:23]
    ds_read_b128 v[92:95], v129 offset:6144
    v_mfma_f32_16x16x32_bf16 v[24:27], v[100:103], v[72:75], v[24:27]
    ds_read_b64_tr_b16 v[116:117], v133 offset:24576
    v_mfma_f32_16x16x32_bf16 v[28:31], v[100:103], v[76:79], v[28:31]
    ds_read_b64_tr_b16 v[118:119], v133 offset:25600
    s_waitcnt lgkmcnt(10)
    v_mfma_f32_16x16x32_bf16 v[32:35], v[104:107], v[64:67], v[32:35]
    ds_read_b64_tr_b16 v[120:121], v134 offset:24576
    v_mfma_f32_16x16x32_bf16 v[36:39], v[104:107], v[68:71], v[36:39]
    ds_read_b64_tr_b16 v[122:123], v134 offset:25600
    v_mfma_f32_16x16x32_bf16 v[40:43], v[104:107], v[72:75], v[40:43]
    ds_read_b64_tr_b16 v[124:125], v135 offset:24576
    v_mfma_f32_16x16x32_bf16 v[44:47], v[104:107], v[76:79], v[44:47]
    ds_read_b64_tr_b16 v[126:127], v135 offset:25600
    s_waitcnt lgkmcnt(12)
    v_mfma_f32_16x16x32_bf16 v[48:51], v[108:111], v[64:67], v[48:51]
    v_mfma_f32_16x16x32_bf16 v[52:55], v[108:111], v[68:71], v[52:55]
    v_mfma_f32_16x16x32_bf16 v[56:59], v[108:111], v[72:75], v[56:59]
    s_waitcnt vmcnt(6) lgkmcnt(0)
    s_barrier
    s_setprio 1
    v_mfma_f32_16x16x32_bf16 v[60:63], v[108:111], v[76:79], v[60:63]
    v_mfma_f32_16x16x32_bf16 v[0:3], v[112:115], v[80:83], v[0:3]
    ds_read_b128 v[64:67], v128 offset:32768
    s_add_u32 m0, s37, 131072
    s_nop 0
    buffer_load_dwordx4 v140, s[12:15], s17 offen offset:0 lds
    v_mfma_f32_16x16x32_bf16 v[4:7], v[112:115], v[84:87], v[4:7]
    ds_read_b64_tr_b16 v[96:97], v132 offset:32768
    v_mfma_f32_16x16x32_bf16 v[8:11], v[112:115], v[88:91], v[8:11]
    ds_read_b64_tr_b16 v[98:99], v132 offset:33792
    buffer_load_dwordx4 v141, s[12:15], s17 offen offset:1024 lds
    s_add_u32 s17, s17, 131072
    v_mfma_f32_16x16x32_bf16 v[12:15], v[112:115], v[92:95], v[12:15]
    ds_read_b128 v[68:71], v128 offset:34816
    v_mfma_f32_16x16x32_bf16 v[16:19], v[116:119], v[80:83], v[16:19]
    s_add_u32 m0, s36, 0
    s_nop 0
    buffer_load_dwordx4 v136, s[8:11], s16 offen offset:0 sc1 lds
    v_mfma_f32_16x16x32_bf16 v[20:23], v[116:119], v[84:87], v[20:23]
    ds_read_b128 v[72:75], v128 offset:36864
    v_mfma_f32_16x16x32_bf16 v[24:27], v[116:119], v[88:91], v[24:27]
    ds_read_b128 v[76:79], v128 offset:38912
    v_mfma_f32_16x16x32_bf16 v[28:31], v[116:119], v[92:95], v[28:31]
    ds_read_b64_tr_b16 v[100:101], v133 offset:32768
    buffer_load_dwordx4 v137, s[8:11], s16 offen offset:1024 sc1 lds
    v_mfma_f32_16x16x32_bf16 v[32:35], v[120:123], v[80:83], v[32:35]
    ds_read_b64_tr_b16 v[102:103], v133 offset:33792
    v_mfma_f32_16x16x32_bf16 v[36:39], v[120:123], v[84:87], v[36:39]
    buffer_load_dwordx4 v138, s[8:11], s16 offen offset:2048 sc1 lds
    v_mfma_f32_16x16x32_bf16 v[40:43], v[120:123], v[88:91], v[40:43]
    ds_read_b64_tr_b16 v[104:105], v134 offset:32768
    v_mfma_f32_16x16x32_bf16 v[44:47], v[120:123], v[92:95], v[44:47]
    ds_read_b64_tr_b16 v[106:107], v134 offset:33792
    buffer_load_dwordx4 v139, s[8:11], s16 offen offset:3072 sc1 lds
    s_add_u32 s16, s16, 262144
    v_mfma_f32_16x16x32_bf16 v[48:51], v[124:127], v[80:83], v[48:51]
    ds_read_b64_tr_b16 v[108:109], v135 offset:32768
    v_mfma_f32_16x16x32_bf16 v[52:55], v[124:127], v[84:87], v[52:55]
    ds_read_b64_tr_b16 v[110:111], v135 offset:33792
    s_setprio 0
    v_mfma_f32_16x16x32_bf16 v[56:59], v[124:127], v[88:91], v[56:59]
    v_mfma_f32_16x16x32_bf16 v[60:63], v[124:127], v[92:95], v[60:63]
    s_waitcnt lgkmcnt(9)
    v_mfma_f32_16x16x32_bf16 v[0:3], v[96:99], v[64:67], v[0:3]
    ds_read_b128 v[80:83], v129 offset:32768
    s_waitcnt lgkmcnt(9)
    v_mfma_f32_16x16x32_bf16 v[4:7], v[96:99], v[68:71], v[4:7]
    ds_read_b64_tr_b16 v[112:113], v132 offset:40960
    s_waitcnt lgkmcnt(9)
    v_mfma_f32_16x16x32_bf16 v[8:11], v[96:99], v[72:75], v[8:11]
    ds_read_b64_tr_b16 v[114:115], v132 offset:41984
    s_waitcnt lgkmcnt(9)
    v_mfma_f32_16x16x32_bf16 v[12:15], v[96:99], v[76:79], v[12:15]
    ds_read_b128 v[84:87], v129 offset:34816
    s_waitcnt lgkmcnt(8)
    v_mfma_f32_16x16x32_bf16 v[16:19], v[100:103], v[64:67], v[16:19]
    ds_read_b128 v[88:91], v129 offset:36864
    v_mfma_f32_16x16x32_bf16 v[20:23], v[100:103], v[68:71], v[20:23]
    ds_read_b128 v[92:95], v129 offset:38912
    v_mfma_f32_16x16x32_bf16 v[24:27], v[100:103], v[72:75], v[24:27]
    ds_read_b64_tr_b16 v[116:117], v133 offset:40960
    v_mfma_f32_16x16x32_bf16 v[28:31], v[100:103], v[76:79], v[28:31]
    ds_read_b64_tr_b16 v[118:119], v133 offset:41984
    s_waitcnt lgkmcnt(10)
    v_mfma_f32_16x16x32_bf16 v[32:35], v[104:107], v[64:67], v[32:35]
    ds_read_b64_tr_b16 v[120:121], v134 offset:40960
    v_mfma_f32_16x16x32_bf16 v[36:39], v[104:107], v[68:71], v[36:39]
    ds_read_b64_tr_b16 v[122:123], v134 offset:41984
    v_mfma_f32_16x16x32_bf16 v[40:43], v[104:107], v[72:75], v[40:43]
    ds_read_b64_tr_b16 v[124:125], v135 offset:40960
    v_mfma_f32_16x16x32_bf16 v[44:47], v[104:107], v[76:79], v[44:47]
    ds_read_b64_tr_b16 v[126:127], v135 offset:41984
    s_waitcnt lgkmcnt(12)
    v_mfma_f32_16x16x32_bf16 v[48:51], v[108:111], v[64:67], v[48:51]
    v_mfma_f32_16x16x32_bf16 v[52:55], v[108:111], v[68:71], v[52:55]
    v_mfma_f32_16x16x32_bf16 v[56:59], v[108:111], v[72:75], v[56:59]
    s_waitcnt vmcnt(6) lgkmcnt(0)
    s_barrier
    s_setprio 1
    v_mfma_f32_16x16x32_bf16 v[60:63], v[108:111], v[76:79], v[60:63]
    v_mfma_f32_16x16x32_bf16 v[0:3], v[112:115], v[80:83], v[0:3]
    ds_read_b128 v[64:67], v130 offset:0
    s_add_u32 m0, s37, 147456
    s_nop 0
    buffer_load_dwordx4 v140, s[12:15], s17 offen offset:0 lds
    v_mfma_f32_16x16x32_bf16 v[4:7], v[112:115], v[84:87], v[4:7]
    ds_read_b64_tr_b16 v[96:97], v132 offset:0
    v_mfma_f32_16x16x32_bf16 v[8:11], v[112:115], v[88:91], v[8:11]
    ds_read_b64_tr_b16 v[98:99], v132 offset:1024
    buffer_load_dwordx4 v141, s[12:15], s17 offen offset:1024 lds
    s_add_u32 s17, s17, 131072
    v_mfma_f32_16x16x32_bf16 v[12:15], v[112:115], v[92:95], v[12:15]
    ds_read_b128 v[68:71], v130 offset:2048
    v_mfma_f32_16x16x32_bf16 v[16:19], v[116:119], v[80:83], v[16:19]
    s_add_u32 m0, s36, 32768
    s_nop 0
    buffer_load_dwordx4 v136, s[8:11], s16 offen offset:0 sc1 lds
    v_mfma_f32_16x16x32_bf16 v[20:23], v[116:119], v[84:87], v[20:23]
    ds_read_b128 v[72:75], v130 offset:4096
    v_mfma_f32_16x16x32_bf16 v[24:27], v[116:119], v[88:91], v[24:27]
    ds_read_b128 v[76:79], v130 offset:6144
    v_mfma_f32_16x16x32_bf16 v[28:31], v[116:119], v[92:95], v[28:31]
    ds_read_b64_tr_b16 v[100:101], v133 offset:0
    buffer_load_dwordx4 v137, s[8:11], s16 offen offset:1024 sc1 lds
    v_mfma_f32_16x16x32_bf16 v[32:35], v[120:123], v[80:83], v[32:35]
    ds_read_b64_tr_b16 v[102:103], v133 offset:1024
    v_mfma_f32_16x16x32_bf16 v[36:39], v[120:123], v[84:87], v[36:39]
    buffer_load_dwordx4 v138, s[8:11], s16 offen offset:2048 sc1 lds
    v_mfma_f32_16x16x32_bf16 v[40:43], v[120:123], v[88:91], v[40:43]
    ds_read_b64_tr_b16 v[104:105], v134 offset:0
    v_mfma_f32_16x16x32_bf16 v[44:47], v[120:123], v[92:95], v[44:47]
    ds_read_b64_tr_b16 v[106:107], v134 offset:1024
    buffer_load_dwordx4 v139, s[8:11], s16 offen offset:3072 sc1 lds
    s_add_u32 s16, s16, 262144
    v_mfma_f32_16x16x32_bf16 v[48:51], v[124:127], v[80:83], v[48:51]
    ds_read_b64_tr_b16 v[108:109], v135 offset:0
    v_mfma_f32_16x16x32_bf16 v[52:55], v[124:127], v[84:87], v[52:55]
    ds_read_b64_tr_b16 v[110:111], v135 offset:1024
    s_mov_b32 s56, s4
    s_mov_b32 s57, s5
    s_mov_b32 s58, 4194304
    s_mov_b32 s59, 0x00020000
    s_mov_b32 s40, s88
    s_mov_b32 s41, s89
    s_mov_b32 s42, 2048
    s_mov_b32 s43, 0x00020000
    buffer_load_dwordx4 v[144:147], v142, s[56:59], 0 offen offset:0
    buffer_load_dwordx4 v[152:155], v143, s[40:43], 0 offen offset:0
    buffer_load_dwordx4 v[148:151], v142, s[56:59], 0 offen offset:64
    buffer_load_dwordx4 v[156:159], v143, s[40:43], 0 offen offset:64
    s_setprio 0
    v_mfma_f32_16x16x32_bf16 v[56:59], v[124:127], v[88:91], v[56:59]
    v_mfma_f32_16x16x32_bf16 v[60:63], v[124:127], v[92:95], v[60:63]
    s_waitcnt lgkmcnt(9)
    v_mfma_f32_16x16x32_bf16 v[0:3], v[96:99], v[64:67], v[0:3]
    ds_read_b128 v[80:83], v131 offset:0
    s_waitcnt lgkmcnt(9)
    v_mfma_f32_16x16x32_bf16 v[4:7], v[96:99], v[68:71], v[4:7]
    ds_read_b64_tr_b16 v[112:113], v132 offset:8192
    s_waitcnt lgkmcnt(9)
    v_mfma_f32_16x16x32_bf16 v[8:11], v[96:99], v[72:75], v[8:11]
    ds_read_b64_tr_b16 v[114:115], v132 offset:9216
    s_waitcnt lgkmcnt(9)
    v_mfma_f32_16x16x32_bf16 v[12:15], v[96:99], v[76:79], v[12:15]
    ds_read_b128 v[84:87], v131 offset:2048
    s_waitcnt lgkmcnt(8)
    v_mfma_f32_16x16x32_bf16 v[16:19], v[100:103], v[64:67], v[16:19]
    ds_read_b128 v[88:91], v131 offset:4096
    v_mfma_f32_16x16x32_bf16 v[20:23], v[100:103], v[68:71], v[20:23]
    ds_read_b128 v[92:95], v131 offset:6144
    v_mfma_f32_16x16x32_bf16 v[24:27], v[100:103], v[72:75], v[24:27]
    ds_read_b64_tr_b16 v[116:117], v133 offset:8192
    v_mfma_f32_16x16x32_bf16 v[28:31], v[100:103], v[76:79], v[28:31]
    ds_read_b64_tr_b16 v[118:119], v133 offset:9216
    s_waitcnt lgkmcnt(10)
    v_mfma_f32_16x16x32_bf16 v[32:35], v[104:107], v[64:67], v[32:35]
    ds_read_b64_tr_b16 v[120:121], v134 offset:8192
    v_mfma_f32_16x16x32_bf16 v[36:39], v[104:107], v[68:71], v[36:39]
    ds_read_b64_tr_b16 v[122:123], v134 offset:9216
    v_mfma_f32_16x16x32_bf16 v[40:43], v[104:107], v[72:75], v[40:43]
    ds_read_b64_tr_b16 v[124:125], v135 offset:8192
    v_mfma_f32_16x16x32_bf16 v[44:47], v[104:107], v[76:79], v[44:47]
    ds_read_b64_tr_b16 v[126:127], v135 offset:9216
    s_waitcnt lgkmcnt(12)
    v_mfma_f32_16x16x32_bf16 v[48:51], v[108:111], v[64:67], v[48:51]
    v_mfma_f32_16x16x32_bf16 v[52:55], v[108:111], v[68:71], v[52:55]
    v_mfma_f32_16x16x32_bf16 v[56:59], v[108:111], v[72:75], v[56:59]
    s_waitcnt vmcnt(10) lgkmcnt(0)
    s_barrier
    s_setprio 1
    v_mfma_f32_16x16x32_bf16 v[60:63], v[108:111], v[76:79], v[60:63]
    v_mfma_f32_16x16x32_bf16 v[0:3], v[112:115], v[80:83], v[0:3]
    ds_read_b128 v[64:67], v128 offset:0
    v_mfma_f32_16x16x32_bf16 v[4:7], v[112:115], v[84:87], v[4:7]
    ds_read_b64_tr_b16 v[96:97], v132 offset:16384
    v_mfma_f32_16x16x32_bf16 v[8:11], v[112:115], v[88:91], v[8:11]
    ds_read_b64_tr_b16 v[98:99], v132 offset:17408
    v_mfma_f32_16x16x32_bf16 v[12:15], v[112:115], v[92:95], v[12:15]
    ds_read_b128 v[68:71], v128 offset:2048
    v_mfma_f32_16x16x32_bf16 v[16:19], v[116:119], v[80:83], v[16:19]
    v_mfma_f32_16x16x32_bf16 v[20:23], v[116:119], v[84:87], v[20:23]
    ds_read_b128 v[72:75], v128 offset:4096
    v_mfma_f32_16x16x32_bf16 v[24:27], v[116:119], v[88:91], v[24:27]
    ds_read_b128 v[76:79], v128 offset:6144
    v_mfma_f32_16x16x32_bf16 v[28:31], v[116:119], v[92:95], v[28:31]
    ds_read_b64_tr_b16 v[100:101], v133 offset:16384
    v_mfma_f32_16x16x32_bf16 v[32:35], v[120:123], v[80:83], v[32:35]
    ds_read_b64_tr_b16 v[102:103], v133 offset:17408
    v_mfma_f32_16x16x32_bf16 v[36:39], v[120:123], v[84:87], v[36:39]
    v_mfma_f32_16x16x32_bf16 v[40:43], v[120:123], v[88:91], v[40:43]
    ds_read_b64_tr_b16 v[104:105], v134 offset:16384
    v_mfma_f32_16x16x32_bf16 v[44:47], v[120:123], v[92:95], v[44:47]
    ds_read_b64_tr_b16 v[106:107], v134 offset:17408
    v_mfma_f32_16x16x32_bf16 v[48:51], v[124:127], v[80:83], v[48:51]
    ds_read_b64_tr_b16 v[108:109], v135 offset:16384
    v_mfma_f32_16x16x32_bf16 v[52:55], v[124:127], v[84:87], v[52:55]
    ds_read_b64_tr_b16 v[110:111], v135 offset:17408
    s_setprio 0
    v_mfma_f32_16x16x32_bf16 v[56:59], v[124:127], v[88:91], v[56:59]
    v_mfma_f32_16x16x32_bf16 v[60:63], v[124:127], v[92:95], v[60:63]
    s_waitcnt lgkmcnt(9)
    v_mfma_f32_16x16x32_bf16 v[0:3], v[96:99], v[64:67], v[0:3]
    ds_read_b128 v[80:83], v129 offset:0
    s_waitcnt lgkmcnt(9)
    v_mfma_f32_16x16x32_bf16 v[4:7], v[96:99], v[68:71], v[4:7]
    ds_read_b64_tr_b16 v[112:113], v132 offset:24576
    s_waitcnt lgkmcnt(9)
    v_mfma_f32_16x16x32_bf16 v[8:11], v[96:99], v[72:75], v[8:11]
    ds_read_b64_tr_b16 v[114:115], v132 offset:25600
    s_waitcnt lgkmcnt(9)
    v_mfma_f32_16x16x32_bf16 v[12:15], v[96:99], v[76:79], v[12:15]
    ds_read_b128 v[84:87], v129 offset:2048
    s_waitcnt lgkmcnt(8)
    v_mfma_f32_16x16x32_bf16 v[16:19], v[100:103], v[64:67], v[16:19]
    ds_read_b128 v[88:91], v129 offset:4096
    v_mfma_f32_16x16x32_bf16 v[20:23], v[100:103], v[68:71], v[20:23]
    ds_read_b128 v[92:95], v129 offset:6144
    v_mfma_f32_16x16x32_bf16 v[24:27], v[100:103], v[72:75], v[24:27]
    ds_read_b64_tr_b16 v[116:117], v133 offset:24576
    v_mfma_f32_16x16x32_bf16 v[28:31], v[100:103], v[76:79], v[28:31]
    ds_read_b64_tr_b16 v[118:119], v133 offset:25600
    s_waitcnt lgkmcnt(10)
    v_mfma_f32_16x16x32_bf16 v[32:35], v[104:107], v[64:67], v[32:35]
    ds_read_b64_tr_b16 v[120:121], v134 offset:24576
    v_mfma_f32_16x16x32_bf16 v[36:39], v[104:107], v[68:71], v[36:39]
    ds_read_b64_tr_b16 v[122:123], v134 offset:25600
    v_mfma_f32_16x16x32_bf16 v[40:43], v[104:107], v[72:75], v[40:43]
    ds_read_b64_tr_b16 v[124:125], v135 offset:24576
    v_mfma_f32_16x16x32_bf16 v[44:47], v[104:107], v[76:79], v[44:47]
    ds_read_b64_tr_b16 v[126:127], v135 offset:25600
    s_waitcnt lgkmcnt(12)
    v_mfma_f32_16x16x32_bf16 v[48:51], v[108:111], v[64:67], v[48:51]
    v_mfma_f32_16x16x32_bf16 v[52:55], v[108:111], v[68:71], v[52:55]
    v_mfma_f32_16x16x32_bf16 v[56:59], v[108:111], v[72:75], v[56:59]
    s_waitcnt vmcnt(4) lgkmcnt(0)
    s_barrier
    s_setprio 1
    v_mfma_f32_16x16x32_bf16 v[60:63], v[108:111], v[76:79], v[60:63]
    v_mfma_f32_16x16x32_bf16 v[0:3], v[112:115], v[80:83], v[0:3]
    ds_read_b128 v[64:67], v128 offset:32768
    v_mfma_f32_16x16x32_bf16 v[4:7], v[112:115], v[84:87], v[4:7]
    ds_read_b64_tr_b16 v[96:97], v132 offset:32768
    v_mfma_f32_16x16x32_bf16 v[8:11], v[112:115], v[88:91], v[8:11]
    ds_read_b64_tr_b16 v[98:99], v132 offset:33792
    v_mfma_f32_16x16x32_bf16 v[12:15], v[112:115], v[92:95], v[12:15]
    ds_read_b128 v[68:71], v128 offset:34816
    v_mfma_f32_16x16x32_bf16 v[16:19], v[116:119], v[80:83], v[16:19]
    v_mfma_f32_16x16x32_bf16 v[20:23], v[116:119], v[84:87], v[20:23]
    ds_read_b128 v[72:75], v128 offset:36864
    v_mfma_f32_16x16x32_bf16 v[24:27], v[116:119], v[88:91], v[24:27]
    ds_read_b128 v[76:79], v128 offset:38912
    v_mfma_f32_16x16x32_bf16 v[28:31], v[116:119], v[92:95], v[28:31]
    ds_read_b64_tr_b16 v[100:101], v133 offset:32768
    v_mfma_f32_16x16x32_bf16 v[32:35], v[120:123], v[80:83], v[32:35]
    ds_read_b64_tr_b16 v[102:103], v133 offset:33792
    v_mfma_f32_16x16x32_bf16 v[36:39], v[120:123], v[84:87], v[36:39]
    v_mfma_f32_16x16x32_bf16 v[40:43], v[120:123], v[88:91], v[40:43]
    ds_read_b64_tr_b16 v[104:105], v134 offset:32768
    v_mfma_f32_16x16x32_bf16 v[44:47], v[120:123], v[92:95], v[44:47]
    ds_read_b64_tr_b16 v[106:107], v134 offset:33792
    v_mfma_f32_16x16x32_bf16 v[48:51], v[124:127], v[80:83], v[48:51]
    ds_read_b64_tr_b16 v[108:109], v135 offset:32768
    v_mfma_f32_16x16x32_bf16 v[52:55], v[124:127], v[84:87], v[52:55]
    ds_read_b64_tr_b16 v[110:111], v135 offset:33792
    s_setprio 0
    v_mfma_f32_16x16x32_bf16 v[56:59], v[124:127], v[88:91], v[56:59]
    v_mfma_f32_16x16x32_bf16 v[60:63], v[124:127], v[92:95], v[60:63]
    s_waitcnt lgkmcnt(9)
    v_mfma_f32_16x16x32_bf16 v[0:3], v[96:99], v[64:67], v[0:3]
    ds_read_b128 v[80:83], v129 offset:32768
    s_waitcnt lgkmcnt(9)
    v_mfma_f32_16x16x32_bf16 v[4:7], v[96:99], v[68:71], v[4:7]
    ds_read_b64_tr_b16 v[112:113], v132 offset:40960
    s_waitcnt lgkmcnt(9)
    v_mfma_f32_16x16x32_bf16 v[8:11], v[96:99], v[72:75], v[8:11]
    ds_read_b64_tr_b16 v[114:115], v132 offset:41984
    s_waitcnt lgkmcnt(9)
    v_mfma_f32_16x16x32_bf16 v[12:15], v[96:99], v[76:79], v[12:15]
    ds_read_b128 v[84:87], v129 offset:34816
    s_waitcnt lgkmcnt(8)
    v_mfma_f32_16x16x32_bf16 v[16:19], v[100:103], v[64:67], v[16:19]
    ds_read_b128 v[88:91], v129 offset:36864
    v_mfma_f32_16x16x32_bf16 v[20:23], v[100:103], v[68:71], v[20:23]
    ds_read_b128 v[92:95], v129 offset:38912
    v_mfma_f32_16x16x32_bf16 v[24:27], v[100:103], v[72:75], v[24:27]
    ds_read_b64_tr_b16 v[116:117], v133 offset:40960
    v_mfma_f32_16x16x32_bf16 v[28:31], v[100:103], v[76:79], v[28:31]
    ds_read_b64_tr_b16 v[118:119], v133 offset:41984
    s_waitcnt lgkmcnt(10)
    v_mfma_f32_16x16x32_bf16 v[32:35], v[104:107], v[64:67], v[32:35]
    ds_read_b64_tr_b16 v[120:121], v134 offset:40960
    v_mfma_f32_16x16x32_bf16 v[36:39], v[104:107], v[68:71], v[36:39]
    ds_read_b64_tr_b16 v[122:123], v134 offset:41984
    v_mfma_f32_16x16x32_bf16 v[40:43], v[104:107], v[72:75], v[40:43]
    ds_read_b64_tr_b16 v[124:125], v135 offset:40960
    v_mfma_f32_16x16x32_bf16 v[44:47], v[104:107], v[76:79], v[44:47]
    ds_read_b64_tr_b16 v[126:127], v135 offset:41984
    s_waitcnt lgkmcnt(12)
    v_mfma_f32_16x16x32_bf16 v[48:51], v[108:111], v[64:67], v[48:51]
    v_mfma_f32_16x16x32_bf16 v[52:55], v[108:111], v[68:71], v[52:55]
    v_mfma_f32_16x16x32_bf16 v[56:59], v[108:111], v[72:75], v[56:59]
    v_mfma_f32_16x16x32_bf16 v[60:63], v[108:111], v[76:79], v[60:63]
    s_waitcnt lgkmcnt(9)
    v_mfma_f32_16x16x32_bf16 v[0:3], v[112:115], v[80:83], v[0:3]
    s_waitcnt lgkmcnt(8)
    v_mfma_f32_16x16x32_bf16 v[4:7], v[112:115], v[84:87], v[4:7]
    s_waitcnt lgkmcnt(7)
    v_mfma_f32_16x16x32_bf16 v[8:11], v[112:115], v[88:91], v[8:11]
    s_waitcnt lgkmcnt(6)
    v_mfma_f32_16x16x32_bf16 v[12:15], v[112:115], v[92:95], v[12:15]
    s_waitcnt lgkmcnt(4)
    v_mfma_f32_16x16x32_bf16 v[16:19], v[116:119], v[80:83], v[16:19]
    v_mfma_f32_16x16x32_bf16 v[20:23], v[116:119], v[84:87], v[20:23]
    v_mfma_f32_16x16x32_bf16 v[24:27], v[116:119], v[88:91], v[24:27]
    v_mfma_f32_16x16x32_bf16 v[28:31], v[116:119], v[92:95], v[28:31]
    s_waitcnt lgkmcnt(2)
    v_mfma_f32_16x16x32_bf16 v[32:35], v[120:123], v[80:83], v[32:35]
    v_mfma_f32_16x16x32_bf16 v[36:39], v[120:123], v[84:87], v[36:39]
    v_mfma_f32_16x16x32_bf16 v[40:43], v[120:123], v[88:91], v[40:43]
    v_mfma_f32_16x16x32_bf16 v[44:47], v[120:123], v[92:95], v[44:47]
    s_waitcnt lgkmcnt(0)
    v_mfma_f32_16x16x32_bf16 v[48:51], v[124:127], v[80:83], v[48:51]
    v_mfma_f32_16x16x32_bf16 v[52:55], v[124:127], v[84:87], v[52:55]
    s_setprio 0
    v_mfma_f32_16x16x32_bf16 v[56:59], v[124:127], v[88:91], v[56:59]
    v_mfma_f32_16x16x32_bf16 v[60:63], v[124:127], v[92:95], v[60:63]
    s_waitcnt vmcnt(0)
    s_mov_b32 s40, s90
    s_mov_b32 s41, s91
    s_mov_b32 s42, 4194304
    s_mov_b32 s43, 0x00020000
    s_lshl_b32 s61, s18, 3
    s_add_u32 s61, s61, s19
    v_lshlrev_b32 v160, 4, v254
    s_lshl_b32 s60, s24, 11
    v_add_u32 v160, s60, v160
    s_xor_b32 s60, s54, 1
    s_lshl_b32 s62, s61, 2
    s_add_u32 s60, s60, s62
    s_mul_i32 s60, s60, 49152
    s_add_u32 s60, s60, 10485760
    v_cvt_pk_bf16_f32 v64, v4, v5
    v_cvt_pk_bf16_f32 v65, v6, v7
    v_cvt_pk_bf16_f32 v66, v20, v21
    v_cvt_pk_bf16_f32 v67, v22, v23
    s_nop 0
    v_permlane16_swap_b32 v64, v66
    v_permlane16_swap_b32 v65, v67
    buffer_store_dwordx4 v[64:67], v160, s[44:47], s60 offen offset:0 sc1
    v_cvt_pk_bf16_f32 v68, v36, v37
    v_cvt_pk_bf16_f32 v69, v38, v39
    v_cvt_pk_bf16_f32 v70, v52, v53
    v_cvt_pk_bf16_f32 v71, v54, v55
    s_nop 0
    v_permlane16_swap_b32 v68, v70
    v_permlane16_swap_b32 v69, v71
    buffer_store_dwordx4 v[68:71], v160, s[44:47], s60 offen offset:1024 sc1
    s_xor_b32 s60, s54, 2
    s_lshl_b32 s62, s61, 2
    s_add_u32 s60, s60, s62
    s_mul_i32 s60, s60, 49152
    s_add_u32 s60, s60, 10502144
    v_cvt_pk_bf16_f32 v72, v8, v9
    v_cvt_pk_bf16_f32 v73, v10, v11
    v_cvt_pk_bf16_f32 v74, v24, v25
    v_cvt_pk_bf16_f32 v75, v26, v27
    s_nop 0
    v_permlane16_swap_b32 v72, v74
    v_permlane16_swap_b32 v73, v75
    buffer_store_dwordx4 v[72:75], v160, s[44:47], s60 offen offset:0 sc1
    v_cvt_pk_bf16_f32 v76, v40, v41
    v_cvt_pk_bf16_f32 v77, v42, v43
    v_cvt_pk_bf16_f32 v78, v56, v57
    v_cvt_pk_bf16_f32 v79, v58, v59
    s_nop 0
    v_permlane16_swap_b32 v76, v78
    v_permlane16_swap_b32 v77, v79
    buffer_store_dwordx4 v[76:79], v160, s[44:47], s60 offen offset:1024 sc1
    s_xor_b32 s60, s54, 3
    s_lshl_b32 s62, s61, 2
    s_add_u32 s60, s60, s62
    s_mul_i32 s60, s60, 49152
    s_add_u32 s60, s60, 10518528
    v_cvt_pk_bf16_f32 v80, v12, v13
    v_cvt_pk_bf16_f32 v81, v14, v15
    v_cvt_pk_bf16_f32 v82, v28, v29
    v_cvt_pk_bf16_f32 v83, v30, v31
    s_nop 0
    v_permlane16_swap_b32 v80, v82
    v_permlane16_swap_b32 v81, v83
    buffer_store_dwordx4 v[80:83], v160, s[44:47], s60 offen offset:0 sc1
    v_cvt_pk_bf16_f32 v84, v44, v45
    v_cvt_pk_bf16_f32 v85, v46, v47
    v_cvt_pk_bf16_f32 v86, v60, v61
    v_cvt_pk_bf16_f32 v87, v62, v63
    s_nop 0
    v_permlane16_swap_b32 v84, v86
    v_permlane16_swap_b32 v85, v87
    buffer_store_dwordx4 v[84:87], v160, s[44:47], s60 offen offset:1024 sc1
    v_permlane16_swap_b32 v0, v16
    v_permlane16_swap_b32 v1, v17
    v_permlane16_swap_b32 v2, v18
    v_permlane16_swap_b32 v3, v19
    v_permlane16_swap_b32 v32, v48
    v_permlane16_swap_b32 v33, v49
    v_permlane16_swap_b32 v34, v50
    v_permlane16_swap_b32 v35, v51
    v_lshlrev_b32 v162, 16, v144
    v_and_b32 v163, 0xffff0000, v144
    v_pk_add_f32 v[0:1], v[0:1], v[162:163]
    v_lshlrev_b32 v162, 16, v145
    v_and_b32 v163, 0xffff0000, v145
    v_pk_add_f32 v[2:3], v[2:3], v[162:163]
    v_lshlrev_b32 v162, 16, v146
    v_and_b32 v163, 0xffff0000, v146
    v_pk_add_f32 v[16:17], v[16:17], v[162:163]
    v_lshlrev_b32 v162, 16, v147
    v_and_b32 v163, 0xffff0000, v147
    v_pk_add_f32 v[18:19], v[18:19], v[162:163]
    v_lshlrev_b32 v162, 16, v148
    v_and_b32 v163, 0xffff0000, v148
    v_pk_add_f32 v[32:33], v[32:33], v[162:163]
    v_lshlrev_b32 v162, 16, v149
    v_and_b32 v163, 0xffff0000, v149
    v_pk_add_f32 v[34:35], v[34:35], v[162:163]
    v_lshlrev_b32 v162, 16, v150
    v_and_b32 v163, 0xffff0000, v150
    v_pk_add_f32 v[48:49], v[48:49], v[162:163]
    v_lshlrev_b32 v162, 16, v151
    v_and_b32 v163, 0xffff0000, v151
    v_pk_add_f32 v[50:51], v[50:51], v[162:163]
    v_lshlrev_b32 v162, 16, v152
    v_and_b32 v163, 0xffff0000, v152
    v_pk_add_f32 v[0:1], v[0:1], v[162:163]
    v_lshlrev_b32 v162, 16, v153
    v_and_b32 v163, 0xffff0000, v153
    v_pk_add_f32 v[2:3], v[2:3], v[162:163]
    v_lshlrev_b32 v162, 16, v154
    v_and_b32 v163, 0xffff0000, v154
    v_pk_add_f32 v[16:17], v[16:17], v[162:163]
    v_lshlrev_b32 v162, 16, v155
    v_and_b32 v163, 0xffff0000, v155
    v_pk_add_f32 v[18:19], v[18:19], v[162:163]
    v_lshlrev_b32 v162, 16, v156
    v_and_b32 v163, 0xffff0000, v156
    v_pk_add_f32 v[32:33], v[32:33], v[162:163]
    v_lshlrev_b32 v162, 16, v157
    v_and_b32 v163, 0xffff0000, v157
    v_pk_add_f32 v[34:35], v[34:35], v[162:163]
    v_lshlrev_b32 v162, 16, v158
    v_and_b32 v163, 0xffff0000, v158
    v_pk_add_f32 v[48:49], v[48:49], v[162:163]
    v_lshlrev_b32 v162, 16, v159
    v_and_b32 v163, 0xffff0000, v159
    v_pk_add_f32 v[50:51], v[50:51], v[162:163]
    s_waitcnt vmcnt(0)
    s_barrier
    s_cmp_eq_u32 s24, 0
    s_cbranch_scc0 nw_97
    s_lshl_b32 s60, s18, 5
    s_add_u32 s60, s60, s19
    s_lshl_b32 s60, s60, 7
    s_add_u32 s60, s60, 9437220
    v_and_b32 v161, 3, v254
    v_cmp_eq_u32 s[56:57], s54, v161
    v_lshlrev_b32 v161, 10, v161
    v_mov_b32 v162, 1
    s_lshl_b64 exec, 1, s54
    buffer_store_dword v162, v161, s[44:47], s60 offen sc1
    s_mov_b64 exec, 15
    buffer_load_dword v162, v161, s[44:47], s60 offen sc1
    s_waitcnt vmcnt(0)
    v_cmp_eq_u32 vcc, 1, v162
    s_nop 0
    s_or_b64 vcc, vcc, s[56:57]
    s_and_b32 s62, vcc_lo, 15
    s_cmp_eq_u32 s62, 15
    s_cbranch_scc1 polld_99
    s_mov_b32 s70, 1048576
poll_98:
    s_sleep 1
    buffer_load_dword v162, v161, s[44:47], s60 offen sc1
    s_waitcnt vmcnt(0)
    v_cmp_eq_u32 vcc, 1, v162
    s_nop 0
    s_or_b64 vcc, vcc, s[56:57]
    s_and_b32 s62, vcc_lo, 15
    s_cmp_eq_u32 s62, 15
    s_cbranch_scc1 polld_99
    s_sub_u32 s70, s70, 1
    s_cmp_lg_u32 s70, 0
    s_cbranch_scc1 poll_98
polld_99:
    s_mov_b64 exec, -1
nw_97:
    s_barrier
    s_lshl_b32 s60, s61, 2
    s_add_u32 s60, s60, s54
    s_mul_i32 s60, s60, 49152
    s_add_u32 s60, s60, 10485760
    buffer_load_dwordx4 v[64:67], v160, s[44:47], s60 offen offset:0 sc1
    buffer_load_dwordx4 v[68:71], v160, s[44:47], s60 offen offset:1024 sc1
    s_add_u32 s60, s60, 16384
    buffer_load_dwordx4 v[72:75], v160, s[44:47], s60 offen offset:0 sc1
    buffer_load_dwordx4 v[76:79], v160, s[44:47], s60 offen offset:1024 sc1
    s_add_u32 s60, s60, 16384
    buffer_load_dwordx4 v[80:83], v160, s[44:47], s60 offen offset:0 sc1
    buffer_load_dwordx4 v[84:87], v160, s[44:47], s60 offen offset:1024 sc1
    s_waitcnt vmcnt(4)
    v_lshlrev_b32 v162, 16, v64
    v_and_b32 v163, 0xffff0000, v64
    v_pk_add_f32 v[0:1], v[0:1], v[162:163]
    v_lshlrev_b32 v162, 16, v65
    v_and_b32 v163, 0xffff0000, v65
    v_pk_add_f32 v[2:3], v[2:3], v[162:163]
    v_lshlrev_b32 v162, 16, v66
    v_and_b32 v163, 0xffff0000, v66
    v_pk_add_f32 v[16:17], v[16:17], v[162:163]
    v_lshlrev_b32 v162, 16, v67
    v_and_b32 v163, 0xffff0000, v67
    v_pk_add_f32 v[18:19], v[18:19], v[162:163]
    v_lshlrev_b32 v162, 16, v68
    v_and_b32 v163, 0xffff0000, v68
    v_pk_add_f32 v[32:33], v[32:33], v[162:163]
    v_lshlrev_b32 v162, 16, v69
    v_and_b32 v163, 0xffff0000, v69
    v_pk_add_f32 v[34:35], v[34:35], v[162:163]
    v_lshlrev_b32 v162, 16, v70
    v_and_b32 v163, 0xffff0000, v70
    v_pk_add_f32 v[48:49], v[48:49], v[162:163]
    v_lshlrev_b32 v162, 16, v71
    v_and_b32 v163, 0xffff0000, v71
    v_pk_add_f32 v[50:51], v[50:51], v[162:163]
    s_waitcnt vmcnt(2)
    v_lshlrev_b32 v162, 16, v72
    v_and_b32 v163, 0xffff0000, v72
    v_pk_add_f32 v[0:1], v[0:1], v[162:163]
    v_lshlrev_b32 v162, 16, v73
    v_and_b32 v163, 0xffff0000, v73
    v_pk_add_f32 v[2:3], v[2:3], v[162:163]
    v_lshlrev_b32 v162, 16, v74
    v_and_b32 v163, 0xffff0000, v74
    v_pk_add_f32 v[16:17], v[16:17], v[162:163]
    v_lshlrev_b32 v162, 16, v75
    v_and_b32 v163, 0xffff0000, v75
    v_pk_add_f32 v[18:19], v[18:19], v[162:163]
    v_lshlrev_b32 v162, 16, v76
    v_and_b32 v163, 0xffff0000, v76
    v_pk_add_f32 v[32:33], v[32:33], v[162:163]
    v_lshlrev_b32 v162, 16, v77
    v_and_b32 v163, 0xffff0000, v77
    v_pk_add_f32 v[34:35], v[34:35], v[162:163]
    v_lshlrev_b32 v162, 16, v78
    v_and_b32 v163, 0xffff0000, v78
    v_pk_add_f32 v[48:49], v[48:49], v[162:163]
    v_lshlrev_b32 v162, 16, v79
    v_and_b32 v163, 0xffff0000, v79
    v_pk_add_f32 v[50:51], v[50:51], v[162:163]
    s_waitcnt vmcnt(0)
    v_lshlrev_b32 v162, 16, v80
    v_and_b32 v163, 0xffff0000, v80
    v_pk_add_f32 v[0:1], v[0:1], v[162:163]
    v_lshlrev_b32 v162, 16, v81
    v_and_b32 v163, 0xffff0000, v81
    v_pk_add_f32 v[2:3], v[2:3], v[162:163]
    v_lshlrev_b32 v162, 16, v82
    v_and_b32 v163, 0xffff0000, v82
    v_pk_add_f32 v[16:17], v[16:17], v[162:163]
    v_lshlrev_b32 v162, 16, v83
    v_and_b32 v163, 0xffff0000, v83
    v_pk_add_f32 v[18:19], v[18:19], v[162:163]
    v_lshlrev_b32 v162, 16, v84
    v_and_b32 v163, 0xffff0000, v84
    v_pk_add_f32 v[32:33], v[32:33], v[162:163]
    v_lshlrev_b32 v162, 16, v85
    v_and_b32 v163, 0xffff0000, v85
    v_pk_add_f32 v[34:35], v[34:35], v[162:163]
    v_lshlrev_b32 v162, 16, v86
    v_and_b32 v163, 0xffff0000, v86
    v_pk_add_f32 v[48:49], v[48:49], v[162:163]
    v_lshlrev_b32 v162, 16, v87
    v_and_b32 v163, 0xffff0000, v87
    v_pk_add_f32 v[50:51], v[50:51], v[162:163]
    v_cvt_pk_bf16_f32 v144, v0, v1
    v_cvt_pk_bf16_f32 v145, v2, v3
    v_cvt_pk_bf16_f32 v146, v16, v17
    v_cvt_pk_bf16_f32 v147, v18, v19
    buffer_store_dwordx4 v[144:147], v142, s[40:43], 0 offen offset:0
    v_cvt_pk_bf16_f32 v148, v32, v33
    v_cvt_pk_bf16_f32 v149, v34, v35
    v_cvt_pk_bf16_f32 v150, v48, v49
    v_cvt_pk_bf16_f32 v151, v50, v51
    buffer_store_dwordx4 v[148:151], v142, s[40:43], 0 offen offset:64
f1_done:
    s_endpgm
p_30:
    buffer_store_dwordx4 v[156:159], v113, s[40:43], s56 offen offset:0 sc1
    s_nop 0
    s_branch p_31
p_32:
    buffer_store_dwordx4 v[160:163], v113, s[40:43], s56 offen offset:1024 sc1
    s_nop 0
    s_branch p_33
p_34:
    buffer_store_dwordx4 v[164:167], v113, s[40:43], s56 offen offset:2048 sc1
    s_nop 0
    s_branch p_35
p_36:
    buffer_store_dwordx4 v[168:171], v113, s[40:43], s56 offen offset:3072 sc1
    s_nop 0
    s_branch p_37
p_38:
    buffer_store_dwordx4 v[172:175], v113, s[40:43], s56 offen offset:0 sc1
    s_nop 0
    s_branch p_39
p_40:
    buffer_store_dwordx4 v[176:179], v113, s[40:43], s56 offen offset:1024 sc1
    s_nop 0
    s_branch p_41
p_42:
    buffer_store_dwordx4 v[180:183], v113, s[40:43], s56 offen offset:2048 sc1
    s_nop 0
    s_branch p_43
p_44:
    buffer_store_dwordx4 v[184:187], v113, s[40:43], s56 offen offset:3072 sc1
    s_nop 0
    s_branch p_45
p_46:
    buffer_store_dwordx4 v[156:159], v113, s[40:43], s56 offen offset:0 sc1
    s_nop 0
    s_branch p_47
p_48:
    buffer_store_dwordx4 v[160:163], v113, s[40:43], s56 offen offset:1024 sc1
    s_nop 0
    s_branch p_49
p_50:
    buffer_store_dwordx4 v[164:167], v113, s[40:43], s56 offen offset:2048 sc1
    s_nop 0
    s_branch p_51
p_52:
    buffer_store_dwordx4 v[168:171], v113, s[40:43], s56 offen offset:3072 sc1
    s_nop 0
    s_branch p_53
p_54:
    buffer_store_dwordx4 v[172:175], v114, s[40:43], s57 offen offset:0 sc1
    s_nop 0
    s_branch p_55
p_56:
    buffer_store_dwordx4 v[176:179], v114, s[40:43], s57 offen offset:2048 sc1
    s_nop 0
    s_branch p_57
p_88:
    buffer_store_dwordx4 v[88:91], v250, s[40:43], s58 offen sc1
    buffer_store_dwordx4 v[92:95], v250, s[40:43], s58 offen offset:32 sc1
    s_nop 0
    s_branch p_89
.section .rodata,"a"
.p2align 6
.amdhsa_kernel f1_kernel
  .amdhsa_next_free_vgpr 256
  .amdhsa_next_free_sgpr 102
  .amdhsa_accum_offset 256
  .amdhsa_group_segment_fixed_size 0
  .amdhsa_kernarg_size 88
  .amdhsa_user_sgpr_count 2
  .amdhsa_user_sgpr_kernarg_segment_ptr 1
  .amdhsa_system_sgpr_workgroup_id_x 1
  .amdhsa_float_denorm_mode_32 3
.end_amdhsa_kernel
```
